```python
import torch

def _softmax(x, axis=-1):
    return torch.softmax(x, dim=axis)
def _gelu(x):
    return torch.nn.functional.gelu(x, approximate="tanh")
def _silu(x):
    return torch.nn.functional.silu(x)
def _sigmoid(x):
    return torch.sigmoid(x)
def _layernorm(x, axis=-1, eps=1e-5):
    m = x.mean(dim=axis, keepdim=True)
    v = x.var(dim=axis, keepdim=True, unbiased=False)
    return (x - m) / torch.sqrt(v + eps)
def _scatter_add(tgt, idx, src, axis=0):
    return tgt.clone().index_add_(axis, idx, src)
def _segment_sum(src, seg, n):
    out = torch.zeros((n,) + src.shape[1:], dtype=src.dtype)
    return out.index_add_(0, seg, src)
def _pad(x, pw):
    flat = tuple(v for pair in reversed(pw) for v in pair)
    return torch.nn.functional.pad(x, flat)

kernel_name = 'recurrent_scan__ssm_conv_s5__geglu_ffn__prompt'

def setup_inputs():

    _w = (lambda a: (lambda t: t.to(torch.bfloat16) if t.is_floating_point() else t)(torch.as_tensor(a)))
    def _A_setup():
        B, S, D = 1, 2048, 640
        P = D
        Lambda_re = -0.5 * (lambda _x: torch.exp(torch.as_tensor(_x)))((lambda *s: torch.randn(*s, dtype=torch.bfloat16) * 0.2)(P))
        Lambda_im = (lambda *s: torch.randn(*s, dtype=torch.bfloat16) * 0.4)(P) * 1.0
        B_re = (lambda *s: torch.randn(*s, dtype=torch.bfloat16) * 0.2)(P, D) * (D ** -0.5)
        B_im = (lambda *s: torch.randn(*s, dtype=torch.bfloat16) * 0.2)(P, D) * (D ** -0.5)
        C_re = (lambda *s: torch.randn(*s, dtype=torch.bfloat16) * 0.2)(D, P) * (P ** -0.5)
        C_im = (lambda *s: torch.randn(*s, dtype=torch.bfloat16) * 0.2)(D, P) * (P ** -0.5)
        log_dt = (lambda *s: torch.randn(*s, dtype=torch.bfloat16) * 0.2)(P) * 0.3 - 2.0
        Dskip = (lambda *s: torch.randn(*s, dtype=torch.bfloat16) * 0.05)(D)
        return {
            "x": _w((lambda *s: torch.randn(*s, dtype=torch.bfloat16) * 0.05)(B, S, D)),
            "Lambda_re": _w(Lambda_re),
            "Lambda_im": _w(Lambda_im),
            "B_re": _w(B_re),
            "B_im": _w(B_im),
            "C_re": _w(C_re),
            "C_im": _w(C_im),
            "log_dt": _w(log_dt),
            "Dskip": _w(Dskip),
        }
    _A_in = _A_setup()

    def _B_setup():
        B, S, D, F = 1, 2048, 640, 1728
        return {
            "x": _w((lambda *s: torch.randn(*s, dtype=torch.bfloat16) * 0.05)(B, S, D)),
            "w_gate": _w((lambda *s: torch.randn(*s, dtype=torch.bfloat16) * 0.05)(D, F)),
            "w_up": _w((lambda *s: torch.randn(*s, dtype=torch.bfloat16) * 0.05)(D, F)),
            "w_down": _w((lambda *s: torch.randn(*s, dtype=torch.bfloat16) * 0.05)(F, D)),
        }
    _B_in = _B_setup()

    return {
        "A_x": _A_in["x"],
        "A_Lambda_re": _A_in["Lambda_re"],
        "A_Lambda_im": _A_in["Lambda_im"],
        "A_B_re": _A_in["B_re"],
        "A_B_im": _A_in["B_im"],
        "A_C_re": _A_in["C_re"],
        "A_C_im": _A_in["C_im"],
        "A_log_dt": _A_in["log_dt"],
        "A_Dskip": _A_in["Dskip"],
        "B_x": _B_in["x"],
        "B_w_gate": _B_in["w_gate"],
        "B_w_up": _B_in["w_up"],
        "B_w_down": _B_in["w_down"],
    }

def reference(A_x, A_Lambda_re, A_Lambda_im, A_B_re, A_B_im, A_C_re, A_C_im, A_log_dt, A_Dskip, B_x, B_w_gate, B_w_up, B_w_down):
    def _A_ref(x, Lambda_re, Lambda_im, B_re, B_im, C_re, C_im, log_dt, Dskip):
        Bsz, L, H = x.shape
        Lam = Lambda_re + 1j * Lambda_im
        Bmat = B_re + 1j * B_im
        Cmat = C_re + 1j * C_im
        dt = torch.exp(log_dt)
        Lam_bar = torch.exp(dt * Lam)
        B_bar = ((Lam_bar - 1.0) / Lam)[:, None] * Bmat
        Bu = torch.einsum("bld,pd->blp", x + 0j, B_bar)
        h = torch.zeros_like(Bu[:, 0, :])
        hs = []
        for t in range(L):
            h = Lam_bar[None, :] * h + Bu[:, t, :]
            hs.append(h)
        hseq = torch.stack(hs, 1)
        y = 2.0 * torch.einsum("blp,dp->bld", hseq, Cmat).real + x * Dskip[None, None, :]
        return y

    def _B_ref(x, w_gate, w_up, w_down):
        return (_gelu(x @ w_gate) * (x @ w_up)) @ w_down

    x = A_x
    xn = _layernorm(x, axis=-1)
    s = _A_ref(xn, A_Lambda_re, A_Lambda_im, A_B_re, A_B_im, A_C_re, A_C_im, A_log_dt, A_Dskip)
    g = _silu(_B_ref(xn, B_w_gate, B_w_up, B_w_down))
    return x + s * g
```

```asm
; @launch grid=(256,1,1) block=(256,1,1) lds=163840
.amdgcn_target "amdgcn-amd-amdhsa--gfx950"
.text
.globl recurrent_scan__ssm_conv_s5__geglu_ffn__prompt_kernel
.p2align 8
.type recurrent_scan__ssm_conv_s5__geglu_ffn__prompt_kernel,@function
recurrent_scan__ssm_conv_s5__geglu_ffn__prompt_kernel:
  s_cmp_ge_u32 s2, 256
  s_cbranch_scc1 L_END
  s_load_dwordx16 s[16:31], s[0:1], 0
  s_load_dwordx16 s[32:47], s[0:1], 64
  s_memrealtime s[12:13]
  v_mov_b32 v59, 0x40000000
  v_cmp_eq_u32 vcc, 0, v0
  s_nop 1
  v_cndmask_b32_e64 v59, v59, 0, vcc
  v_and_b32 v1, 63, v0
  v_lshrrev_b32 v60, 6, v0
  s_nop 0
  v_readfirstlane_b32 s3, v60
  s_getpc_b64 s[10:11]
L_pcref:
  s_lshr_b32 s8, s2, 3
  s_lshl_b32 s8, s8, 11
  s_min_u32 s8, s8, L_CODE_END-recurrent_scan__ssm_conv_s5__geglu_ffn__prompt_kernel-2048
  s_sub_u32 s8, s8, L_pcref-recurrent_scan__ssm_conv_s5__geglu_ffn__prompt_kernel
  s_ashr_i32 s9, s8, 31
  s_add_u32 s10, s10, s8
  s_addc_u32 s11, s11, s9
  v_and_b32 v61, 15, v0
  v_lshlrev_b32 v61, 7, v61
  v_mov_b32 v63, s11
  v_add_co_u32 v62, vcc, s10, v61
  s_nop 1
  v_addc_co_u32 v63, vcc, 0, v63, vcc
  global_load_dword a254, v[62:63], off
  s_and_b32 s8, s2, 7
  s_lshr_b32 s9, s2, 3
  s_and_b32 s4, s8, 1
  s_lshl_b32 s4, s4, 3
  s_and_b32 s10, s9, 7
  s_add_u32 s4, s4, s10
  s_lshr_b32 s5, s8, 1
  s_lshr_b32 s10, s9, 3
  s_lshl_b32 s10, s10, 2
  s_add_u32 s5, s5, s10
  v_lshrrev_b32 v61, 3, v1
  v_and_b32 v62, 7, v1
  v_lshrrev_b32 v63, 1, v61
  v_xor_b32 v63, v62, v63
  v_mul_u32_u24 v2, 1280, v61
  v_lshl_add_u32 v2, v63, 4, v2
  v_xor_b32 v3, 64, v2
  v_add_u32 v3, 9216, v3
  v_add_u32 v4, 18432, v2
  v_add_u32 v5, 18432, v3
  s_lshl_b32 s10, s4, 2
  s_add_u32 s10, s10, s3
  s_mul_i32 s80, s10, 40960
  s_mul_i32 s81, s3, 12288
  s_add_u32 s81, s81, 98304
  s_lshl_b32 s82, s3, 12
  s_waitcnt lgkmcnt(0)
  s_cmp_eq_u32 s2, 0
  s_cbranch_scc0 L_noep_1
  s_or_b32 s12, s12, 1
  v_mov_b32 v58, s12
  s_mov_b32 s60, s44
  s_mov_b32 s61, s45
  s_mov_b32 s62, 0x100
  s_mov_b32 s63, 0x20000
  buffer_store_dword v58, v59, s[60:63], 0 offen sc1
L_noep_1:
  s_mov_b32 s48, s16
  s_mov_b32 s49, s17
  s_mov_b32 s50, 0x280000
  s_mov_b32 s51, 0x20000
  s_mov_b32 s56, s46
  s_mov_b32 s57, s47
  s_mov_b32 s58, 0x10d0000
  s_mov_b32 s59, 0x20000
  s_cmp_lt_u32 s5, 7
  s_cbranch_scc1 L_SSM
L_FFN:
  s_sub_u32 s99, s5, 7
  s_cmp_lt_u32 s3, 2
  s_cselect_b32 s52, s36, s38
  s_cselect_b32 s53, s37, s39
  s_mov_b32 s54, 2211840
  s_mov_b32 s55, 0x20000
  s_mul_i32 s8, s99, 384
  s_and_b32 s12, s3, 1
  s_mul_i32 s12, s12, 110592
  s_add_u32 s83, s8, s12
  s_add_u32 s84, s83, 128
  s_add_u32 s85, s83, 256
  v_lshrrev_b32 v61, 3, v1
  v_and_b32 v62, 7, v1
  v_and_b32 v63, 2, v61
  v_lshlrev_b32 v63, 1, v63
  v_xor_b32 v63, v62, v63
  v_mul_u32_u24 v10, 3456, v61
  v_lshl_add_u32 v10, v63, 4, v10
  v_add_u32 v11, 26624, v10
  v_add_u32 v12, 53248, v10
  v_add_u32 v13, 79872, v10
  s_add_u32 s14, s80, 0
  s_add_u32 m0, s81, 0
  s_nop 0
  buffer_load_dwordx4 v2, s[48:51], s14 offen offset:0 lds
  buffer_load_dwordx4 v3, s[48:51], s14 offen offset:1024 lds
  buffer_load_dwordx4 v4, s[48:51], s14 offen offset:2048 lds
  buffer_load_dwordx4 v5, s[48:51], s14 offen offset:3072 lds
  s_add_u32 s15, s83, 0
  s_add_u32 m0, s82, 0
  s_nop 0
  buffer_load_dwordx4 v10, s[52:55], s15 offen offset:0 lds
  buffer_load_dwordx4 v11, s[52:55], s15 offen offset:1024 lds
  buffer_load_dwordx4 v12, s[52:55], s15 offen offset:2048 lds
  buffer_load_dwordx4 v13, s[52:55], s15 offen offset:3072 lds
  s_add_u32 s14, s80, 128
  s_add_u32 m0, s81, 4096
  s_nop 0
  buffer_load_dwordx4 v2, s[48:51], s14 offen offset:0 lds
  buffer_load_dwordx4 v3, s[48:51], s14 offen offset:1024 lds
  buffer_load_dwordx4 v4, s[48:51], s14 offen offset:2048 lds
  buffer_load_dwordx4 v5, s[48:51], s14 offen offset:3072 lds
  s_add_u32 s15, s83, 221184
  s_add_u32 m0, s82, 16384
  s_nop 0
  buffer_load_dwordx4 v10, s[52:55], s15 offen offset:0 lds
  buffer_load_dwordx4 v11, s[52:55], s15 offen offset:1024 lds
  buffer_load_dwordx4 v12, s[52:55], s15 offen offset:2048 lds
  buffer_load_dwordx4 v13, s[52:55], s15 offen offset:3072 lds
  s_lshl_b32 s8, s99, 2
  s_add_u32 s9, s8, 40
  s_add_u32 s10, s8, 47
  s_cmp_le_u32 s99, 4
  s_cselect_b32 s9, s9, s10
  s_add_u32 s10, s9, 2
  s_cmp_eq_u32 s99, 4
  s_cselect_b32 s10, 83, s10
  s_lshl_b32 s8, s99, 1
  s_add_u32 s11, s8, 58
  s_add_u32 s12, s8, 75
  s_cmp_le_u32 s99, 4
  s_cselect_b32 s11, s11, s12
  s_mul_i32 s96, s9, 131072
  s_add_u32 s96, s96, 0x400000
  s_mul_i32 s97, s10, 131072
  s_add_u32 s97, s97, 0x400000
  s_mul_i32 s98, s11, 131072
  s_add_u32 s98, s98, 0x400000
  s_mov_b32 s12, 131072
  s_cmp_eq_u32 s99, 4
  s_cselect_b32 s92, 3538944, s12
  s_min_u32 s13, s3, 2
  s_mul_i32 s91, s99, 3
  s_add_u32 s91, s91, s13
  v_and_b32 v60, 31, v1
  v_lshrrev_b32 v61, 2, v60
  v_and_b32 v61, 1, v61
  v_lshlrev_b32 v61, 4, v61
  v_and_b32 v62, 3, v60
  v_add_u32 v61, v61, v62
  v_lshrrev_b32 v62, 3, v60
  v_lshl_add_u32 v57, v62, 2, v61
  v_lshrrev_b32 v62, 1, v57
  v_and_b32 v62, 7, v62
  v_lshrrev_b32 v63, 5, v1
  v_lshlrev_b32 v61, 7, v57
  v_add_u32 v61, s81, v61
  v_add_u32 v60, 0, v63
  v_xor_b32 v60, v60, v62
  v_lshl_add_u32 v6, v60, 4, v61
  v_add_u32 v60, 2, v63
  v_xor_b32 v60, v60, v62
  v_lshl_add_u32 v7, v60, 4, v61
  v_add_u32 v60, 4, v63
  v_xor_b32 v60, v60, v62
  v_lshl_add_u32 v8, v60, 4, v61
  v_add_u32 v60, 6, v63
  v_xor_b32 v60, v60, v62
  v_lshl_add_u32 v9, v60, 4, v61
  v_mov_b32 v32, 0x3f803f80
  v_lshrrev_b32 v60, 4, v1
  v_and_b32 v61, 15, v1
  v_lshrrev_b32 v62, 2, v61
  v_and_b32 v61, 3, v61
  v_lshrrev_b32 v63, 1, v60
  v_lshlrev_b32 v14, 10, v63
  v_lshl_add_u32 v14, v62, 7, v14
  v_and_b32 v60, 1, v60
  v_lshl_add_u32 v14, v60, 5, v14
  v_lshl_add_u32 v14, v61, 3, v14
  v_lshrrev_b32 v62, 1, v62
  v_lshl_add_u32 v14, v62, 6, v14
  v_xor_b32 v15, 64, v14
  v_add_u32 v16, 65536, v14
  v_add_u32 v17, 65536, v15
  v_and_b32 v60, 31, v1
  v_lshrrev_b32 v61, 2, v60
  v_and_b32 v61, 1, v61
  v_lshlrev_b32 v29, 10, v61
  v_and_b32 v61, 3, v60
  v_lshrrev_b32 v62, 3, v60
  v_lshl_add_u32 v61, v62, 2, v61
  v_lshrrev_b32 v62, 5, v1
  v_lshl_add_u32 v61, v62, 4, v61
  v_lshl_add_u32 v29, v61, 4, v29
  s_lshl_b32 s8, s4, 2
  s_add_u32 s8, s8, s3
  s_lshl_b32 s8, s8, 11
  v_add_u32 v29, s8, v29
  v_lshlrev_b32 v30, 2, v60
  v_add_u32 v30, 160768, v30
  v_cmp_gt_u32 vcc, 32, v1
  s_nop 1
  v_cndmask_b32_e64 v31, 0, -1, vcc
  v_mov_b32 v237, 0
  v_mov_b32 v238, 0
  v_mov_b32 v239, 0
  v_mov_b32 v241, 0
  v_mov_b32 v242, 0
  v_mov_b32 v243, 0
  v_mov_b32 v245, 0
  v_mov_b32 v246, 0
  v_mov_b32 v247, 0
  v_mov_b32 v249, 0
  v_mov_b32 v250, 0
  v_mov_b32 v251, 0
  s_waitcnt vmcnt(12)
  ds_read_b128 a[0:3], v6 offset:0
  ds_read_b128 a[4:7], v7 offset:0
  ds_read_b128 a[8:11], v8 offset:0
  ds_read_b128 a[12:15], v9 offset:0
  s_waitcnt vmcnt(8)
  s_barrier
  ds_read_b64_tr_b16 v[192:193], v14 offset:0
  ds_read_b64_tr_b16 v[194:195], v14 offset:512
  ds_read_b64_tr_b16 v[196:197], v15 offset:0
  ds_read_b64_tr_b16 v[198:199], v15 offset:512
  ds_read_b64_tr_b16 v[200:201], v14 offset:8192
  ds_read_b64_tr_b16 v[202:203], v14 offset:8704
  ds_read_b64_tr_b16 v[204:205], v15 offset:8192
  ds_read_b64_tr_b16 v[206:207], v15 offset:8704
  ds_read_b64_tr_b16 v[208:209], v14 offset:2048
  ds_read_b64_tr_b16 v[210:211], v14 offset:2560
  ds_read_b64_tr_b16 v[212:213], v15 offset:2048
  ds_read_b64_tr_b16 v[214:215], v15 offset:2560
  s_waitcnt lgkmcnt(12)
  s_waitcnt lgkmcnt(8)
  v_mfma_f32_32x32x16_bf16 v[64:79], v[192:195], a[0:3], 0
  ds_read_b64_tr_b16 v[216:217], v14 offset:10240
  ds_read_b64_tr_b16 v[218:219], v14 offset:10752
  s_add_u32 s14, s80, 256
  s_add_u32 m0, s81, 8192
  s_nop 0
  buffer_load_dwordx4 v2, s[48:51], s14 offen offset:0 lds
  s_waitcnt vmcnt(5)
  v_mfma_f32_32x32x16_bf16 v[96:111], v[196:199], a[0:3], 0
  ds_read_b64_tr_b16 v[220:221], v15 offset:10240
  ds_read_b64_tr_b16 v[222:223], v15 offset:10752
  buffer_load_dwordx4 v3, s[48:51], s14 offen offset:1024 lds
  ds_read_b128 a[16:19], v6 offset:4096
  s_waitcnt lgkmcnt(9)
  v_mfma_f32_32x32x16_bf16 v[80:95], v[200:203], a[0:3], 0
  ds_read_b64_tr_b16 v[192:193], v14 offset:4096
  ds_read_b64_tr_b16 v[194:195], v14 offset:4608
  buffer_load_dwordx4 v4, s[48:51], s14 offen offset:2048 lds
  ds_read_b128 a[20:23], v7 offset:4096
  v_mfma_f32_32x32x16_bf16 v[112:127], v[204:207], a[0:3], 0
  ds_read_b64_tr_b16 v[196:197], v15 offset:4096
  ds_read_b64_tr_b16 v[198:199], v15 offset:4608
  buffer_load_dwordx4 v5, s[48:51], s14 offen offset:3072 lds
  s_add_u32 s15, s83, 442368
  s_add_u32 m0, s82, 32768
  s_nop 0
  buffer_load_dwordx4 v10, s[52:55], s15 offen offset:0 lds
  ds_read_b128 a[24:27], v8 offset:4096
  s_waitcnt lgkmcnt(11)
  v_mfma_f32_32x32x16_bf16 v[64:79], v[208:211], a[4:7], v[64:79]
  ds_read_b64_tr_b16 v[200:201], v14 offset:12288
  ds_read_b64_tr_b16 v[202:203], v14 offset:12800
  buffer_load_dwordx4 v11, s[52:55], s15 offen offset:1024 lds
  ds_read_b128 a[28:31], v9 offset:4096
  v_mfma_f32_32x32x16_bf16 v[96:111], v[212:215], a[4:7], v[96:111]
  ds_read_b64_tr_b16 v[204:205], v15 offset:12288
  ds_read_b64_tr_b16 v[206:207], v15 offset:12800
  buffer_load_dwordx4 v12, s[52:55], s15 offen offset:2048 lds
  buffer_load_dwordx4 v13, s[52:55], s15 offen offset:3072 lds
  v_lshrrev_b32 v60, 5, v1
  s_waitcnt lgkmcnt(12)
  v_mfma_f32_32x32x16_bf16 v[80:95], v[216:219], a[4:7], v[80:95]
  ds_read_b64_tr_b16 v[208:209], v14 offset:6144
  ds_read_b64_tr_b16 v[210:211], v14 offset:6656
  s_add_u32 s14, s80, 384
  s_add_u32 m0, s81, 0
  s_nop 0
  buffer_load_dwordx4 v2, s[48:51], s14 offen offset:0 lds
  v_and_b32 v61, 31, v1
  v_mfma_f32_32x32x16_bf16 v[112:127], v[220:223], a[4:7], v[112:127]
  ds_read_b64_tr_b16 v[212:213], v15 offset:6144
  ds_read_b64_tr_b16 v[214:215], v15 offset:6656
  buffer_load_dwordx4 v3, s[48:51], s14 offen offset:1024 lds
  buffer_load_dwordx4 v4, s[48:51], s14 offen offset:2048 lds
  v_mul_u32_u24 v60, 1280, v60
  s_waitcnt lgkmcnt(10)
  v_mfma_f32_32x32x16_bf16 v[64:79], v[192:195], a[8:11], v[64:79]
  ds_read_b64_tr_b16 v[216:217], v14 offset:14336
  ds_read_b64_tr_b16 v[218:219], v14 offset:14848
  buffer_load_dwordx4 v5, s[48:51], s14 offen offset:3072 lds
  v_lshl_add_u32 v60, v61, 3, v60
  v_mfma_f32_32x32x16_bf16 v[96:111], v[196:199], a[8:11], v[96:111]
  ds_read_b64_tr_b16 v[220:221], v15 offset:14336
  ds_read_b64_tr_b16 v[222:223], v15 offset:14848
  s_add_u32 s15, s83, 663552
  s_add_u32 m0, s82, 49152
  s_nop 0
  buffer_load_dwordx4 v10, s[52:55], s15 offen offset:0 lds
  buffer_load_dwordx4 v11, s[52:55], s15 offen offset:1024 lds
  s_lshl_b32 s8, s4, 4
  s_add_u32 s8, s8, s5
  s_lshl_b32 s8, s8, 2
  s_add_u32 s8, s8, s3
  s_mul_i32 s8, s8, 2560
  buffer_load_dwordx2 v[128:129], v60, s[48:51], s8 offen offset:0
  buffer_load_dwordx2 v[130:131], v60, s[48:51], s8 offen offset:256
  buffer_load_dwordx2 v[132:133], v60, s[48:51], s8 offen offset:512
  buffer_load_dwordx2 v[134:135], v60, s[48:51], s8 offen offset:768
  buffer_load_dwordx2 v[136:137], v60, s[48:51], s8 offen offset:1024
  s_waitcnt lgkmcnt(8)
  v_mfma_f32_32x32x16_bf16 v[80:95], v[200:203], a[8:11], v[80:95]
  buffer_load_dwordx4 v12, s[52:55], s15 offen offset:2048 lds
  buffer_load_dwordx4 v13, s[52:55], s15 offen offset:3072 lds
  s_waitcnt vmcnt(21)
  s_barrier
  ds_read_b64_tr_b16 v[192:193], v14 offset:16384
  ds_read_b64_tr_b16 v[194:195], v14 offset:16896
  s_add_u32 s15, s83, 884736
  s_add_u32 m0, s82, 65536
  s_nop 0
  buffer_load_dwordx4 v10, s[52:55], s15 offen offset:0 lds
  s_waitcnt vmcnt(18)
  v_mfma_f32_32x32x16_bf16 v[112:127], v[204:207], a[8:11], v[112:127]
  ds_read_b64_tr_b16 v[196:197], v15 offset:16384
  ds_read_b64_tr_b16 v[198:199], v15 offset:16896
  s_waitcnt lgkmcnt(8)
  v_mfma_f32_32x32x16_bf16 v[64:79], v[208:211], a[12:15], v[64:79]
  ds_read_b64_tr_b16 v[200:201], v14 offset:24576
  ds_read_b64_tr_b16 v[202:203], v14 offset:25088
  buffer_load_dwordx4 v11, s[52:55], s15 offen offset:1024 lds
  ds_read_b128 a[32:35], v6 offset:8192
  v_mfma_f32_32x32x16_bf16 v[96:111], v[212:215], a[12:15], v[96:111]
  ds_read_b64_tr_b16 v[204:205], v15 offset:24576
  ds_read_b64_tr_b16 v[206:207], v15 offset:25088
  buffer_load_dwordx4 v12, s[52:55], s15 offen offset:2048 lds
  s_waitcnt lgkmcnt(9)
  v_mfma_f32_32x32x16_bf16 v[80:95], v[216:219], a[12:15], v[80:95]
  ds_read_b64_tr_b16 v[208:209], v14 offset:18432
  ds_read_b64_tr_b16 v[210:211], v14 offset:18944
  buffer_load_dwordx4 v13, s[52:55], s15 offen offset:3072 lds
  v_mfma_f32_32x32x16_bf16 v[112:127], v[220:223], a[12:15], v[112:127]
  ds_read_b64_tr_b16 v[212:213], v15 offset:18432
  ds_read_b64_tr_b16 v[214:215], v15 offset:18944
  s_add_u32 s14, s80, 512
  s_add_u32 m0, s81, 4096
  s_nop 0
  buffer_load_dwordx4 v2, s[48:51], s14 offen offset:0 lds
  ds_read_b128 a[36:39], v7 offset:8192
  s_waitcnt lgkmcnt(10)
  v_mfma_f32_32x32x16_bf16 v[64:79], v[192:195], a[16:19], v[64:79]
  ds_read_b64_tr_b16 v[216:217], v14 offset:26624
  ds_read_b64_tr_b16 v[218:219], v14 offset:27136
  buffer_load_dwordx4 v3, s[48:51], s14 offen offset:1024 lds
  v_mfma_f32_32x32x16_bf16 v[96:111], v[196:199], a[16:19], v[96:111]
  ds_read_b64_tr_b16 v[220:221], v15 offset:26624
  ds_read_b64_tr_b16 v[222:223], v15 offset:27136
  buffer_load_dwordx4 v4, s[48:51], s14 offen offset:2048 lds
  s_waitcnt lgkmcnt(9)
  v_mfma_f32_32x32x16_bf16 v[80:95], v[200:203], a[16:19], v[80:95]
  ds_read_b64_tr_b16 v[192:193], v14 offset:20480
  ds_read_b64_tr_b16 v[194:195], v14 offset:20992
  buffer_load_dwordx4 v5, s[48:51], s14 offen offset:3072 lds
  ds_read_b128 a[40:43], v8 offset:8192
  v_mfma_f32_32x32x16_bf16 v[112:127], v[204:207], a[16:19], v[112:127]
  ds_read_b64_tr_b16 v[196:197], v15 offset:20480
  ds_read_b64_tr_b16 v[198:199], v15 offset:20992
  s_add_u32 s15, s83, 1105920
  s_add_u32 m0, s82, 81920
  s_nop 0
  buffer_load_dwordx4 v10, s[52:55], s15 offen offset:0 lds
  s_waitcnt lgkmcnt(10)
  v_mfma_f32_32x32x16_bf16 v[64:79], v[208:211], a[20:23], v[64:79]
  ds_read_b64_tr_b16 v[200:201], v14 offset:28672
  ds_read_b64_tr_b16 v[202:203], v14 offset:29184
  buffer_load_dwordx4 v11, s[52:55], s15 offen offset:1024 lds
  v_mfma_f32_32x32x16_bf16 v[96:111], v[212:215], a[20:23], v[96:111]
  ds_read_b64_tr_b16 v[204:205], v15 offset:28672
  ds_read_b64_tr_b16 v[206:207], v15 offset:29184
  buffer_load_dwordx4 v12, s[52:55], s15 offen offset:2048 lds
  ds_read_b128 a[44:47], v9 offset:8192
  s_waitcnt lgkmcnt(10)
  v_mfma_f32_32x32x16_bf16 v[80:95], v[216:219], a[20:23], v[80:95]
  ds_read_b64_tr_b16 v[208:209], v14 offset:22528
  ds_read_b64_tr_b16 v[210:211], v14 offset:23040
  buffer_load_dwordx4 v13, s[52:55], s15 offen offset:3072 lds
  v_mfma_f32_32x32x16_bf16 v[112:127], v[220:223], a[20:23], v[112:127]
  ds_read_b64_tr_b16 v[212:213], v15 offset:22528
  ds_read_b64_tr_b16 v[214:215], v15 offset:23040
  s_waitcnt lgkmcnt(4)
  s_add_u32 s14, s80, 640
  s_add_u32 m0, s81, 8192
  s_nop 0
  buffer_load_dwordx4 v2, s[48:51], s14 offen offset:0 lds
  v_mfma_f32_32x32x16_bf16 v[64:79], v[192:195], a[24:27], v[64:79]
  ds_read_b64_tr_b16 v[216:217], v14 offset:30720
  ds_read_b64_tr_b16 v[218:219], v14 offset:31232
  buffer_load_dwordx4 v3, s[48:51], s14 offen offset:1024 lds
  s_mov_b32 s60, s44
  s_mov_b32 s61, s45
  s_mov_b32 s62, 0x100
  s_mov_b32 s63, 0x20000
  v_mov_b32 v56, 0
  buffer_load_dword v55, v56, s[60:63], 0 offen sc1
  v_mfma_f32_32x32x16_bf16 v[96:111], v[196:199], a[24:27], v[96:111]
  ds_read_b64_tr_b16 v[220:221], v15 offset:30720
  ds_read_b64_tr_b16 v[222:223], v15 offset:31232
  buffer_load_dwordx4 v4, s[48:51], s14 offen offset:2048 lds
  v_mfma_f32_32x32x16_bf16 v[80:95], v[200:203], a[24:27], v[80:95]
  buffer_load_dwordx4 v5, s[48:51], s14 offen offset:3072 lds
  s_waitcnt vmcnt(30)
  s_barrier
  ds_read_b64_tr_b16 v[192:193], v14 offset:32768
  ds_read_b64_tr_b16 v[194:195], v14 offset:33280
  s_add_u32 s15, s83, 1327104
  s_add_u32 m0, s82, 0
  s_nop 0
  buffer_load_dwordx4 v10, s[52:55], s15 offen offset:0 lds
  s_waitcnt vmcnt(27)
  v_mfma_f32_32x32x16_bf16 v[112:127], v[204:207], a[24:27], v[112:127]
  ds_read_b64_tr_b16 v[196:197], v15 offset:32768
  ds_read_b64_tr_b16 v[198:199], v15 offset:33280
  s_waitcnt lgkmcnt(8)
  v_mfma_f32_32x32x16_bf16 v[64:79], v[208:211], a[28:31], v[64:79]
  ds_read_b64_tr_b16 v[200:201], v14 offset:40960
  ds_read_b64_tr_b16 v[202:203], v14 offset:41472
  v_mfma_f32_32x32x16_bf16 v[96:111], v[212:215], a[28:31], v[96:111]
  ds_read_b64_tr_b16 v[204:205], v15 offset:40960
  ds_read_b64_tr_b16 v[206:207], v15 offset:41472
  buffer_load_dwordx4 v11, s[52:55], s15 offen offset:1024 lds
  ds_read_b128 a[48:51], v6 offset:0
  s_waitcnt lgkmcnt(9)
  v_mfma_f32_32x32x16_bf16 v[80:95], v[216:219], a[28:31], v[80:95]
  ds_read_b64_tr_b16 v[208:209], v14 offset:34816
  ds_read_b64_tr_b16 v[210:211], v14 offset:35328
  v_mfma_f32_32x32x16_bf16 v[112:127], v[220:223], a[28:31], v[112:127]
  ds_read_b64_tr_b16 v[212:213], v15 offset:34816
  ds_read_b64_tr_b16 v[214:215], v15 offset:35328
  buffer_load_dwordx4 v12, s[52:55], s15 offen offset:2048 lds
  s_waitcnt lgkmcnt(9)
  v_mfma_f32_32x32x16_bf16 v[64:79], v[192:195], a[32:35], v[64:79]
  ds_read_b64_tr_b16 v[216:217], v14 offset:43008
  ds_read_b64_tr_b16 v[218:219], v14 offset:43520
  ds_read_b128 a[52:55], v7 offset:0
  v_mfma_f32_32x32x16_bf16 v[96:111], v[196:199], a[32:35], v[96:111]
  ds_read_b64_tr_b16 v[220:221], v15 offset:43008
  ds_read_b64_tr_b16 v[222:223], v15 offset:43520
  buffer_load_dwordx4 v13, s[52:55], s15 offen offset:3072 lds
  s_waitcnt lgkmcnt(10)
  v_mfma_f32_32x32x16_bf16 v[80:95], v[200:203], a[32:35], v[80:95]
  ds_read_b64_tr_b16 v[192:193], v14 offset:36864
  ds_read_b64_tr_b16 v[194:195], v14 offset:37376
  v_mfma_f32_32x32x16_bf16 v[112:127], v[204:207], a[32:35], v[112:127]
  ds_read_b64_tr_b16 v[196:197], v15 offset:36864
  ds_read_b64_tr_b16 v[198:199], v15 offset:37376
  s_waitcnt lgkmcnt(6)
  s_add_u32 s14, s80, 768
  s_add_u32 m0, s81, 0
  s_nop 0
  buffer_load_dwordx4 v2, s[48:51], s14 offen offset:0 lds
  v_mfma_f32_32x32x16_bf16 v[64:79], v[208:211], a[36:39], v[64:79]
  ds_read_b64_tr_b16 v[200:201], v14 offset:45056
  ds_read_b64_tr_b16 v[202:203], v14 offset:45568
  ds_read_b128 a[56:59], v8 offset:0
  v_mfma_f32_32x32x16_bf16 v[96:111], v[212:215], a[36:39], v[96:111]
  ds_read_b64_tr_b16 v[204:205], v15 offset:45056
  ds_read_b64_tr_b16 v[206:207], v15 offset:45568
  buffer_load_dwordx4 v3, s[48:51], s14 offen offset:1024 lds
  s_waitcnt lgkmcnt(9)
  v_mfma_f32_32x32x16_bf16 v[80:95], v[216:219], a[36:39], v[80:95]
  ds_read_b64_tr_b16 v[208:209], v14 offset:38912
  ds_read_b64_tr_b16 v[210:211], v14 offset:39424
  v_mfma_f32_32x32x16_bf16 v[112:127], v[220:223], a[36:39], v[112:127]
  ds_read_b64_tr_b16 v[212:213], v15 offset:38912
  ds_read_b64_tr_b16 v[214:215], v15 offset:39424
  buffer_load_dwordx4 v4, s[48:51], s14 offen offset:2048 lds
  ds_read_b128 a[60:63], v9 offset:0
  s_waitcnt lgkmcnt(10)
  v_mfma_f32_32x32x16_bf16 v[64:79], v[192:195], a[40:43], v[64:79]
  ds_read_b64_tr_b16 v[216:217], v14 offset:47104
  ds_read_b64_tr_b16 v[218:219], v14 offset:47616
  v_mfma_f32_32x32x16_bf16 v[96:111], v[196:199], a[40:43], v[96:111]
  ds_read_b64_tr_b16 v[220:221], v15 offset:47104
  ds_read_b64_tr_b16 v[222:223], v15 offset:47616
  buffer_load_dwordx4 v5, s[48:51], s14 offen offset:3072 lds
  s_waitcnt lgkmcnt(9)
  v_mfma_f32_32x32x16_bf16 v[80:95], v[200:203], a[40:43], v[80:95]
  s_waitcnt vmcnt(25)
  s_barrier
  ds_read_b64_tr_b16 v[192:193], v14 offset:49152
  ds_read_b64_tr_b16 v[194:195], v14 offset:49664
  s_add_u32 s15, s83, 1548288
  s_add_u32 m0, s82, 16384
  s_nop 0
  buffer_load_dwordx4 v10, s[52:55], s15 offen offset:0 lds
  s_waitcnt vmcnt(18)
  ds_read_b128 a[64:67], v6 offset:4096
  ds_read_b128 a[68:71], v7 offset:4096
  ds_read_b128 a[72:75], v8 offset:4096
  v_mfma_f32_32x32x16_bf16 v[112:127], v[204:207], a[40:43], v[112:127]
  ds_read_b64_tr_b16 v[196:197], v15 offset:49152
  ds_read_b64_tr_b16 v[198:199], v15 offset:49664
  ds_read_b128 a[76:79], v9 offset:4096
  v_lshlrev_b32 v40, 16, v128
  s_waitcnt lgkmcnt(13)
  v_mfma_f32_32x32x16_bf16 v[64:79], v[208:211], a[44:47], v[64:79]
  ds_read_b64_tr_b16 v[200:201], v14 offset:57344
  ds_read_b64_tr_b16 v[202:203], v14 offset:57856
  v_and_b32 v41, 0xffff0000, v128
  v_mov_b32 v42, v40
  v_mov_b32 v43, v41
  v_mfma_f32_32x32x16_bf16 v[96:111], v[212:215], a[44:47], v[96:111]
  ds_read_b64_tr_b16 v[204:205], v15 offset:57344
  ds_read_b64_tr_b16 v[206:207], v15 offset:57856
  buffer_load_dwordx4 v11, s[52:55], s15 offen offset:1024 lds
  v_mul_f32 v44, v40, v40
  v_mul_f32 v45, v41, v41
  v_lshlrev_b32 v40, 16, v129
  s_waitcnt lgkmcnt(12)
  v_mfma_f32_32x32x16_bf16 v[80:95], v[216:219], a[44:47], v[80:95]
  ds_read_b64_tr_b16 v[208:209], v14 offset:51200
  ds_read_b64_tr_b16 v[210:211], v14 offset:51712
  v_and_b32 v41, 0xffff0000, v129
  v_add_f32 v42, v42, v40
  v_add_f32 v43, v43, v41
  v_mfma_f32_32x32x16_bf16 v[112:127], v[220:223], a[44:47], v[112:127]
  ds_read_b64_tr_b16 v[212:213], v15 offset:51200
  ds_read_b64_tr_b16 v[214:215], v15 offset:51712
  buffer_load_dwordx4 v12, s[52:55], s15 offen offset:2048 lds
  v_fmac_f32 v44, v40, v40
  v_fmac_f32 v45, v41, v41
  v_lshlrev_b32 v40, 16, v130
  s_waitcnt lgkmcnt(9)
  v_mfma_f32_32x32x16_bf16 v[64:79], v[192:195], a[48:51], v[64:79]
  ds_read_b64_tr_b16 v[216:217], v14 offset:59392
  ds_read_b64_tr_b16 v[218:219], v14 offset:59904
  v_and_b32 v41, 0xffff0000, v130
  v_add_f32 v42, v42, v40
  v_add_f32 v43, v43, v41
  v_mfma_f32_32x32x16_bf16 v[96:111], v[196:199], a[48:51], v[96:111]
  ds_read_b64_tr_b16 v[220:221], v15 offset:59392
  ds_read_b64_tr_b16 v[222:223], v15 offset:59904
  buffer_load_dwordx4 v13, s[52:55], s15 offen offset:3072 lds
  v_fmac_f32 v44, v40, v40
  v_fmac_f32 v45, v41, v41
  v_lshlrev_b32 v40, 16, v131
  s_waitcnt lgkmcnt(8)
  v_mfma_f32_32x32x16_bf16 v[80:95], v[200:203], a[48:51], v[80:95]
  ds_read_b64_tr_b16 v[192:193], v14 offset:53248
  ds_read_b64_tr_b16 v[194:195], v14 offset:53760
  v_and_b32 v41, 0xffff0000, v131
  v_add_f32 v42, v42, v40
  v_add_f32 v43, v43, v41
  v_mfma_f32_32x32x16_bf16 v[112:127], v[204:207], a[48:51], v[112:127]
  ds_read_b64_tr_b16 v[196:197], v15 offset:53248
  ds_read_b64_tr_b16 v[198:199], v15 offset:53760
  s_add_u32 s14, s80, 896
  s_add_u32 m0, s81, 4096
  s_nop 0
  buffer_load_dwordx4 v2, s[48:51], s14 offen offset:0 lds
  v_fmac_f32 v44, v40, v40
  v_fmac_f32 v45, v41, v41
  v_lshlrev_b32 v40, 16, v132
  s_waitcnt lgkmcnt(8)
  v_mfma_f32_32x32x16_bf16 v[64:79], v[208:211], a[52:55], v[64:79]
  ds_read_b64_tr_b16 v[200:201], v14 offset:61440
  ds_read_b64_tr_b16 v[202:203], v14 offset:61952
  v_and_b32 v41, 0xffff0000, v132
  v_add_f32 v42, v42, v40
  v_add_f32 v43, v43, v41
  v_mfma_f32_32x32x16_bf16 v[96:111], v[212:215], a[52:55], v[96:111]
  ds_read_b64_tr_b16 v[204:205], v15 offset:61440
  ds_read_b64_tr_b16 v[206:207], v15 offset:61952
  buffer_load_dwordx4 v3, s[48:51], s14 offen offset:1024 lds
  v_fmac_f32 v44, v40, v40
  v_fmac_f32 v45, v41, v41
  v_lshlrev_b32 v40, 16, v133
  s_waitcnt lgkmcnt(8)
  v_mfma_f32_32x32x16_bf16 v[80:95], v[216:219], a[52:55], v[80:95]
  ds_read_b64_tr_b16 v[208:209], v14 offset:55296
  ds_read_b64_tr_b16 v[210:211], v14 offset:55808
  v_and_b32 v41, 0xffff0000, v133
  v_add_f32 v42, v42, v40
  v_add_f32 v43, v43, v41
  v_mfma_f32_32x32x16_bf16 v[112:127], v[220:223], a[52:55], v[112:127]
  ds_read_b64_tr_b16 v[212:213], v15 offset:55296
  ds_read_b64_tr_b16 v[214:215], v15 offset:55808
  buffer_load_dwordx4 v4, s[48:51], s14 offen offset:2048 lds
  v_fmac_f32 v44, v40, v40
  v_fmac_f32 v45, v41, v41
  v_lshlrev_b32 v40, 16, v134
  s_waitcnt lgkmcnt(8)
  v_mfma_f32_32x32x16_bf16 v[64:79], v[192:195], a[56:59], v[64:79]
  ds_read_b64_tr_b16 v[216:217], v14 offset:63488
  ds_read_b64_tr_b16 v[218:219], v14 offset:64000
  v_and_b32 v41, 0xffff0000, v134
  v_add_f32 v42, v42, v40
  v_add_f32 v43, v43, v41
  v_mfma_f32_32x32x16_bf16 v[96:111], v[196:199], a[56:59], v[96:111]
  ds_read_b64_tr_b16 v[220:221], v15 offset:63488
  ds_read_b64_tr_b16 v[222:223], v15 offset:64000
  buffer_load_dwordx4 v5, s[48:51], s14 offen offset:3072 lds
  v_fmac_f32 v44, v40, v40
  v_fmac_f32 v45, v41, v41
  v_lshlrev_b32 v40, 16, v135
  s_waitcnt lgkmcnt(8)
  v_mfma_f32_32x32x16_bf16 v[80:95], v[200:203], a[56:59], v[80:95]
  v_and_b32 v41, 0xffff0000, v135
  v_add_f32 v42, v42, v40
  v_add_f32 v43, v43, v41
  s_barrier
  ds_read_b64_tr_b16 v[192:193], v16 offset:0
  ds_read_b64_tr_b16 v[194:195], v16 offset:512
  s_add_u32 s15, s83, 1769472
  s_add_u32 m0, s82, 32768
  s_nop 0
  buffer_load_dwordx4 v10, s[52:55], s15 offen offset:0 lds
  s_waitcnt vmcnt(17)
  ds_read_b128 a[80:83], v6 offset:8192
  ds_read_b128 a[84:87], v7 offset:8192
  ds_read_b128 a[88:91], v8 offset:8192
  ds_read_b128 a[92:95], v9 offset:8192
  v_fmac_f32 v44, v40, v40
  v_mfma_f32_32x32x16_bf16 v[112:127], v[204:207], a[56:59], v[112:127]
  ds_read_b64_tr_b16 v[196:197], v17 offset:0
  ds_read_b64_tr_b16 v[198:199], v17 offset:512
  v_fmac_f32 v45, v41, v41
  v_lshlrev_b32 v40, 16, v136
  v_and_b32 v41, 0xffff0000, v136
  v_add_f32 v42, v42, v40
  v_add_f32 v43, v43, v41
  v_fmac_f32 v44, v40, v40
  s_waitcnt lgkmcnt(12)
  v_mfma_f32_32x32x16_bf16 v[64:79], v[208:211], a[60:63], v[64:79]
  ds_read_b64_tr_b16 v[200:201], v16 offset:8192
  ds_read_b64_tr_b16 v[202:203], v16 offset:8704
  v_fmac_f32 v45, v41, v41
  v_lshlrev_b32 v40, 16, v137
  v_and_b32 v41, 0xffff0000, v137
  v_add_f32 v42, v42, v40
  v_add_f32 v43, v43, v41
  v_fmac_f32 v44, v40, v40
  v_mfma_f32_32x32x16_bf16 v[96:111], v[212:215], a[60:63], v[96:111]
  ds_read_b64_tr_b16 v[204:205], v17 offset:8192
  ds_read_b64_tr_b16 v[206:207], v17 offset:8704
  buffer_load_dwordx4 v11, s[52:55], s15 offen offset:1024 lds
  v_fmac_f32 v45, v41, v41
  v_add_f32 v42, v42, v43
  v_add_f32 v44, v44, v45
  s_nop 0
  v_add_f32_dpp v42, v42, v42 row_ror:8 row_mask:0xf bank_mask:0xf
  v_add_f32_dpp v44, v44, v44 row_ror:8 row_mask:0xf bank_mask:0xf
  s_waitcnt lgkmcnt(12)
  v_mfma_f32_32x32x16_bf16 v[80:95], v[216:219], a[60:63], v[80:95]
  ds_read_b64_tr_b16 v[208:209], v16 offset:2048
  ds_read_b64_tr_b16 v[210:211], v16 offset:2560
  v_add_f32_dpp v42, v42, v42 row_ror:4 row_mask:0xf bank_mask:0xf
  v_add_f32_dpp v44, v44, v44 row_ror:4 row_mask:0xf bank_mask:0xf
  s_nop 0
  v_add_f32_dpp v42, v42, v42 row_ror:2 row_mask:0xf bank_mask:0xf
  v_add_f32_dpp v44, v44, v44 row_ror:2 row_mask:0xf bank_mask:0xf
  s_nop 0
  v_add_f32_dpp v42, v42, v42 row_ror:1 row_mask:0xf bank_mask:0xf
  v_add_f32_dpp v44, v44, v44 row_ror:1 row_mask:0xf bank_mask:0xf
  v_mfma_f32_32x32x16_bf16 v[112:127], v[220:223], a[60:63], v[112:127]
  ds_read_b64_tr_b16 v[212:213], v17 offset:2048
  ds_read_b64_tr_b16 v[214:215], v17 offset:2560
  buffer_load_dwordx4 v12, s[52:55], s15 offen offset:2048 lds
  v_mov_b32 v43, v42
  v_mov_b32 v45, v44
  s_nop 0
  v_permlane16_swap_b32 v42, v43
  v_permlane16_swap_b32 v44, v45
  v_add_f32 v42, v42, v43
  v_add_f32 v44, v44, v45
  s_waitcnt lgkmcnt(8)
  v_mfma_f32_32x32x16_bf16 v[64:79], v[192:195], a[64:67], v[64:79]
  ds_read_b64_tr_b16 v[216:217], v16 offset:10240
  ds_read_b64_tr_b16 v[218:219], v16 offset:10752
  v_mul_f32 v42, 0x3acccccd, v42
  v_mul_f32 v44, 0x3acccccd, v44
  v_fma_f32 v44, -v42, v42, v44
  v_max_f32 v44, 0, v44
  v_cvt_pk_bf16_f32 v42, v42, v42
  v_mfma_f32_32x32x16_bf16 v[96:111], v[196:199], a[64:67], v[96:111]
  ds_read_b64_tr_b16 v[220:221], v17 offset:10240
  ds_read_b64_tr_b16 v[222:223], v17 offset:10752
  buffer_load_dwordx4 v13, s[52:55], s15 offen offset:3072 lds
  v_lshlrev_b32 v42, 16, v42
  v_cvt_pk_bf16_f32 v44, v44, v44
  v_lshlrev_b32 v44, 16, v44
  v_add_f32 v44, 0x3727c5ac, v44
  v_cvt_pk_bf16_f32 v44, v44, v44
  v_lshlrev_b32 v44, 16, v44
  s_waitcnt lgkmcnt(8)
  v_mfma_f32_32x32x16_bf16 v[80:95], v[200:203], a[64:67], v[80:95]
  ds_read_b64_tr_b16 v[192:193], v16 offset:4096
  ds_read_b64_tr_b16 v[194:195], v16 offset:4608
  v_sqrt_f32 v45, v44
  s_nop 0
  v_cvt_pk_bf16_f32 v45, v45, v45
  v_lshlrev_b32 v45, 16, v45
  v_lshrrev_b32 v42, 16, v42
  v_or_b32 v42, v42, v45
  v_readfirstlane_b32 s6, v55
  s_nop 1
  s_cmp_eq_u32 s6, 0
  s_cbranch_scc1 L_slow_2
L_back_3:
  v_mfma_f32_32x32x16_bf16 v[112:127], v[204:207], a[64:67], v[112:127]
  ds_read_b64_tr_b16 v[196:197], v17 offset:4096
  ds_read_b64_tr_b16 v[198:199], v17 offset:4608
  s_add_u32 s14, s80, 1024
  s_add_u32 m0, s81, 8192
  s_nop 0
  buffer_load_dwordx4 v2, s[48:51], s14 offen offset:0 lds
  v_mov_b32 v43, s6
  v_lshrrev_b32 v40, 5, v1
  v_lshlrev_b32 v40, 3, v40
  v_and_b32 v41, 31, v1
  v_cmp_eq_u32 vcc, 0, v41
  v_mov_b32 v41, 0x40000000
  s_nop 0
  v_cndmask_b32 v40, v41, v40, vcc
  s_lshl_b32 s8, s4, 4
  s_add_u32 s8, s8, s5
  s_lshl_b32 s8, s8, 2
  s_add_u32 s8, s8, s3
  s_lshl_b32 s8, s8, 4
  s_add_u32 s8, s8, 0x1000000
  buffer_store_dwordx2 v[42:43], v40, s[56:59], s8 offen sc1
  s_mov_b32 s60, s40
  s_mov_b32 s61, s41
  s_mov_b32 s62, 0x21c000
  s_mov_b32 s63, 0x20000
  v_lshrrev_b32 v60, 3, v0
  v_and_b32 v61, 7, v0
  v_mul_u32_u24 v33, 1280, v60
  v_lshl_add_u32 v33, v61, 4, v33
  s_waitcnt lgkmcnt(8)
  v_mfma_f32_32x32x16_bf16 v[64:79], v[208:211], a[68:71], v[64:79]
  ds_read_b64_tr_b16 v[200:201], v16 offset:12288
  ds_read_b64_tr_b16 v[202:203], v16 offset:12800
  v_mul_u32_u24 v34, 160, v60
  v_lshl_add_u32 v34, v61, 4, v34
  v_add_u32 v34, 147456, v34
  s_add_u32 s8, s2, 0
  s_mul_i32 s9, s8, 6554
  s_lshr_b32 s9, s9, 16
  s_mul_i32 s10, s9, 10
  s_sub_u32 s10, s8, s10
  s_mul_i32 s11, s9, 40960
  s_lshl_b32 s12, s10, 7
  s_add_u32 s11, s11, s12
  v_mfma_f32_32x32x16_bf16 v[96:111], v[212:215], a[68:71], v[96:111]
  ds_read_b64_tr_b16 v[204:205], v17 offset:12288
  ds_read_b64_tr_b16 v[206:207], v17 offset:12800
  buffer_load_dwordx4 v3, s[48:51], s14 offen offset:1024 lds
  s_mul_i32 s12, s9, 43
  s_lshr_b32 s12, s12, 8
  s_mul_i32 s13, s12, 6
  s_sub_u32 s13, s9, s13
  s_lshl_b32 s7, s12, 2
  s_add_u32 s7, s7, s13
  s_add_u32 s7, s7, 40
  s_cmp_ge_u32 s12, 5
  s_cselect_b32 s9, 7, 0
  s_add_u32 s7, s7, s9
  s_cmp_eq_u32 s12, 4
  s_cselect_b32 s9, 1, 0
  s_cmp_ge_u32 s13, 2
  s_cselect_b32 s9, s9, 0
  s_mul_i32 s9, s9, 25
  s_add_u32 s7, s7, s9
  s_lshl_b32 s9, s12, 1
  s_add_u32 s9, s9, s13
  s_add_u32 s9, s9, 54
  s_cmp_ge_u32 s12, 5
  s_cselect_b32 s12, 17, 0
  s_add_u32 s9, s9, s12
  s_cmp_eq_u32 s9, 67
  s_cselect_b32 s9, 93, s9
  s_cmp_ge_u32 s13, 4
  s_cselect_b32 s12, s9, s7
  s_mul_i32 s12, s12, 40960
  s_lshl_b32 s13, s10, 2
  s_add_u32 s13, s13, s3
  s_lshl_b32 s13, s13, 10
  s_add_u32 s12, s12, s13
  s_cmp_lt_u32 s8, 540
  s_cselect_b32 s11, s11, 0x40000000
  s_cselect_b32 s86, s12, 0x40000000
  buffer_load_dwordx4 a[164:167], v33, s[60:63], s11 offen
  s_add_u32 s8, s2, 256
  s_mul_i32 s9, s8, 6554
  s_lshr_b32 s9, s9, 16
  s_mul_i32 s10, s9, 10
  s_sub_u32 s10, s8, s10
  s_waitcnt lgkmcnt(8)
  v_mfma_f32_32x32x16_bf16 v[80:95], v[216:219], a[68:71], v[80:95]
  ds_read_b64_tr_b16 v[208:209], v16 offset:6144
  ds_read_b64_tr_b16 v[210:211], v16 offset:6656
  s_mul_i32 s11, s9, 40960
  s_lshl_b32 s12, s10, 7
  s_add_u32 s11, s11, s12
  s_mul_i32 s12, s9, 43
  s_lshr_b32 s12, s12, 8
  s_mul_i32 s13, s12, 6
  s_sub_u32 s13, s9, s13
  s_lshl_b32 s7, s12, 2
  s_add_u32 s7, s7, s13
  s_add_u32 s7, s7, 40
  s_cmp_ge_u32 s12, 5
  s_cselect_b32 s9, 7, 0
  s_add_u32 s7, s7, s9
  s_cmp_eq_u32 s12, 4
  s_cselect_b32 s9, 1, 0
  s_cmp_ge_u32 s13, 2
  s_cselect_b32 s9, s9, 0
  s_mul_i32 s9, s9, 25
  s_add_u32 s7, s7, s9
  s_lshl_b32 s9, s12, 1
  s_add_u32 s9, s9, s13
  s_add_u32 s9, s9, 54
  s_cmp_ge_u32 s12, 5
  s_cselect_b32 s12, 17, 0
  s_add_u32 s9, s9, s12
  s_cmp_eq_u32 s9, 67
  s_cselect_b32 s9, 93, s9
  s_cmp_ge_u32 s13, 4
  s_cselect_b32 s12, s9, s7
  s_mul_i32 s12, s12, 40960
  s_lshl_b32 s13, s10, 2
  s_add_u32 s13, s13, s3
  s_lshl_b32 s13, s13, 10
  s_add_u32 s12, s12, s13
  s_cmp_lt_u32 s8, 540
  s_cselect_b32 s11, s11, 0x40000000
  s_cselect_b32 s87, s12, 0x40000000
  buffer_load_dwordx4 a[168:171], v33, s[60:63], s11 offen
  v_mfma_f32_32x32x16_bf16 v[112:127], v[220:223], a[68:71], v[112:127]
  ds_read_b64_tr_b16 v[212:213], v17 offset:6144
  ds_read_b64_tr_b16 v[214:215], v17 offset:6656
  buffer_load_dwordx4 v4, s[48:51], s14 offen offset:2048 lds
  s_add_u32 s8, s2, 512
  s_mul_i32 s9, s8, 6554
  s_lshr_b32 s9, s9, 16
  s_mul_i32 s10, s9, 10
  s_sub_u32 s10, s8, s10
  s_mul_i32 s11, s9, 40960
  s_lshl_b32 s12, s10, 7
  s_add_u32 s11, s11, s12
  s_mul_i32 s12, s9, 43
  s_lshr_b32 s12, s12, 8
  s_mul_i32 s13, s12, 6
  s_sub_u32 s13, s9, s13
  s_lshl_b32 s7, s12, 2
  s_add_u32 s7, s7, s13
  s_add_u32 s7, s7, 40
  s_cmp_ge_u32 s12, 5
  s_cselect_b32 s9, 7, 0
  s_add_u32 s7, s7, s9
  s_cmp_eq_u32 s12, 4
  s_cselect_b32 s9, 1, 0
  s_cmp_ge_u32 s13, 2
  s_cselect_b32 s9, s9, 0
  s_mul_i32 s9, s9, 25
  s_add_u32 s7, s7, s9
  s_lshl_b32 s9, s12, 1
  s_add_u32 s9, s9, s13
  s_add_u32 s9, s9, 54
  s_cmp_ge_u32 s12, 5
  s_cselect_b32 s12, 17, 0
  s_add_u32 s9, s9, s12
  s_cmp_eq_u32 s9, 67
  s_cselect_b32 s9, 93, s9
  s_cmp_ge_u32 s13, 4
  s_cselect_b32 s12, s9, s7
  s_mul_i32 s12, s12, 40960
  s_waitcnt lgkmcnt(8)
  v_mfma_f32_32x32x16_bf16 v[64:79], v[192:195], a[72:75], v[64:79]
  ds_read_b64_tr_b16 v[216:217], v16 offset:14336
  ds_read_b64_tr_b16 v[218:219], v16 offset:14848
  s_lshl_b32 s13, s10, 2
  s_add_u32 s13, s13, s3
  s_lshl_b32 s13, s13, 10
  s_add_u32 s12, s12, s13
  s_cmp_lt_u32 s8, 540
  s_cselect_b32 s11, s11, 0x40000000
  s_cselect_b32 s88, s12, 0x40000000
  buffer_load_dwordx4 a[172:175], v33, s[60:63], s11 offen
  s_mov_b32 s60, s26
  s_mov_b32 s61, s27
  s_mov_b32 s62, 0xc8000
  s_mov_b32 s63, 0x20000
  s_mov_b32 s64, s28
  s_mov_b32 s65, s29
  s_mov_b32 s66, 0xc8000
  s_mov_b32 s67, 0x20000
  v_and_b32 v60, 15, v1
  v_lshrrev_b32 v61, 4, v1
  v_mfma_f32_32x32x16_bf16 v[96:111], v[196:199], a[72:75], v[96:111]
  ds_read_b64_tr_b16 v[220:221], v17 offset:14336
  ds_read_b64_tr_b16 v[222:223], v17 offset:14848
  buffer_load_dwordx4 v5, s[48:51], s14 offen offset:3072 lds
  v_mul_u32_u24 v35, 1280, v60
  v_lshl_add_u32 v35, v61, 3, v35
  v_lshlrev_b32 v36, 4, v1
  s_lshl_b32 s8, s2, 2
  s_add_u32 s8, s8, s3
  s_add_u32 s8, s8, 0
  s_mul_i32 s9, s8, 1639
  s_lshr_b32 s9, s9, 16
  s_mul_i32 s10, s9, 40
  s_sub_u32 s10, s8, s10
  s_mul_i32 s11, s9, 20480
  s_lshl_b32 s12, s10, 5
  s_add_u32 s11, s11, s12
  s_mul_i32 s12, s10, 40960
  s_lshl_b32 s13, s9, 10
  s_add_u32 s12, s12, s13
  s_waitcnt lgkmcnt(8)
  v_mfma_f32_32x32x16_bf16 v[80:95], v[200:203], a[72:75], v[80:95]
  s_cmp_lt_u32 s8, 1600
  s_cselect_b32 s11, s11, 0x40000000
  s_cselect_b32 s89, s12, 0x40000000
  buffer_load_dwordx2 v[140:141], v35, s[60:63], s11 offen
  buffer_load_dwordx2 v[144:145], v35, s[64:67], s11 offen
  s_lshl_b32 s8, s2, 2
  s_add_u32 s8, s8, s3
  s_add_u32 s8, s8, 1024
  s_mul_i32 s9, s8, 1639
  s_lshr_b32 s9, s9, 16
  s_mul_i32 s10, s9, 40
  s_sub_u32 s10, s8, s10
  s_mul_i32 s11, s9, 20480
  s_lshl_b32 s12, s10, 5
  s_add_u32 s11, s11, s12
  s_mul_i32 s12, s10, 40960
  s_lshl_b32 s13, s9, 10
  s_add_u32 s12, s12, s13
  s_cmp_lt_u32 s8, 1600
  s_cselect_b32 s11, s11, 0x40000000
  s_cselect_b32 s90, s12, 0x40000000
  buffer_load_dwordx2 v[142:143], v35, s[60:63], s11 offen
  buffer_load_dwordx2 v[146:147], v35, s[64:67], s11 offen
  s_barrier
  ds_read_b64_tr_b16 v[192:193], v16 offset:16384
  ds_read_b64_tr_b16 v[194:195], v16 offset:16896
  s_add_u32 s15, s83, 1990656
  s_add_u32 m0, s82, 49152
  s_nop 0
  buffer_load_dwordx4 v10, s[52:55], s15 offen offset:0 lds
  s_waitcnt vmcnt(24)
  v_mfma_f32_32x32x16_bf16 v[112:127], v[204:207], a[72:75], v[112:127]
  ds_read_b64_tr_b16 v[196:197], v17 offset:16384
  ds_read_b64_tr_b16 v[198:199], v17 offset:16896
  s_waitcnt lgkmcnt(8)
  v_mfma_f32_32x32x16_bf16 v[64:79], v[208:211], a[76:79], v[64:79]
  ds_read_b64_tr_b16 v[200:201], v16 offset:24576
  ds_read_b64_tr_b16 v[202:203], v16 offset:25088
  v_mfma_f32_32x32x16_bf16 v[96:111], v[212:215], a[76:79], v[96:111]
  ds_read_b64_tr_b16 v[204:205], v17 offset:24576
  ds_read_b64_tr_b16 v[206:207], v17 offset:25088
  buffer_load_dwordx4 v11, s[52:55], s15 offen offset:1024 lds
  ds_read_b128 a[96:99], v6 offset:0
  s_waitcnt lgkmcnt(9)
  v_mfma_f32_32x32x16_bf16 v[80:95], v[216:219], a[76:79], v[80:95]
  ds_read_b64_tr_b16 v[208:209], v16 offset:18432
  ds_read_b64_tr_b16 v[210:211], v16 offset:18944
  v_mfma_f32_32x32x16_bf16 v[112:127], v[220:223], a[76:79], v[112:127]
  ds_read_b64_tr_b16 v[212:213], v17 offset:18432
  ds_read_b64_tr_b16 v[214:215], v17 offset:18944
  buffer_load_dwordx4 v12, s[52:55], s15 offen offset:2048 lds
  s_waitcnt lgkmcnt(9)
  v_mfma_f32_32x32x16_bf16 v[64:79], v[192:195], a[80:83], v[64:79]
  ds_read_b64_tr_b16 v[216:217], v16 offset:26624
  ds_read_b64_tr_b16 v[218:219], v16 offset:27136
  ds_read_b128 a[100:103], v7 offset:0
  v_mfma_f32_32x32x16_bf16 v[96:111], v[196:199], a[80:83], v[96:111]
  ds_read_b64_tr_b16 v[220:221], v17 offset:26624
  ds_read_b64_tr_b16 v[222:223], v17 offset:27136
  buffer_load_dwordx4 v13, s[52:55], s15 offen offset:3072 lds
  s_waitcnt lgkmcnt(10)
  v_mfma_f32_32x32x16_bf16 v[80:95], v[200:203], a[80:83], v[80:95]
  ds_read_b64_tr_b16 v[192:193], v16 offset:20480
  ds_read_b64_tr_b16 v[194:195], v16 offset:20992
  v_mfma_f32_32x32x16_bf16 v[112:127], v[204:207], a[80:83], v[112:127]
  ds_read_b64_tr_b16 v[196:197], v17 offset:20480
  ds_read_b64_tr_b16 v[198:199], v17 offset:20992
  s_waitcnt lgkmcnt(6)
  s_add_u32 s14, s80, 1152
  s_add_u32 m0, s81, 0
  s_nop 0
  buffer_load_dwordx4 v2, s[48:51], s14 offen offset:0 lds
  v_mfma_f32_32x32x16_bf16 v[64:79], v[208:211], a[84:87], v[64:79]
  ds_read_b64_tr_b16 v[200:201], v16 offset:28672
  ds_read_b64_tr_b16 v[202:203], v16 offset:29184
  ds_read_b128 a[104:107], v8 offset:0
  v_mfma_f32_32x32x16_bf16 v[96:111], v[212:215], a[84:87], v[96:111]
  ds_read_b64_tr_b16 v[204:205], v17 offset:28672
  ds_read_b64_tr_b16 v[206:207], v17 offset:29184
  buffer_load_dwordx4 v3, s[48:51], s14 offen offset:1024 lds
  s_waitcnt lgkmcnt(9)
  v_mfma_f32_32x32x16_bf16 v[80:95], v[216:219], a[84:87], v[80:95]
  ds_read_b64_tr_b16 v[208:209], v16 offset:22528
  ds_read_b64_tr_b16 v[210:211], v16 offset:23040
  v_mfma_f32_32x32x16_bf16 v[112:127], v[220:223], a[84:87], v[112:127]
  ds_read_b64_tr_b16 v[212:213], v17 offset:22528
  ds_read_b64_tr_b16 v[214:215], v17 offset:23040
  buffer_load_dwordx4 v4, s[48:51], s14 offen offset:2048 lds
  ds_read_b128 a[108:111], v9 offset:0
  s_waitcnt lgkmcnt(10)
  v_mfma_f32_32x32x16_bf16 v[64:79], v[192:195], a[88:91], v[64:79]
  ds_read_b64_tr_b16 v[216:217], v16 offset:30720
  ds_read_b64_tr_b16 v[218:219], v16 offset:31232
  v_mfma_f32_32x32x16_bf16 v[96:111], v[196:199], a[88:91], v[96:111]
  ds_read_b64_tr_b16 v[220:221], v17 offset:30720
  ds_read_b64_tr_b16 v[222:223], v17 offset:31232
  buffer_load_dwordx4 v5, s[48:51], s14 offen offset:3072 lds
  s_waitcnt lgkmcnt(9)
  v_mfma_f32_32x32x16_bf16 v[80:95], v[200:203], a[88:91], v[80:95]
  s_barrier
  ds_read_b64_tr_b16 v[192:193], v14 offset:0
  ds_read_b64_tr_b16 v[194:195], v14 offset:512
  s_add_u32 s15, s84, 0
  s_add_u32 m0, s82, 65536
  s_nop 0
  buffer_load_dwordx4 v10, s[52:55], s15 offen offset:0 lds
  s_waitcnt vmcnt(24)
  v_mfma_f32_32x32x16_bf16 v[112:127], v[204:207], a[88:91], v[112:127]
  ds_read_b64_tr_b16 v[196:197], v15 offset:0
  ds_read_b64_tr_b16 v[198:199], v15 offset:512
  s_waitcnt lgkmcnt(9)
  v_mfma_f32_32x32x16_bf16 v[64:79], v[208:211], a[92:95], v[64:79]
  ds_read_b64_tr_b16 v[200:201], v14 offset:8192
  ds_read_b64_tr_b16 v[202:203], v14 offset:8704
  v_mfma_f32_32x32x16_bf16 v[96:111], v[212:215], a[92:95], v[96:111]
  ds_read_b64_tr_b16 v[204:205], v15 offset:8192
  ds_read_b64_tr_b16 v[206:207], v15 offset:8704
  ds_read_b128 a[112:115], v6 offset:4096
  s_waitcnt lgkmcnt(9)
  v_mfma_f32_32x32x16_bf16 v[80:95], v[216:219], a[92:95], v[80:95]
  ds_read_b64_tr_b16 v[208:209], v14 offset:2048
  ds_read_b64_tr_b16 v[210:211], v14 offset:2560
  v_mfma_f32_32x32x16_bf16 v[112:127], v[220:223], a[92:95], v[112:127]
  ds_read_b64_tr_b16 v[212:213], v15 offset:2048
  ds_read_b64_tr_b16 v[214:215], v15 offset:2560
  buffer_load_dwordx4 v11, s[52:55], s15 offen offset:1024 lds
  s_waitcnt lgkmcnt(9)
  v_mfma_f32_32x32x16_bf16 v[64:79], v[192:195], a[96:99], v[64:79]
  ds_read_b64_tr_b16 v[216:217], v14 offset:10240
  ds_read_b64_tr_b16 v[218:219], v14 offset:10752
  ds_read_b128 a[116:119], v7 offset:4096
  v_mfma_f32_32x32x16_bf16 v[96:111], v[196:199], a[96:99], v[96:111]
  ds_read_b64_tr_b16 v[220:221], v15 offset:10240
  ds_read_b64_tr_b16 v[222:223], v15 offset:10752
  s_waitcnt lgkmcnt(10)
  v_mfma_f32_32x32x16_bf16 v[80:95], v[200:203], a[96:99], v[80:95]
  ds_read_b64_tr_b16 v[192:193], v14 offset:4096
  ds_read_b64_tr_b16 v[194:195], v14 offset:4608
  v_mfma_f32_32x32x16_bf16 v[112:127], v[204:207], a[96:99], v[112:127]
  ds_read_b64_tr_b16 v[196:197], v15 offset:4096
  ds_read_b64_tr_b16 v[198:199], v15 offset:4608
  buffer_load_dwordx4 v12, s[52:55], s15 offen offset:2048 lds
  s_waitcnt lgkmcnt(9)
  v_mfma_f32_32x32x16_bf16 v[64:79], v[208:211], a[100:103], v[64:79]
  ds_read_b64_tr_b16 v[200:201], v14 offset:12288
  ds_read_b64_tr_b16 v[202:203], v14 offset:12800
  ds_read_b128 a[120:123], v8 offset:4096
  v_mfma_f32_32x32x16_bf16 v[96:111], v[212:215], a[100:103], v[96:111]
  ds_read_b64_tr_b16 v[204:205], v15 offset:12288
  ds_read_b64_tr_b16 v[206:207], v15 offset:12800
  s_waitcnt lgkmcnt(9)
  v_mfma_f32_32x32x16_bf16 v[80:95], v[216:219], a[100:103], v[80:95]
  ds_read_b64_tr_b16 v[208:209], v14 offset:6144
  ds_read_b64_tr_b16 v[210:211], v14 offset:6656
  v_mfma_f32_32x32x16_bf16 v[112:127], v[220:223], a[100:103], v[112:127]
  ds_read_b64_tr_b16 v[212:213], v15 offset:6144
  ds_read_b64_tr_b16 v[214:215], v15 offset:6656
  buffer_load_dwordx4 v13, s[52:55], s15 offen offset:3072 lds
  ds_read_b128 a[124:127], v9 offset:4096
  s_waitcnt lgkmcnt(10)
  v_mfma_f32_32x32x16_bf16 v[64:79], v[192:195], a[104:107], v[64:79]
  ds_read_b64_tr_b16 v[216:217], v14 offset:14336
  ds_read_b64_tr_b16 v[218:219], v14 offset:14848
  v_mfma_f32_32x32x16_bf16 v[96:111], v[196:199], a[104:107], v[96:111]
  ds_read_b64_tr_b16 v[220:221], v15 offset:14336
  ds_read_b64_tr_b16 v[222:223], v15 offset:14848
  s_waitcnt lgkmcnt(9)
  v_mfma_f32_32x32x16_bf16 v[80:95], v[200:203], a[104:107], v[80:95]
  s_barrier
  ds_read_b64_tr_b16 v[192:193], v14 offset:16384
  ds_read_b64_tr_b16 v[194:195], v14 offset:16896
  s_add_u32 s15, s84, 221184
  s_add_u32 m0, s82, 81920
  s_nop 0
  buffer_load_dwordx4 v10, s[52:55], s15 offen offset:0 lds
  s_waitcnt vmcnt(17)
  v_mfma_f32_32x32x16_bf16 v[112:127], v[204:207], a[104:107], v[112:127]
  ds_read_b64_tr_b16 v[196:197], v15 offset:16384
  ds_read_b64_tr_b16 v[198:199], v15 offset:16896
  s_waitcnt lgkmcnt(9)
  v_mfma_f32_32x32x16_bf16 v[64:79], v[208:211], a[108:111], v[64:79]
  ds_read_b64_tr_b16 v[200:201], v14 offset:24576
  ds_read_b64_tr_b16 v[202:203], v14 offset:25088
  v_mfma_f32_32x32x16_bf16 v[96:111], v[212:215], a[108:111], v[96:111]
  ds_read_b64_tr_b16 v[204:205], v15 offset:24576
  ds_read_b64_tr_b16 v[206:207], v15 offset:25088
  ds_read_b128 a[128:131], v6 offset:8192
  s_waitcnt lgkmcnt(9)
  v_mfma_f32_32x32x16_bf16 v[80:95], v[216:219], a[108:111], v[80:95]
  ds_read_b64_tr_b16 v[208:209], v14 offset:18432
  ds_read_b64_tr_b16 v[210:211], v14 offset:18944
  v_mfma_f32_32x32x16_bf16 v[112:127], v[220:223], a[108:111], v[112:127]
  ds_read_b64_tr_b16 v[212:213], v15 offset:18432
  ds_read_b64_tr_b16 v[214:215], v15 offset:18944
  buffer_load_dwordx4 v11, s[52:55], s15 offen offset:1024 lds
  s_waitcnt lgkmcnt(9)
  v_mfma_f32_32x32x16_bf16 v[64:79], v[192:195], a[112:115], v[64:79]
  ds_read_b64_tr_b16 v[216:217], v14 offset:26624
  ds_read_b64_tr_b16 v[218:219], v14 offset:27136
  ds_read_b128 a[132:135], v7 offset:8192
  v_mfma_f32_32x32x16_bf16 v[96:111], v[196:199], a[112:115], v[96:111]
  ds_read_b64_tr_b16 v[220:221], v15 offset:26624
  ds_read_b64_tr_b16 v[222:223], v15 offset:27136
  s_waitcnt lgkmcnt(10)
  v_mfma_f32_32x32x16_bf16 v[80:95], v[200:203], a[112:115], v[80:95]
  ds_read_b64_tr_b16 v[192:193], v14 offset:20480
  ds_read_b64_tr_b16 v[194:195], v14 offset:20992
  v_mfma_f32_32x32x16_bf16 v[112:127], v[204:207], a[112:115], v[112:127]
  ds_read_b64_tr_b16 v[196:197], v15 offset:20480
  ds_read_b64_tr_b16 v[198:199], v15 offset:20992
  buffer_load_dwordx4 v12, s[52:55], s15 offen offset:2048 lds
  s_waitcnt lgkmcnt(9)
  v_mfma_f32_32x32x16_bf16 v[64:79], v[208:211], a[116:119], v[64:79]
  ds_read_b64_tr_b16 v[200:201], v14 offset:28672
  ds_read_b64_tr_b16 v[202:203], v14 offset:29184
  ds_read_b128 a[136:139], v8 offset:8192
  v_mfma_f32_32x32x16_bf16 v[96:111], v[212:215], a[116:119], v[96:111]
  ds_read_b64_tr_b16 v[204:205], v15 offset:28672
  ds_read_b64_tr_b16 v[206:207], v15 offset:29184
  s_waitcnt lgkmcnt(9)
  v_mfma_f32_32x32x16_bf16 v[80:95], v[216:219], a[116:119], v[80:95]
  ds_read_b64_tr_b16 v[208:209], v14 offset:22528
  ds_read_b64_tr_b16 v[210:211], v14 offset:23040
  v_mfma_f32_32x32x16_bf16 v[112:127], v[220:223], a[116:119], v[112:127]
  ds_read_b64_tr_b16 v[212:213], v15 offset:22528
  ds_read_b64_tr_b16 v[214:215], v15 offset:23040
  buffer_load_dwordx4 v13, s[52:55], s15 offen offset:3072 lds
  ds_read_b128 a[140:143], v9 offset:8192
  s_waitcnt lgkmcnt(10)
  v_mfma_f32_32x32x16_bf16 v[64:79], v[192:195], a[120:123], v[64:79]
  ds_read_b64_tr_b16 v[216:217], v14 offset:30720
  ds_read_b64_tr_b16 v[218:219], v14 offset:31232
  v_mfma_f32_32x32x16_bf16 v[96:111], v[196:199], a[120:123], v[96:111]
  ds_read_b64_tr_b16 v[220:221], v15 offset:30720
  ds_read_b64_tr_b16 v[222:223], v15 offset:31232
  s_waitcnt lgkmcnt(9)
  v_mfma_f32_32x32x16_bf16 v[80:95], v[200:203], a[120:123], v[80:95]
  s_barrier
  ds_read_b64_tr_b16 v[192:193], v14 offset:32768
  ds_read_b64_tr_b16 v[194:195], v14 offset:33280
  s_add_u32 s15, s84, 442368
  s_add_u32 m0, s82, 0
  s_nop 0
  buffer_load_dwordx4 v10, s[52:55], s15 offen offset:0 lds
  s_waitcnt vmcnt(9)
  v_mfma_f32_32x32x16_bf16 v[112:127], v[204:207], a[120:123], v[112:127]
  ds_read_b64_tr_b16 v[196:197], v15 offset:32768
  ds_read_b64_tr_b16 v[198:199], v15 offset:33280
  ds_read_b128 a[144:147], v6 offset:0
  s_waitcnt lgkmcnt(10)
  v_mfma_f32_32x32x16_bf16 v[64:79], v[208:211], a[124:127], v[64:79]
  ds_read_b64_tr_b16 v[200:201], v14 offset:40960
  ds_read_b64_tr_b16 v[202:203], v14 offset:41472
  v_mfma_f32_32x32x16_bf16 v[96:111], v[212:215], a[124:127], v[96:111]
  ds_read_b64_tr_b16 v[204:205], v15 offset:40960
  ds_read_b64_tr_b16 v[206:207], v15 offset:41472
  ds_read_b128 a[148:151], v7 offset:0
  s_waitcnt lgkmcnt(10)
  v_mfma_f32_32x32x16_bf16 v[80:95], v[216:219], a[124:127], v[80:95]
  ds_read_b64_tr_b16 v[208:209], v14 offset:34816
  ds_read_b64_tr_b16 v[210:211], v14 offset:35328
  v_mfma_f32_32x32x16_bf16 v[112:127], v[220:223], a[124:127], v[112:127]
  ds_read_b64_tr_b16 v[212:213], v15 offset:34816
  ds_read_b64_tr_b16 v[214:215], v15 offset:35328
  buffer_load_dwordx4 v11, s[52:55], s15 offen offset:1024 lds
  ds_read_b128 a[152:155], v8 offset:0
  s_waitcnt lgkmcnt(11)
  v_mfma_f32_32x32x16_bf16 v[64:79], v[192:195], a[128:131], v[64:79]
  ds_read_b64_tr_b16 v[216:217], v14 offset:43008
  ds_read_b64_tr_b16 v[218:219], v14 offset:43520
  v_mfma_f32_32x32x16_bf16 v[96:111], v[196:199], a[128:131], v[96:111]
  ds_read_b64_tr_b16 v[220:221], v15 offset:43008
  ds_read_b64_tr_b16 v[222:223], v15 offset:43520
  ds_read_b128 a[156:159], v9 offset:0
  s_waitcnt lgkmcnt(11)
  v_mfma_f32_32x32x16_bf16 v[80:95], v[200:203], a[128:131], v[80:95]
  ds_read_b64_tr_b16 v[192:193], v14 offset:36864
  ds_read_b64_tr_b16 v[194:195], v14 offset:37376
  v_mfma_f32_32x32x16_bf16 v[112:127], v[204:207], a[128:131], v[112:127]
  ds_read_b64_tr_b16 v[196:197], v15 offset:36864
  ds_read_b64_tr_b16 v[198:199], v15 offset:37376
  buffer_load_dwordx4 v12, s[52:55], s15 offen offset:2048 lds
  v_lshlrev_b32 v42, 3, v1
  s_waitcnt lgkmcnt(10)
  v_mfma_f32_32x32x16_bf16 v[64:79], v[208:211], a[132:135], v[64:79]
  ds_read_b64_tr_b16 v[200:201], v14 offset:45056
  ds_read_b64_tr_b16 v[202:203], v14 offset:45568
  v_mfma_f32_32x32x16_bf16 v[96:111], v[212:215], a[132:135], v[96:111]
  ds_read_b64_tr_b16 v[204:205], v15 offset:45056
  ds_read_b64_tr_b16 v[206:207], v15 offset:45568
  s_mul_i32 s8, s91, 1024
  s_add_u32 s8, s8, 0x1050000
  s_add_u32 s9, s8, 27648
  buffer_load_dwordx2 v[224:225], v42, s[56:59], s8 offen offset:0 sc1
  buffer_load_dwordx2 v[226:227], v42, s[56:59], s8 offen offset:512 sc1
  buffer_load_dwordx2 v[228:229], v42, s[56:59], s9 offen offset:0 sc1
  buffer_load_dwordx2 v[230:231], v42, s[56:59], s9 offen offset:512 sc1
  s_waitcnt lgkmcnt(9)
  v_mfma_f32_32x32x16_bf16 v[80:95], v[216:219], a[132:135], v[80:95]
  ds_read_b64_tr_b16 v[208:209], v14 offset:38912
  ds_read_b64_tr_b16 v[210:211], v14 offset:39424
  v_mfma_f32_32x32x16_bf16 v[112:127], v[220:223], a[132:135], v[112:127]
  ds_read_b64_tr_b16 v[212:213], v15 offset:38912
  ds_read_b64_tr_b16 v[214:215], v15 offset:39424
  buffer_load_dwordx4 v13, s[52:55], s15 offen offset:3072 lds
  v_lshlrev_b32 v37, 3, v57
  s_waitcnt lgkmcnt(8)
  v_mfma_f32_32x32x16_bf16 v[64:79], v[192:195], a[136:139], v[64:79]
  ds_read_b64_tr_b16 v[216:217], v14 offset:47104
  ds_read_b64_tr_b16 v[218:219], v14 offset:47616
  v_mfma_f32_32x32x16_bf16 v[96:111], v[196:199], a[136:139], v[96:111]
  ds_read_b64_tr_b16 v[220:221], v15 offset:47104
  ds_read_b64_tr_b16 v[222:223], v15 offset:47616
  s_lshl_b32 s8, s4, 2
  s_add_u32 s8, s8, s3
  s_lshl_b32 s8, s8, 8
  s_add_u32 s8, s8, 0x1000000
  buffer_load_dwordx2 v[38:39], v37, s[56:59], s8 offen sc1
  s_waitcnt lgkmcnt(8)
  v_mfma_f32_32x32x16_bf16 v[80:95], v[200:203], a[136:139], v[80:95]
  s_barrier
  ds_read_b64_tr_b16 v[192:193], v14 offset:49152
  ds_read_b64_tr_b16 v[194:195], v14 offset:49664
  s_add_u32 s15, s84, 663552
  s_add_u32 m0, s82, 16384
  s_nop 0
  buffer_load_dwordx4 v10, s[52:55], s15 offen offset:0 lds
  v_mfma_f32_32x32x16_bf16 v[112:127], v[204:207], a[136:139], v[112:127]
  ds_read_b64_tr_b16 v[196:197], v15 offset:49152
  ds_read_b64_tr_b16 v[198:199], v15 offset:49664
  ds_write_b128 v34, a[164:167] offset:0
  s_waitcnt lgkmcnt(9)
  v_mfma_f32_32x32x16_bf16 v[64:79], v[208:211], a[140:143], v[64:79]
  ds_read_b64_tr_b16 v[200:201], v14 offset:57344
  ds_read_b64_tr_b16 v[202:203], v14 offset:57856
  ds_write_b128 v34, a[168:171] offset:5120
  v_mfma_f32_32x32x16_bf16 v[96:111], v[212:215], a[140:143], v[96:111]
  ds_read_b64_tr_b16 v[204:205], v15 offset:57344
  ds_read_b64_tr_b16 v[206:207], v15 offset:57856
  ds_write_b128 v34, a[172:175] offset:10240
  s_waitcnt lgkmcnt(11)
  v_mfma_f32_32x32x16_bf16 v[80:95], v[216:219], a[140:143], v[80:95]
  ds_read_b64_tr_b16 v[208:209], v14 offset:51200
  ds_read_b64_tr_b16 v[210:211], v14 offset:51712
  v_mfma_f32_32x32x16_bf16 v[112:127], v[220:223], a[140:143], v[112:127]
  ds_read_b64_tr_b16 v[212:213], v15 offset:51200
  ds_read_b64_tr_b16 v[214:215], v15 offset:51712
  buffer_load_dwordx4 v11, s[52:55], s15 offen offset:1024 lds
  s_waitcnt lgkmcnt(11)
  v_mfma_f32_32x32x16_bf16 v[64:79], v[192:195], a[144:147], v[64:79]
  ds_read_b64_tr_b16 v[216:217], v14 offset:59392
  ds_read_b64_tr_b16 v[218:219], v14 offset:59904
  v_xor_b32 v144, 0x80008000, v144
  v_mfma_f32_32x32x16_bf16 v[96:111], v[196:199], a[144:147], v[96:111]
  ds_read_b64_tr_b16 v[220:221], v15 offset:59392
  ds_read_b64_tr_b16 v[222:223], v15 offset:59904
  v_xor_b32 v145, 0x80008000, v145
  s_waitcnt lgkmcnt(9)
  v_mfma_f32_32x32x16_bf16 v[80:95], v[200:203], a[144:147], v[80:95]
  ds_read_b64_tr_b16 v[192:193], v14 offset:53248
  ds_read_b64_tr_b16 v[194:195], v14 offset:53760
  v_mfma_f32_32x32x16_bf16 v[112:127], v[204:207], a[144:147], v[112:127]
  ds_read_b64_tr_b16 v[196:197], v15 offset:53248
  ds_read_b64_tr_b16 v[198:199], v15 offset:53760
  buffer_load_dwordx4 v12, s[52:55], s15 offen offset:2048 lds
  s_mov_b32 s8, 0x05040100
  s_mov_b32 s9, 0x07060302
  v_perm_b32 v180, v144, v140, s8
  v_perm_b32 v181, v144, v140, s9
  v_perm_b32 v182, v145, v141, s8
  v_perm_b32 v183, v145, v141, s9
  s_waitcnt lgkmcnt(8)
  v_mfma_f32_32x32x16_bf16 v[64:79], v[208:211], a[148:151], v[64:79]
  ds_read_b64_tr_b16 v[200:201], v14 offset:61440
  ds_read_b64_tr_b16 v[202:203], v14 offset:61952
  buffer_store_dwordx4 v[180:183], v36, s[56:59], s89 offen sc1
  v_mfma_f32_32x32x16_bf16 v[96:111], v[212:215], a[148:151], v[96:111]
  ds_read_b64_tr_b16 v[204:205], v15 offset:61440
  ds_read_b64_tr_b16 v[206:207], v15 offset:61952
  v_xor_b32 v146, 0x80008000, v146
  s_waitcnt lgkmcnt(8)
  v_mfma_f32_32x32x16_bf16 v[80:95], v[216:219], a[148:151], v[80:95]
  ds_read_b64_tr_b16 v[208:209], v14 offset:55296
  ds_read_b64_tr_b16 v[210:211], v14 offset:55808
  v_mfma_f32_32x32x16_bf16 v[112:127], v[220:223], a[148:151], v[112:127]
  ds_read_b64_tr_b16 v[212:213], v15 offset:55296
  ds_read_b64_tr_b16 v[214:215], v15 offset:55808
  buffer_load_dwordx4 v13, s[52:55], s15 offen offset:3072 lds
  v_xor_b32 v147, 0x80008000, v147
  s_waitcnt lgkmcnt(8)
  v_mfma_f32_32x32x16_bf16 v[64:79], v[192:195], a[152:155], v[64:79]
  ds_read_b64_tr_b16 v[216:217], v14 offset:63488
  ds_read_b64_tr_b16 v[218:219], v14 offset:64000
  s_mov_b32 s8, 0x05040100
  s_mov_b32 s9, 0x07060302
  v_perm_b32 v184, v146, v142, s8
  v_perm_b32 v185, v146, v142, s9
  v_perm_b32 v186, v147, v143, s8
  v_perm_b32 v187, v147, v143, s9
  v_mfma_f32_32x32x16_bf16 v[96:111], v[196:199], a[152:155], v[96:111]
  ds_read_b64_tr_b16 v[220:221], v15 offset:63488
  ds_read_b64_tr_b16 v[222:223], v15 offset:64000
  buffer_store_dwordx4 v[184:187], v36, s[56:59], s90 offen sc1
  s_waitcnt lgkmcnt(8)
  v_mfma_f32_32x32x16_bf16 v[80:95], v[200:203], a[152:155], v[80:95]
  s_waitcnt vmcnt(17)
  s_barrier
  ds_read_b64_tr_b16 v[192:193], v16 offset:0
  ds_read_b64_tr_b16 v[194:195], v16 offset:512
  s_add_u32 s15, s84, 884736
  s_add_u32 m0, s82, 32768
  s_nop 0
  buffer_load_dwordx4 v10, s[52:55], s15 offen offset:0 lds
  v_lshrrev_b32 v60, 4, v1
  v_and_b32 v61, 15, v1
  v_mfma_f32_32x32x16_bf16 v[112:127], v[204:207], a[152:155], v[112:127]
  ds_read_b64_tr_b16 v[196:197], v17 offset:0
  ds_read_b64_tr_b16 v[198:199], v17 offset:512
  v_lshrrev_b32 v62, 1, v60
  s_waitcnt lgkmcnt(8)
  v_mfma_f32_32x32x16_bf16 v[64:79], v[208:211], a[156:159], v[64:79]
  ds_read_b64_tr_b16 v[200:201], v16 offset:8192
  ds_read_b64_tr_b16 v[202:203], v16 offset:8704
  v_lshlrev_b32 v62, 4, v62
  v_mfma_f32_32x32x16_bf16 v[96:111], v[212:215], a[156:159], v[96:111]
  ds_read_b64_tr_b16 v[204:205], v17 offset:8192
  ds_read_b64_tr_b16 v[206:207], v17 offset:8704
  v_and_b32 v60, 1, v60
  v_lshl_add_u32 v62, v60, 2, v62
  s_waitcnt lgkmcnt(8)
  v_mfma_f32_32x32x16_bf16 v[80:95], v[216:219], a[156:159], v[80:95]
  ds_read_b64_tr_b16 v[208:209], v16 offset:2048
  ds_read_b64_tr_b16 v[210:211], v16 offset:2560
  v_lshrrev_b32 v60, 2, v61
  v_mfma_f32_32x32x16_bf16 v[112:127], v[220:223], a[156:159], v[112:127]
  ds_read_b64_tr_b16 v[212:213], v17 offset:2048
  ds_read_b64_tr_b16 v[214:215], v17 offset:2560
  buffer_load_dwordx4 v11, s[52:55], s15 offen offset:1024 lds
  v_add_u32 v62, v62, v60
  s_waitcnt lgkmcnt(8)
  v_mfma_f32_32x32x16_bf16 v[128:143], v[192:195], a[0:3], 0
  ds_read_b64_tr_b16 v[216:217], v16 offset:10240
  ds_read_b64_tr_b16 v[218:219], v16 offset:10752
  v_mul_u32_u24 v62, 160, v62
  v_and_b32 v61, 3, v61
  v_mfma_f32_32x32x16_bf16 v[160:175], v[196:199], a[0:3], 0
  ds_read_b64_tr_b16 v[220:221], v17 offset:10240
  ds_read_b64_tr_b16 v[222:223], v17 offset:10752
  v_lshl_add_u32 v62, v61, 3, v62
  s_waitcnt lgkmcnt(8)
  v_mfma_f32_32x32x16_bf16 v[144:159], v[200:203], a[0:3], 0
  ds_read_b64_tr_b16 v[192:193], v16 offset:4096
  ds_read_b64_tr_b16 v[194:195], v16 offset:4608
  s_lshl_b32 s8, s3, 5
  s_add_u32 s8, s8, 147456
  v_add_u32 v62, s8, v62
  v_mfma_f32_32x32x16_bf16 v[176:191], v[204:207], a[0:3], 0
  ds_read_b64_tr_b16 v[196:197], v17 offset:4096
  ds_read_b64_tr_b16 v[198:199], v17 offset:4608
  buffer_load_dwordx4 v12, s[52:55], s15 offen offset:2048 lds
  ds_read_b64_tr_b16 a[176:177], v62 offset:0
  s_waitcnt lgkmcnt(9)
  v_mfma_f32_32x32x16_bf16 v[128:143], v[208:211], a[4:7], v[128:143]
  ds_read_b64_tr_b16 v[200:201], v16 offset:12288
  ds_read_b64_tr_b16 v[202:203], v16 offset:12800
  ds_read_b64_tr_b16 a[178:179], v62 offset:1280
  ds_read_b64_tr_b16 a[180:181], v62 offset:5120
  v_mfma_f32_32x32x16_bf16 v[160:175], v[212:215], a[4:7], v[160:175]
  ds_read_b64_tr_b16 v[204:205], v17 offset:12288
  ds_read_b64_tr_b16 v[206:207], v17 offset:12800
  ds_read_b64_tr_b16 a[182:183], v62 offset:6400
  s_waitcnt lgkmcnt(12)
  v_mfma_f32_32x32x16_bf16 v[144:159], v[216:219], a[4:7], v[144:159]
  ds_read_b64_tr_b16 v[208:209], v16 offset:6144
  ds_read_b64_tr_b16 v[210:211], v16 offset:6656
  ds_read_b64_tr_b16 a[184:185], v62 offset:10240
  v_mfma_f32_32x32x16_bf16 v[176:191], v[220:223], a[4:7], v[176:191]
  ds_read_b64_tr_b16 v[212:213], v17 offset:6144
  ds_read_b64_tr_b16 v[214:215], v17 offset:6656
  buffer_load_dwordx4 v13, s[52:55], s15 offen offset:3072 lds
  ds_read_b64_tr_b16 a[186:187], v62 offset:11520
  s_waitcnt lgkmcnt(0)
  v_mfma_f32_32x32x16_bf16 v[128:143], v[192:195], a[8:11], v[128:143]
  ds_read_b64_tr_b16 v[216:217], v16 offset:14336
  ds_read_b64_tr_b16 v[218:219], v16 offset:14848
  buffer_store_dwordx4 a[176:179], v36, s[56:59], s86 offen sc1
  v_mfma_f32_32x32x16_bf16 v[160:175], v[196:199], a[8:11], v[160:175]
  ds_read_b64_tr_b16 v[220:221], v17 offset:14336
  ds_read_b64_tr_b16 v[222:223], v17 offset:14848
  buffer_store_dwordx4 a[180:183], v36, s[56:59], s87 offen sc1
  v_mfma_f32_32x32x16_bf16 v[144:159], v[200:203], a[8:11], v[144:159]
  buffer_store_dwordx4 a[184:187], v36, s[56:59], s88 offen sc1
  s_waitcnt vmcnt(17)
  s_barrier
  ds_read_b64_tr_b16 v[192:193], v16 offset:16384
  ds_read_b64_tr_b16 v[194:195], v16 offset:16896
  s_add_u32 s15, s84, 1105920
  s_add_u32 m0, s82, 49152
  s_nop 0
  buffer_load_dwordx4 v10, s[52:55], s15 offen offset:0 lds
  s_waitcnt vmcnt(9)
  v_xor_b32 v60, s6, v39
  v_cmp_ne_u32 vcc, 0, v60
  s_nop 1
  s_cmp_eq_u64 vcc, 0
  s_cbranch_scc0 L_slow_5
L_back_6:
  v_mfma_f32_32x32x16_bf16 v[176:191], v[204:207], a[8:11], v[176:191]
  ds_read_b64_tr_b16 v[196:197], v17 offset:16384
  ds_read_b64_tr_b16 v[198:199], v17 offset:16896
  v_lshlrev_b32 v26, 16, v38
  v_and_b32 v28, 0xffff0000, v38
  v_mfma_f32_32x32x16_bf16 v[128:143], v[208:211], a[12:15], v[128:143]
  ds_read_b64_tr_b16 v[200:201], v16 offset:24576
  ds_read_b64_tr_b16 v[202:203], v16 offset:25088
  v_rcp_f32 v27, v28
  v_mfma_f32_32x32x16_bf16 v[160:175], v[212:215], a[12:15], v[160:175]
  ds_read_b64_tr_b16 v[204:205], v17 offset:24576
  ds_read_b64_tr_b16 v[206:207], v17 offset:25088
  v_xor_b32 v60, s6, v225
  v_xor_b32 v61, s6, v227
  s_waitcnt lgkmcnt(8)
  v_mfma_f32_32x32x16_bf16 v[144:159], v[216:219], a[12:15], v[144:159]
  ds_read_b64_tr_b16 v[208:209], v16 offset:18432
  ds_read_b64_tr_b16 v[210:211], v16 offset:18944
  v_or_b32 v60, v60, v61
  v_xor_b32 v61, s6, v229
  v_mfma_f32_32x32x16_bf16 v[176:191], v[220:223], a[12:15], v[176:191]
  ds_read_b64_tr_b16 v[212:213], v17 offset:18432
  ds_read_b64_tr_b16 v[214:215], v17 offset:18944
  s_add_u32 m0, s82, 49152
  s_nop 0
  buffer_load_dwordx4 v11, s[52:55], s15 offen offset:1024 lds
  v_or_b32 v60, v60, v61
  v_xor_b32 v61, s6, v231
  v_or_b32 v60, v60, v61
  s_waitcnt lgkmcnt(8)
  v_mfma_f32_32x32x16_bf16 v[128:143], v[192:195], a[16:19], v[128:143]
  ds_read_b64_tr_b16 v[216:217], v16 offset:26624
  ds_read_b64_tr_b16 v[218:219], v16 offset:27136
  v_cmp_ne_u32 vcc, 0, v60
  s_nop 1
  s_cmp_eq_u64 vcc, 0
  s_cbranch_scc0 L_slow_8
L_back_9:
  v_add_f32 v224, v224, v226
  v_mfma_f32_32x32x16_bf16 v[160:175], v[196:199], a[16:19], v[160:175]
  ds_read_b64_tr_b16 v[220:221], v17 offset:26624
  ds_read_b64_tr_b16 v[222:223], v17 offset:27136
  v_cvt_pk_bf16_f32 v225, v224, v224
  v_lshlrev_b32 v225, 16, v225
  s_waitcnt lgkmcnt(8)
  v_mfma_f32_32x32x16_bf16 v[144:159], v[200:203], a[16:19], v[144:159]
  ds_read_b64_tr_b16 v[192:193], v16 offset:20480
  ds_read_b64_tr_b16 v[194:195], v16 offset:20992
  v_sub_f32 v225, v224, v225
  v_cvt_pk_bf16_f32 v224, v224, v225
  v_mfma_f32_32x32x16_bf16 v[176:191], v[204:207], a[16:19], v[176:191]
  ds_read_b64_tr_b16 v[196:197], v17 offset:20480
  ds_read_b64_tr_b16 v[198:199], v17 offset:20992
  s_add_u32 m0, s82, 49152
  s_nop 0
  buffer_load_dwordx4 v12, s[52:55], s15 offen offset:2048 lds
  v_add_f32 v228, v228, v230
  v_cvt_pk_bf16_f32 v229, v228, v228
  s_waitcnt lgkmcnt(8)
  v_mfma_f32_32x32x16_bf16 v[128:143], v[208:211], a[20:23], v[128:143]
  ds_read_b64_tr_b16 v[200:201], v16 offset:28672
  ds_read_b64_tr_b16 v[202:203], v16 offset:29184
  v_lshlrev_b32 v229, 16, v229
  v_sub_f32 v229, v228, v229
  v_mfma_f32_32x32x16_bf16 v[160:175], v[212:215], a[20:23], v[160:175]
  ds_read_b64_tr_b16 v[204:205], v17 offset:28672
  ds_read_b64_tr_b16 v[206:207], v17 offset:29184
  v_cvt_pk_bf16_f32 v228, v228, v229
  s_lshl_b32 s8, s3, 8
  s_add_u32 s8, s8, 160768
  v_lshl_add_u32 v42, v1, 2, s8
  ds_write_b32 v42, v224
  s_waitcnt lgkmcnt(9)
  v_mfma_f32_32x32x16_bf16 v[144:159], v[216:219], a[20:23], v[144:159]
  ds_read_b64_tr_b16 v[208:209], v16 offset:22528
  ds_read_b64_tr_b16 v[210:211], v16 offset:23040
  ds_write_b32 v42, v228 offset:1024
  v_xor_b32 v60, 0x80000000, v26
  v_lshrrev_b32 v61, 16, v60
  v_or_b32 v60, v60, v61
  v_cmp_gt_u32 vcc, 32, v1
  s_nop 1
  v_cndmask_b32 v60, 0, v60, vcc
  v_accvgpr_write_b32 a160, v60
  v_mfma_f32_32x32x16_bf16 v[176:191], v[220:223], a[20:23], v[176:191]
  ds_read_b64_tr_b16 v[212:213], v17 offset:22528
  ds_read_b64_tr_b16 v[214:215], v17 offset:23040
  buffer_load_dwordx4 v13, s[52:55], s15 offen offset:3072 lds
  v_accvgpr_write_b32 a161, 0
  v_accvgpr_write_b32 a162, 0
  s_waitcnt lgkmcnt(10)
  v_mfma_f32_32x32x16_bf16 v[128:143], v[192:195], a[24:27], v[128:143]
  ds_read_b64_tr_b16 v[216:217], v16 offset:30720
  ds_read_b64_tr_b16 v[218:219], v16 offset:31232
  v_accvgpr_write_b32 a163, 0
  v_mul_f32 v22, 0xc0135761, v27
  v_mfma_f32_32x32x16_bf16 v[160:175], v[196:199], a[24:27], v[160:175]
  ds_read_b64_tr_b16 v[220:221], v17 offset:30720
  ds_read_b64_tr_b16 v[222:223], v17 offset:31232
  v_mul_f32 v23, v27, v27
  v_mul_f32 v23, v23, v27
  s_waitcnt lgkmcnt(10)
  v_mfma_f32_32x32x16_bf16 v[144:159], v[200:203], a[24:27], v[144:159]
  v_mul_f32 v23, 0xbdd2d3e8, v23
  v_mul_f32 v24, v28, v28
  s_waitcnt lgkmcnt(6)
  s_barrier
  ds_read_b64_tr_b16 v[192:193], v14 offset:0
  ds_read_b64_tr_b16 v[194:195], v14 offset:512
  s_add_u32 s15, s84, 1327104
  s_add_u32 m0, s82, 65536
  s_nop 0
  buffer_load_dwordx4 v10, s[52:55], s15 offen offset:0 lds
  ds_read_b32 v236, v30 offset:0
  v_mfma_f32_32x32x16_bf16 v[176:191], v[204:207], a[24:27], v[176:191]
  ds_read_b64_tr_b16 v[196:197], v15 offset:0
  ds_read_b64_tr_b16 v[198:199], v15 offset:512
  ds_read_b32 v240, v30 offset:128
  s_waitcnt lgkmcnt(10)
  v_mfma_f32_32x32x16_bf16 v[128:143], v[208:211], a[28:31], v[128:143]
  ds_read_b64_tr_b16 v[200:201], v14 offset:8192
  ds_read_b64_tr_b16 v[202:203], v14 offset:8704
  ds_read_b32 v244, v30 offset:1024
  v_mfma_f32_32x32x16_bf16 v[160:175], v[212:215], a[28:31], v[160:175]
  ds_read_b64_tr_b16 v[204:205], v15 offset:8192
  ds_read_b64_tr_b16 v[206:207], v15 offset:8704
  ds_read_b32 v248, v30 offset:1152
  s_waitcnt lgkmcnt(12)
  v_mfma_f32_32x32x16_bf16 v[144:159], v[216:219], a[28:31], v[144:159]
  ds_read_b64_tr_b16 v[208:209], v14 offset:2048
  ds_read_b64_tr_b16 v[210:211], v14 offset:2560
  v_mfma_f32_32x32x16_bf16 v[176:191], v[220:223], a[28:31], v[176:191]
  ds_read_b64_tr_b16 v[212:213], v15 offset:2048
  ds_read_b64_tr_b16 v[214:215], v15 offset:2560
  buffer_load_dwordx4 v11, s[52:55], s15 offen offset:1024 lds
  s_waitcnt lgkmcnt(4)
  v_mfma_f32_32x32x16_bf16 v[128:143], v[192:195], a[32:35], v[128:143]
  ds_read_b64_tr_b16 v[216:217], v14 offset:10240
  ds_read_b64_tr_b16 v[218:219], v14 offset:10752
  v_and_b32 v236, v236, v31
  v_mfma_f32_32x32x16_bf16 v[160:175], v[196:199], a[32:35], v[160:175]
  ds_read_b64_tr_b16 v[220:221], v15 offset:10240
  ds_read_b64_tr_b16 v[222:223], v15 offset:10752
  v_and_b32 v240, v240, v31
  v_mfma_f32_32x32x16_bf16 v[144:159], v[200:203], a[32:35], v[144:159]
  ds_read_b64_tr_b16 v[192:193], v14 offset:4096
  ds_read_b64_tr_b16 v[194:195], v14 offset:4608
  v_mfma_f32_32x32x16_bf16 v[176:191], v[204:207], a[32:35], v[176:191]
  ds_read_b64_tr_b16 v[196:197], v15 offset:4096
  ds_read_b64_tr_b16 v[198:199], v15 offset:4608
  buffer_load_dwordx4 v12, s[52:55], s15 offen offset:2048 lds
  v_and_b32 v244, v244, v31
  s_waitcnt lgkmcnt(8)
  v_mfma_f32_32x32x16_bf16 v[128:143], v[208:211], a[36:39], v[128:143]
  ds_read_b64_tr_b16 v[200:201], v14 offset:12288
  ds_read_b64_tr_b16 v[202:203], v14 offset:12800
  v_and_b32 v248, v248, v31
  v_mfma_f32_32x32x16_bf16 v[160:175], v[212:215], a[36:39], v[160:175]
  ds_read_b64_tr_b16 v[204:205], v15 offset:12288
  ds_read_b64_tr_b16 v[206:207], v15 offset:12800
  v_mfma_f32_32x32x16_bf16 v[64:79], v[236:239], a[160:163], v[64:79]
  s_waitcnt lgkmcnt(8)
  v_mfma_f32_32x32x16_bf16 v[144:159], v[216:219], a[36:39], v[144:159]
  ds_read_b64_tr_b16 v[208:209], v14 offset:6144
  ds_read_b64_tr_b16 v[210:211], v14 offset:6656
  v_mfma_f32_32x32x16_bf16 v[176:191], v[220:223], a[36:39], v[176:191]
  ds_read_b64_tr_b16 v[212:213], v15 offset:6144
  ds_read_b64_tr_b16 v[214:215], v15 offset:6656
  buffer_load_dwordx4 v13, s[52:55], s15 offen offset:3072 lds
  v_mfma_f32_32x32x16_bf16 v[96:111], v[240:243], a[160:163], v[96:111]
  s_waitcnt lgkmcnt(8)
  v_mfma_f32_32x32x16_bf16 v[128:143], v[192:195], a[40:43], v[128:143]
  ds_read_b64_tr_b16 v[216:217], v14 offset:14336
  ds_read_b64_tr_b16 v[218:219], v14 offset:14848
  v_mfma_f32_32x32x16_bf16 v[80:95], v[244:247], a[160:163], v[80:95]
  v_mfma_f32_32x32x16_bf16 v[160:175], v[196:199], a[40:43], v[160:175]
  ds_read_b64_tr_b16 v[220:221], v15 offset:14336
  ds_read_b64_tr_b16 v[222:223], v15 offset:14848
  v_mfma_f32_32x32x16_bf16 v[112:127], v[248:251], a[160:163], v[112:127]
  s_waitcnt lgkmcnt(8)
  v_mfma_f32_32x32x16_bf16 v[144:159], v[200:203], a[40:43], v[144:159]
  s_waitcnt vmcnt(12)
  s_barrier
  ds_read_b64_tr_b16 v[192:193], v14 offset:16384
  ds_read_b64_tr_b16 v[194:195], v14 offset:16896
  s_add_u32 s15, s84, 1548288
  s_add_u32 m0, s82, 81920
  s_nop 0
  buffer_load_dwordx4 v10, s[52:55], s15 offen offset:0 lds
  v_mul_f32 v252, v64, v64
  v_mul_f32 v253, v65, v65
  v_mul_f32 v254, v66, v66
  v_mfma_f32_32x32x16_bf16 v[176:191], v[204:207], a[40:43], v[176:191]
  ds_read_b64_tr_b16 v[196:197], v15 offset:16384
  ds_read_b64_tr_b16 v[198:199], v15 offset:16896
  v_mul_f32 v255, v67, v67
  v_fma_f32 v252, v252, v23, v22
  s_waitcnt lgkmcnt(8)
  v_mfma_f32_32x32x16_bf16 v[128:143], v[208:211], a[44:47], v[128:143]
  ds_read_b64_tr_b16 v[200:201], v14 offset:24576
  ds_read_b64_tr_b16 v[202:203], v14 offset:25088
  v_fma_f32 v253, v253, v23, v22
  v_fma_f32 v254, v254, v23, v22
  v_mfma_f32_32x32x16_bf16 v[160:175], v[212:215], a[44:47], v[160:175]
  ds_read_b64_tr_b16 v[204:205], v15 offset:24576
  ds_read_b64_tr_b16 v[206:207], v15 offset:25088
  v_fma_f32 v255, v255, v23, v22
  v_mul_f32 v252, v252, v64
  v_mul_f32 v253, v253, v65
  s_waitcnt lgkmcnt(8)
  v_mfma_f32_32x32x16_bf16 v[144:159], v[216:219], a[44:47], v[144:159]
  ds_read_b64_tr_b16 v[208:209], v14 offset:18432
  ds_read_b64_tr_b16 v[210:211], v14 offset:18944
  v_mul_f32 v254, v254, v66
  v_mul_f32 v255, v255, v67
  v_mfma_f32_32x32x16_bf16 v[176:191], v[220:223], a[44:47], v[176:191]
  ds_read_b64_tr_b16 v[212:213], v15 offset:18432
  ds_read_b64_tr_b16 v[214:215], v15 offset:18944
  buffer_load_dwordx4 v11, s[52:55], s15 offen offset:1024 lds
  v_exp_f32 v252, v252
  v_exp_f32 v253, v253
  s_waitcnt lgkmcnt(8)
  v_mfma_f32_32x32x16_bf16 v[128:143], v[192:195], a[48:51], v[128:143]
  ds_read_b64_tr_b16 v[216:217], v14 offset:26624
  ds_read_b64_tr_b16 v[218:219], v14 offset:27136
  v_exp_f32 v254, v254
  v_exp_f32 v255, v255
  v_mul_f32 v80, v80, v64
  v_mfma_f32_32x32x16_bf16 v[160:175], v[196:199], a[48:51], v[160:175]
  ds_read_b64_tr_b16 v[220:221], v15 offset:26624
  ds_read_b64_tr_b16 v[222:223], v15 offset:27136
  v_mul_f32 v81, v81, v65
  v_mul_f32 v82, v82, v66
  s_waitcnt lgkmcnt(8)
  v_mfma_f32_32x32x16_bf16 v[144:159], v[200:203], a[48:51], v[144:159]
  ds_read_b64_tr_b16 v[192:193], v14 offset:20480
  ds_read_b64_tr_b16 v[194:195], v14 offset:20992
  v_mul_f32 v83, v83, v67
  v_fma_f32 v252, v252, v24, v24
  v_mfma_f32_32x32x16_bf16 v[176:191], v[204:207], a[48:51], v[176:191]
  ds_read_b64_tr_b16 v[196:197], v15 offset:20480
  ds_read_b64_tr_b16 v[198:199], v15 offset:20992
  buffer_load_dwordx4 v12, s[52:55], s15 offen offset:2048 lds
  v_fma_f32 v253, v253, v24, v24
  v_fma_f32 v254, v254, v24, v24
  s_waitcnt lgkmcnt(8)
  v_mfma_f32_32x32x16_bf16 v[128:143], v[208:211], a[52:55], v[128:143]
  ds_read_b64_tr_b16 v[200:201], v14 offset:28672
  ds_read_b64_tr_b16 v[202:203], v14 offset:29184
  v_fma_f32 v255, v255, v24, v24
  v_rcp_f32 v252, v252
  v_rcp_f32 v253, v253
  v_mfma_f32_32x32x16_bf16 v[160:175], v[212:215], a[52:55], v[160:175]
  ds_read_b64_tr_b16 v[204:205], v15 offset:28672
  ds_read_b64_tr_b16 v[206:207], v15 offset:29184
  v_rcp_f32 v254, v254
  v_rcp_f32 v255, v255
  s_waitcnt lgkmcnt(8)
  v_mfma_f32_32x32x16_bf16 v[144:159], v[216:219], a[52:55], v[144:159]
  ds_read_b64_tr_b16 v[208:209], v14 offset:22528
  ds_read_b64_tr_b16 v[210:211], v14 offset:23040
  v_mul_f32 v80, v80, v252
  v_mul_f32 v81, v81, v253
  v_mfma_f32_32x32x16_bf16 v[176:191], v[220:223], a[52:55], v[176:191]
  ds_read_b64_tr_b16 v[212:213], v15 offset:22528
  ds_read_b64_tr_b16 v[214:215], v15 offset:23040
  buffer_load_dwordx4 v13, s[52:55], s15 offen offset:3072 lds
  v_mul_f32 v82, v82, v254
  v_mul_f32 v83, v83, v255
  v_cvt_pk_bf16_f32 v64, v80, v81
  s_waitcnt lgkmcnt(8)
  v_mfma_f32_32x32x16_bf16 v[128:143], v[192:195], a[56:59], v[128:143]
  ds_read_b64_tr_b16 v[216:217], v14 offset:30720
  ds_read_b64_tr_b16 v[218:219], v14 offset:31232
  v_cvt_pk_bf16_f32 v65, v82, v83
  v_mul_f32 v252, v68, v68
  v_mfma_f32_32x32x16_bf16 v[160:175], v[196:199], a[56:59], v[160:175]
  ds_read_b64_tr_b16 v[220:221], v15 offset:30720
  ds_read_b64_tr_b16 v[222:223], v15 offset:31232
  v_mul_f32 v253, v69, v69
  v_mul_f32 v254, v70, v70
  s_waitcnt lgkmcnt(8)
  v_mfma_f32_32x32x16_bf16 v[144:159], v[200:203], a[56:59], v[144:159]
  v_mul_f32 v255, v71, v71
  v_fma_f32 v252, v252, v23, v22
  s_waitcnt vmcnt(12)
  s_waitcnt vmcnt(12)
  s_barrier
  ds_read_b64_tr_b16 v[192:193], v14 offset:32768
  ds_read_b64_tr_b16 v[194:195], v14 offset:33280
  s_add_u32 s15, s84, 1769472
  s_add_u32 m0, s82, 0
  s_nop 0
  buffer_load_dwordx4 v10, s[52:55], s15 offen offset:0 lds
  s_lshl_b32 s8, s2, 2
  s_add_u32 s8, s8, 0x10b0000
  v_mov_b32 v58, s6
  buffer_store_dword v58, v59, s[56:59], s8 offen sc1
  v_fma_f32 v253, v253, v23, v22
  v_fma_f32 v254, v254, v23, v22
  v_mfma_f32_32x32x16_bf16 v[176:191], v[204:207], a[56:59], v[176:191]
  ds_read_b64_tr_b16 v[196:197], v15 offset:32768
  ds_read_b64_tr_b16 v[198:199], v15 offset:33280
  v_fma_f32 v255, v255, v23, v22
  v_mul_f32 v252, v252, v68
  s_waitcnt lgkmcnt(8)
  v_mfma_f32_32x32x16_bf16 v[128:143], v[208:211], a[60:63], v[128:143]
  ds_read_b64_tr_b16 v[200:201], v14 offset:40960
  ds_read_b64_tr_b16 v[202:203], v14 offset:41472
  v_mul_f32 v253, v253, v69
  v_mul_f32 v254, v254, v70
  v_mul_f32 v255, v255, v71
  v_mfma_f32_32x32x16_bf16 v[160:175], v[212:215], a[60:63], v[160:175]
  ds_read_b64_tr_b16 v[204:205], v15 offset:40960
  ds_read_b64_tr_b16 v[206:207], v15 offset:41472
  v_exp_f32 v252, v252
  v_exp_f32 v253, v253
  s_waitcnt lgkmcnt(8)
  v_mfma_f32_32x32x16_bf16 v[144:159], v[216:219], a[60:63], v[144:159]
  ds_read_b64_tr_b16 v[208:209], v14 offset:34816
  ds_read_b64_tr_b16 v[210:211], v14 offset:35328
  v_exp_f32 v254, v254
  v_exp_f32 v255, v255
  v_mfma_f32_32x32x16_bf16 v[176:191], v[220:223], a[60:63], v[176:191]
  ds_read_b64_tr_b16 v[212:213], v15 offset:34816
  ds_read_b64_tr_b16 v[214:215], v15 offset:35328
  buffer_load_dwordx4 v11, s[52:55], s15 offen offset:1024 lds
  v_mul_f32 v84, v84, v68
  v_mul_f32 v85, v85, v69
  v_mul_f32 v86, v86, v70
  s_waitcnt lgkmcnt(8)
  v_mfma_f32_32x32x16_bf16 v[128:143], v[192:195], a[64:67], v[128:143]
  ds_read_b64_tr_b16 v[216:217], v14 offset:43008
  ds_read_b64_tr_b16 v[218:219], v14 offset:43520
  v_mul_f32 v87, v87, v71
  v_fma_f32 v252, v252, v24, v24
  v_mfma_f32_32x32x16_bf16 v[160:175], v[196:199], a[64:67], v[160:175]
  ds_read_b64_tr_b16 v[220:221], v15 offset:43008
  ds_read_b64_tr_b16 v[222:223], v15 offset:43520
  v_fma_f32 v253, v253, v24, v24
  v_fma_f32 v254, v254, v24, v24
  s_waitcnt lgkmcnt(8)
  v_mfma_f32_32x32x16_bf16 v[144:159], v[200:203], a[64:67], v[144:159]
  ds_read_b64_tr_b16 v[192:193], v14 offset:36864
  ds_read_b64_tr_b16 v[194:195], v14 offset:37376
  v_fma_f32 v255, v255, v24, v24
  v_rcp_f32 v252, v252
  v_rcp_f32 v253, v253
  v_mfma_f32_32x32x16_bf16 v[176:191], v[204:207], a[64:67], v[176:191]
  ds_read_b64_tr_b16 v[196:197], v15 offset:36864
  ds_read_b64_tr_b16 v[198:199], v15 offset:37376
  buffer_load_dwordx4 v12, s[52:55], s15 offen offset:2048 lds
  v_rcp_f32 v254, v254
  v_rcp_f32 v255, v255
  s_waitcnt lgkmcnt(8)
  v_mfma_f32_32x32x16_bf16 v[128:143], v[208:211], a[68:71], v[128:143]
  ds_read_b64_tr_b16 v[200:201], v14 offset:45056
  ds_read_b64_tr_b16 v[202:203], v14 offset:45568
  v_mul_f32 v84, v84, v252
  v_mul_f32 v85, v85, v253
  v_mfma_f32_32x32x16_bf16 v[160:175], v[212:215], a[68:71], v[160:175]
  ds_read_b64_tr_b16 v[204:205], v15 offset:45056
  ds_read_b64_tr_b16 v[206:207], v15 offset:45568
  v_mul_f32 v86, v86, v254
  v_mul_f32 v87, v87, v255
  v_cvt_pk_bf16_f32 v66, v84, v85
  s_waitcnt lgkmcnt(8)
  v_mfma_f32_32x32x16_bf16 v[144:159], v[216:219], a[68:71], v[144:159]
  ds_read_b64_tr_b16 v[208:209], v14 offset:38912
  ds_read_b64_tr_b16 v[210:211], v14 offset:39424
  v_cvt_pk_bf16_f32 v67, v86, v87
  buffer_store_dwordx4 v[64:67], v29, s[56:59], s96 offen offset:0 sc1
  v_mfma_f32_32x32x16_bf16 v[176:191], v[220:223], a[68:71], v[176:191]
  ds_read_b64_tr_b16 v[212:213], v15 offset:38912
  ds_read_b64_tr_b16 v[214:215], v15 offset:39424
  buffer_load_dwordx4 v13, s[52:55], s15 offen offset:3072 lds
  v_mul_f32 v252, v72, v72
  v_mul_f32 v253, v73, v73
  s_waitcnt lgkmcnt(8)
  v_mfma_f32_32x32x16_bf16 v[128:143], v[192:195], a[72:75], v[128:143]
  ds_read_b64_tr_b16 v[216:217], v14 offset:47104
  ds_read_b64_tr_b16 v[218:219], v14 offset:47616
  v_mul_f32 v254, v74, v74
  v_mul_f32 v255, v75, v75
  v_fma_f32 v252, v252, v23, v22
  v_mfma_f32_32x32x16_bf16 v[160:175], v[196:199], a[72:75], v[160:175]
  ds_read_b64_tr_b16 v[220:221], v15 offset:47104
  ds_read_b64_tr_b16 v[222:223], v15 offset:47616
  v_fma_f32 v253, v253, v23, v22
  v_fma_f32 v254, v254, v23, v22
  s_waitcnt lgkmcnt(8)
  v_mfma_f32_32x32x16_bf16 v[144:159], v[200:203], a[72:75], v[144:159]
  v_fma_f32 v255, v255, v23, v22
  v_mul_f32 v252, v252, v72
  s_waitcnt vmcnt(12)
  s_barrier
  ds_read_b64_tr_b16 v[192:193], v14 offset:49152
  ds_read_b64_tr_b16 v[194:195], v14 offset:49664
  s_add_u32 s15, s84, 1990656
  s_add_u32 m0, s82, 16384
  s_nop 0
  buffer_load_dwordx4 v10, s[52:55], s15 offen offset:0 lds
  v_mul_f32 v253, v253, v73
  v_mul_f32 v254, v254, v74
  v_mul_f32 v255, v255, v75
  v_mfma_f32_32x32x16_bf16 v[176:191], v[204:207], a[72:75], v[176:191]
  ds_read_b64_tr_b16 v[196:197], v15 offset:49152
  ds_read_b64_tr_b16 v[198:199], v15 offset:49664
  v_exp_f32 v252, v252
  v_exp_f32 v253, v253
  s_waitcnt lgkmcnt(8)
  v_mfma_f32_32x32x16_bf16 v[128:143], v[208:211], a[76:79], v[128:143]
  ds_read_b64_tr_b16 v[200:201], v14 offset:57344
  ds_read_b64_tr_b16 v[202:203], v14 offset:57856
  v_exp_f32 v254, v254
  v_exp_f32 v255, v255
  v_mul_f32 v88, v88, v72
  v_mfma_f32_32x32x16_bf16 v[160:175], v[212:215], a[76:79], v[160:175]
  ds_read_b64_tr_b16 v[204:205], v15 offset:57344
  ds_read_b64_tr_b16 v[206:207], v15 offset:57856
  v_mul_f32 v89, v89, v73
  v_mul_f32 v90, v90, v74
  s_waitcnt lgkmcnt(8)
  v_mfma_f32_32x32x16_bf16 v[144:159], v[216:219], a[76:79], v[144:159]
  ds_read_b64_tr_b16 v[208:209], v14 offset:51200
  ds_read_b64_tr_b16 v[210:211], v14 offset:51712
  v_mul_f32 v91, v91, v75
  v_fma_f32 v252, v252, v24, v24
  v_mfma_f32_32x32x16_bf16 v[176:191], v[220:223], a[76:79], v[176:191]
  ds_read_b64_tr_b16 v[212:213], v15 offset:51200
  ds_read_b64_tr_b16 v[214:215], v15 offset:51712
  buffer_load_dwordx4 v11, s[52:55], s15 offen offset:1024 lds
  v_fma_f32 v253, v253, v24, v24
  v_fma_f32 v254, v254, v24, v24
  v_fma_f32 v255, v255, v24, v24
  s_waitcnt lgkmcnt(8)
  v_mfma_f32_32x32x16_bf16 v[128:143], v[192:195], a[80:83], v[128:143]
  ds_read_b64_tr_b16 v[216:217], v14 offset:59392
  ds_read_b64_tr_b16 v[218:219], v14 offset:59904
  v_rcp_f32 v252, v252
  v_rcp_f32 v253, v253
  v_mfma_f32_32x32x16_bf16 v[160:175], v[196:199], a[80:83], v[160:175]
  ds_read_b64_tr_b16 v[220:221], v15 offset:59392
  ds_read_b64_tr_b16 v[222:223], v15 offset:59904
  v_rcp_f32 v254, v254
  v_rcp_f32 v255, v255
  s_waitcnt lgkmcnt(8)
  v_mfma_f32_32x32x16_bf16 v[144:159], v[200:203], a[80:83], v[144:159]
  ds_read_b64_tr_b16 v[192:193], v14 offset:53248
  ds_read_b64_tr_b16 v[194:195], v14 offset:53760
  v_mul_f32 v88, v88, v252
  v_mul_f32 v89, v89, v253
  v_mul_f32 v90, v90, v254
  v_mfma_f32_32x32x16_bf16 v[176:191], v[204:207], a[80:83], v[176:191]
  ds_read_b64_tr_b16 v[196:197], v15 offset:53248
  ds_read_b64_tr_b16 v[198:199], v15 offset:53760
  buffer_load_dwordx4 v12, s[52:55], s15 offen offset:2048 lds
  v_mul_f32 v91, v91, v255
  v_cvt_pk_bf16_f32 v72, v88, v89
  s_waitcnt lgkmcnt(8)
  v_mfma_f32_32x32x16_bf16 v[128:143], v[208:211], a[84:87], v[128:143]
  ds_read_b64_tr_b16 v[200:201], v14 offset:61440
  ds_read_b64_tr_b16 v[202:203], v14 offset:61952
  v_cvt_pk_bf16_f32 v73, v90, v91
  v_mul_f32 v252, v76, v76
  v_mfma_f32_32x32x16_bf16 v[160:175], v[212:215], a[84:87], v[160:175]
  ds_read_b64_tr_b16 v[204:205], v15 offset:61440
  ds_read_b64_tr_b16 v[206:207], v15 offset:61952
  v_mul_f32 v253, v77, v77
  v_mul_f32 v254, v78, v78
  v_mul_f32 v255, v79, v79
  s_waitcnt lgkmcnt(8)
  v_mfma_f32_32x32x16_bf16 v[144:159], v[216:219], a[84:87], v[144:159]
  ds_read_b64_tr_b16 v[208:209], v14 offset:55296
  ds_read_b64_tr_b16 v[210:211], v14 offset:55808
  v_fma_f32 v252, v252, v23, v22
  v_fma_f32 v253, v253, v23, v22
  v_mfma_f32_32x32x16_bf16 v[176:191], v[220:223], a[84:87], v[176:191]
  ds_read_b64_tr_b16 v[212:213], v15 offset:55296
  ds_read_b64_tr_b16 v[214:215], v15 offset:55808
  buffer_load_dwordx4 v13, s[52:55], s15 offen offset:3072 lds
  v_fma_f32 v254, v254, v23, v22
  v_fma_f32 v255, v255, v23, v22
  s_waitcnt lgkmcnt(8)
  v_mfma_f32_32x32x16_bf16 v[128:143], v[192:195], a[88:91], v[128:143]
  ds_read_b64_tr_b16 v[216:217], v14 offset:63488
  ds_read_b64_tr_b16 v[218:219], v14 offset:64000
  v_mul_f32 v252, v252, v76
  v_mul_f32 v253, v253, v77
  v_mul_f32 v254, v254, v78
  v_mfma_f32_32x32x16_bf16 v[160:175], v[196:199], a[88:91], v[160:175]
  ds_read_b64_tr_b16 v[220:221], v15 offset:63488
  ds_read_b64_tr_b16 v[222:223], v15 offset:64000
  v_mul_f32 v255, v255, v79
  v_exp_f32 v252, v252
  s_waitcnt lgkmcnt(8)
  v_mfma_f32_32x32x16_bf16 v[144:159], v[200:203], a[88:91], v[144:159]
  v_exp_f32 v253, v253
  v_exp_f32 v254, v254
  s_waitcnt vmcnt(12)
  s_barrier
  ds_read_b64_tr_b16 v[192:193], v16 offset:0
  ds_read_b64_tr_b16 v[194:195], v16 offset:512
  s_add_u32 s15, s85, 0
  s_add_u32 m0, s82, 32768
  s_nop 0
  buffer_load_dwordx4 v10, s[52:55], s15 offen offset:0 lds
  v_exp_f32 v255, v255
  v_mul_f32 v92, v92, v76
  v_mul_f32 v93, v93, v77
  v_mfma_f32_32x32x16_bf16 v[176:191], v[204:207], a[88:91], v[176:191]
  ds_read_b64_tr_b16 v[196:197], v17 offset:0
  ds_read_b64_tr_b16 v[198:199], v17 offset:512
  v_mul_f32 v94, v94, v78
  v_mul_f32 v95, v95, v79
  s_waitcnt lgkmcnt(8)
  v_mfma_f32_32x32x16_bf16 v[128:143], v[208:211], a[92:95], v[128:143]
  ds_read_b64_tr_b16 v[200:201], v16 offset:8192
  ds_read_b64_tr_b16 v[202:203], v16 offset:8704
  v_fma_f32 v252, v252, v24, v24
  v_fma_f32 v253, v253, v24, v24
  v_mfma_f32_32x32x16_bf16 v[160:175], v[212:215], a[92:95], v[160:175]
  ds_read_b64_tr_b16 v[204:205], v17 offset:8192
  ds_read_b64_tr_b16 v[206:207], v17 offset:8704
  v_fma_f32 v254, v254, v24, v24
  v_fma_f32 v255, v255, v24, v24
  v_rcp_f32 v252, v252
  s_waitcnt lgkmcnt(8)
  v_mfma_f32_32x32x16_bf16 v[144:159], v[216:219], a[92:95], v[144:159]
  ds_read_b64_tr_b16 v[208:209], v16 offset:2048
  ds_read_b64_tr_b16 v[210:211], v16 offset:2560
  v_rcp_f32 v253, v253
  v_rcp_f32 v254, v254
  v_mfma_f32_32x32x16_bf16 v[176:191], v[220:223], a[92:95], v[176:191]
  ds_read_b64_tr_b16 v[212:213], v17 offset:2048
  ds_read_b64_tr_b16 v[214:215], v17 offset:2560
  buffer_load_dwordx4 v11, s[52:55], s15 offen offset:1024 lds
  v_rcp_f32 v255, v255
  v_mul_f32 v92, v92, v252
  s_waitcnt lgkmcnt(8)
  v_mfma_f32_32x32x16_bf16 v[128:143], v[192:195], a[96:99], v[128:143]
  ds_read_b64_tr_b16 v[216:217], v16 offset:10240
  ds_read_b64_tr_b16 v[218:219], v16 offset:10752
  v_mul_f32 v93, v93, v253
  v_mul_f32 v94, v94, v254
  v_mul_f32 v95, v95, v255
  v_mfma_f32_32x32x16_bf16 v[160:175], v[196:199], a[96:99], v[160:175]
  ds_read_b64_tr_b16 v[220:221], v17 offset:10240
  ds_read_b64_tr_b16 v[222:223], v17 offset:10752
  v_cvt_pk_bf16_f32 v74, v92, v93
  v_cvt_pk_bf16_f32 v75, v94, v95
  s_waitcnt lgkmcnt(8)
  v_mfma_f32_32x32x16_bf16 v[144:159], v[200:203], a[96:99], v[144:159]
  ds_read_b64_tr_b16 v[192:193], v16 offset:4096
  ds_read_b64_tr_b16 v[194:195], v16 offset:4608
  buffer_store_dwordx4 v[72:75], v29, s[56:59], s96 offen offset:512 sc1
  v_mul_f32 v252, v96, v96
  v_mfma_f32_32x32x16_bf16 v[176:191], v[204:207], a[96:99], v[176:191]
  ds_read_b64_tr_b16 v[196:197], v17 offset:4096
  ds_read_b64_tr_b16 v[198:199], v17 offset:4608
  buffer_load_dwordx4 v12, s[52:55], s15 offen offset:2048 lds
  v_mul_f32 v253, v97, v97
  v_mul_f32 v254, v98, v98
  s_waitcnt lgkmcnt(8)
  v_mfma_f32_32x32x16_bf16 v[128:143], v[208:211], a[100:103], v[128:143]
  ds_read_b64_tr_b16 v[200:201], v16 offset:12288
  ds_read_b64_tr_b16 v[202:203], v16 offset:12800
  v_mul_f32 v255, v99, v99
  v_fma_f32 v252, v252, v23, v22
  v_fma_f32 v253, v253, v23, v22
  v_mfma_f32_32x32x16_bf16 v[160:175], v[212:215], a[100:103], v[160:175]
  ds_read_b64_tr_b16 v[204:205], v17 offset:12288
  ds_read_b64_tr_b16 v[206:207], v17 offset:12800
  v_fma_f32 v254, v254, v23, v22
  v_fma_f32 v255, v255, v23, v22
  s_waitcnt lgkmcnt(8)
  v_mfma_f32_32x32x16_bf16 v[144:159], v[216:219], a[100:103], v[144:159]
  ds_read_b64_tr_b16 v[208:209], v16 offset:6144
  ds_read_b64_tr_b16 v[210:211], v16 offset:6656
  v_mul_f32 v252, v252, v96
  v_mul_f32 v253, v253, v97
  v_mfma_f32_32x32x16_bf16 v[176:191], v[220:223], a[100:103], v[176:191]
  ds_read_b64_tr_b16 v[212:213], v17 offset:6144
  ds_read_b64_tr_b16 v[214:215], v17 offset:6656
  buffer_load_dwordx4 v13, s[52:55], s15 offen offset:3072 lds
  v_mul_f32 v254, v254, v98
  v_mul_f32 v255, v255, v99
  v_exp_f32 v252, v252
  s_waitcnt lgkmcnt(8)
  v_mfma_f32_32x32x16_bf16 v[128:143], v[192:195], a[104:107], v[128:143]
  ds_read_b64_tr_b16 v[216:217], v16 offset:14336
  ds_read_b64_tr_b16 v[218:219], v16 offset:14848
  v_exp_f32 v253, v253
  v_exp_f32 v254, v254
  v_mfma_f32_32x32x16_bf16 v[160:175], v[196:199], a[104:107], v[160:175]
  ds_read_b64_tr_b16 v[220:221], v17 offset:14336
  ds_read_b64_tr_b16 v[222:223], v17 offset:14848
  v_exp_f32 v255, v255
  v_mul_f32 v112, v112, v96
  s_waitcnt lgkmcnt(8)
  v_mfma_f32_32x32x16_bf16 v[144:159], v[200:203], a[104:107], v[144:159]
  v_mul_f32 v113, v113, v97
  v_mul_f32 v114, v114, v98
  s_waitcnt vmcnt(12)
  s_barrier
  ds_read_b64_tr_b16 v[192:193], v16 offset:16384
  ds_read_b64_tr_b16 v[194:195], v16 offset:16896
  s_add_u32 s15, s85, 221184
  s_add_u32 m0, s82, 49152
  s_nop 0
  buffer_load_dwordx4 v10, s[52:55], s15 offen offset:0 lds
  v_mul_f32 v115, v115, v99
  v_fma_f32 v252, v252, v24, v24
  v_fma_f32 v253, v253, v24, v24
  v_mfma_f32_32x32x16_bf16 v[176:191], v[204:207], a[104:107], v[176:191]
  ds_read_b64_tr_b16 v[196:197], v17 offset:16384
  ds_read_b64_tr_b16 v[198:199], v17 offset:16896
  v_fma_f32 v254, v254, v24, v24
  v_fma_f32 v255, v255, v24, v24
  s_waitcnt lgkmcnt(8)
  v_mfma_f32_32x32x16_bf16 v[128:143], v[208:211], a[108:111], v[128:143]
  ds_read_b64_tr_b16 v[200:201], v16 offset:24576
  ds_read_b64_tr_b16 v[202:203], v16 offset:25088
  v_rcp_f32 v252, v252
  v_rcp_f32 v253, v253
  v_rcp_f32 v254, v254
  v_mfma_f32_32x32x16_bf16 v[160:175], v[212:215], a[108:111], v[160:175]
  ds_read_b64_tr_b16 v[204:205], v17 offset:24576
  ds_read_b64_tr_b16 v[206:207], v17 offset:25088
  v_rcp_f32 v255, v255
  v_mul_f32 v112, v112, v252
  s_waitcnt lgkmcnt(8)
  v_mfma_f32_32x32x16_bf16 v[144:159], v[216:219], a[108:111], v[144:159]
  ds_read_b64_tr_b16 v[208:209], v16 offset:18432
  ds_read_b64_tr_b16 v[210:211], v16 offset:18944
  v_mul_f32 v113, v113, v253
  v_mul_f32 v114, v114, v254
  v_mfma_f32_32x32x16_bf16 v[176:191], v[220:223], a[108:111], v[176:191]
  ds_read_b64_tr_b16 v[212:213], v17 offset:18432
  ds_read_b64_tr_b16 v[214:215], v17 offset:18944
  buffer_load_dwordx4 v11, s[52:55], s15 offen offset:1024 lds
  v_mul_f32 v115, v115, v255
  v_cvt_pk_bf16_f32 v96, v112, v113
  v_cvt_pk_bf16_f32 v97, v114, v115
  s_waitcnt lgkmcnt(8)
  v_mfma_f32_32x32x16_bf16 v[128:143], v[192:195], a[112:115], v[128:143]
  ds_read_b64_tr_b16 v[216:217], v16 offset:26624
  ds_read_b64_tr_b16 v[218:219], v16 offset:27136
  v_mul_f32 v252, v100, v100
  v_mul_f32 v253, v101, v101
  v_mfma_f32_32x32x16_bf16 v[160:175], v[196:199], a[112:115], v[160:175]
  ds_read_b64_tr_b16 v[220:221], v17 offset:26624
  ds_read_b64_tr_b16 v[222:223], v17 offset:27136
  v_mul_f32 v254, v102, v102
  v_mul_f32 v255, v103, v103
  s_waitcnt lgkmcnt(8)
  v_mfma_f32_32x32x16_bf16 v[144:159], v[200:203], a[112:115], v[144:159]
  ds_read_b64_tr_b16 v[192:193], v16 offset:20480
  ds_read_b64_tr_b16 v[194:195], v16 offset:20992
  v_fma_f32 v252, v252, v23, v22
  v_fma_f32 v253, v253, v23, v22
  v_fma_f32 v254, v254, v23, v22
  v_mfma_f32_32x32x16_bf16 v[176:191], v[204:207], a[112:115], v[176:191]
  ds_read_b64_tr_b16 v[196:197], v17 offset:20480
  ds_read_b64_tr_b16 v[198:199], v17 offset:20992
  buffer_load_dwordx4 v12, s[52:55], s15 offen offset:2048 lds
  v_fma_f32 v255, v255, v23, v22
  v_mul_f32 v252, v252, v100
  s_waitcnt lgkmcnt(8)
  v_mfma_f32_32x32x16_bf16 v[128:143], v[208:211], a[116:119], v[128:143]
  ds_read_b64_tr_b16 v[200:201], v16 offset:28672
  ds_read_b64_tr_b16 v[202:203], v16 offset:29184
  v_mul_f32 v253, v253, v101
  v_mul_f32 v254, v254, v102
  v_mfma_f32_32x32x16_bf16 v[160:175], v[212:215], a[116:119], v[160:175]
  ds_read_b64_tr_b16 v[204:205], v17 offset:28672
  ds_read_b64_tr_b16 v[206:207], v17 offset:29184
  v_mul_f32 v255, v255, v103
  v_exp_f32 v252, v252
  v_exp_f32 v253, v253
  s_waitcnt lgkmcnt(8)
  v_mfma_f32_32x32x16_bf16 v[144:159], v[216:219], a[116:119], v[144:159]
  ds_read_b64_tr_b16 v[208:209], v16 offset:22528
  ds_read_b64_tr_b16 v[210:211], v16 offset:23040
  v_exp_f32 v254, v254
  v_exp_f32 v255, v255
  v_mfma_f32_32x32x16_bf16 v[176:191], v[220:223], a[116:119], v[176:191]
  ds_read_b64_tr_b16 v[212:213], v17 offset:22528
  ds_read_b64_tr_b16 v[214:215], v17 offset:23040
  buffer_load_dwordx4 v13, s[52:55], s15 offen offset:3072 lds
  v_mul_f32 v116, v116, v100
  v_mul_f32 v117, v117, v101
  s_waitcnt lgkmcnt(8)
  v_mfma_f32_32x32x16_bf16 v[128:143], v[192:195], a[120:123], v[128:143]
  ds_read_b64_tr_b16 v[216:217], v16 offset:30720
  ds_read_b64_tr_b16 v[218:219], v16 offset:31232
  v_mul_f32 v118, v118, v102
  v_mul_f32 v119, v119, v103
  v_fma_f32 v252, v252, v24, v24
  v_mfma_f32_32x32x16_bf16 v[160:175], v[196:199], a[120:123], v[160:175]
  ds_read_b64_tr_b16 v[220:221], v17 offset:30720
  ds_read_b64_tr_b16 v[222:223], v17 offset:31232
  v_fma_f32 v253, v253, v24, v24
  v_fma_f32 v254, v254, v24, v24
  s_waitcnt lgkmcnt(8)
  v_mfma_f32_32x32x16_bf16 v[144:159], v[200:203], a[120:123], v[144:159]
  v_fma_f32 v255, v255, v24, v24
  v_rcp_f32 v252, v252
  s_waitcnt vmcnt(12)
  s_barrier
  ds_read_b64_tr_b16 v[192:193], v14 offset:0
  ds_read_b64_tr_b16 v[194:195], v14 offset:512
  s_add_u32 s15, s85, 442368
  s_add_u32 m0, s82, 65536
  s_nop 0
  buffer_load_dwordx4 v10, s[52:55], s15 offen offset:0 lds
  v_rcp_f32 v253, v253
  v_rcp_f32 v254, v254
  v_rcp_f32 v255, v255
  v_mfma_f32_32x32x16_bf16 v[176:191], v[204:207], a[120:123], v[176:191]
  ds_read_b64_tr_b16 v[196:197], v15 offset:0
  ds_read_b64_tr_b16 v[198:199], v15 offset:512
  v_mul_f32 v116, v116, v252
  v_mul_f32 v117, v117, v253
  s_waitcnt lgkmcnt(8)
  v_mfma_f32_32x32x16_bf16 v[128:143], v[208:211], a[124:127], v[128:143]
  ds_read_b64_tr_b16 v[200:201], v14 offset:8192
  ds_read_b64_tr_b16 v[202:203], v14 offset:8704
  v_mul_f32 v118, v118, v254
  v_mul_f32 v119, v119, v255
  v_mfma_f32_32x32x16_bf16 v[160:175], v[212:215], a[124:127], v[160:175]
  ds_read_b64_tr_b16 v[204:205], v15 offset:8192
  ds_read_b64_tr_b16 v[206:207], v15 offset:8704
  v_cvt_pk_bf16_f32 v98, v116, v117
  v_cvt_pk_bf16_f32 v99, v118, v119
  s_add_u32 s8, s96, 131072
  buffer_store_dwordx4 v[96:99], v29, s[56:59], s8 offen offset:0 sc1
  s_waitcnt lgkmcnt(8)
  v_mfma_f32_32x32x16_bf16 v[144:159], v[216:219], a[124:127], v[144:159]
  ds_read_b64_tr_b16 v[208:209], v14 offset:2048
  ds_read_b64_tr_b16 v[210:211], v14 offset:2560
  v_mul_f32 v252, v104, v104
  v_mul_f32 v253, v105, v105
  v_mfma_f32_32x32x16_bf16 v[176:191], v[220:223], a[124:127], v[176:191]
  ds_read_b64_tr_b16 v[212:213], v15 offset:2048
  ds_read_b64_tr_b16 v[214:215], v15 offset:2560
  buffer_load_dwordx4 v11, s[52:55], s15 offen offset:1024 lds
  v_mul_f32 v254, v106, v106
  v_mul_f32 v255, v107, v107
  s_waitcnt lgkmcnt(8)
  v_mfma_f32_32x32x16_bf16 v[128:143], v[192:195], a[128:131], v[128:143]
  ds_read_b64_tr_b16 v[216:217], v14 offset:10240
  ds_read_b64_tr_b16 v[218:219], v14 offset:10752
  v_fma_f32 v252, v252, v23, v22
  v_fma_f32 v253, v253, v23, v22
  v_fma_f32 v254, v254, v23, v22
  v_mfma_f32_32x32x16_bf16 v[160:175], v[196:199], a[128:131], v[160:175]
  ds_read_b64_tr_b16 v[220:221], v15 offset:10240
  ds_read_b64_tr_b16 v[222:223], v15 offset:10752
  v_fma_f32 v255, v255, v23, v22
  v_mul_f32 v252, v252, v104
  s_waitcnt lgkmcnt(8)
  v_mfma_f32_32x32x16_bf16 v[144:159], v[200:203], a[128:131], v[144:159]
  ds_read_b64_tr_b16 v[192:193], v14 offset:4096
  ds_read_b64_tr_b16 v[194:195], v14 offset:4608
  v_mul_f32 v253, v253, v105
  v_mul_f32 v254, v254, v106
  v_mfma_f32_32x32x16_bf16 v[176:191], v[204:207], a[128:131], v[176:191]
  ds_read_b64_tr_b16 v[196:197], v15 offset:4096
  ds_read_b64_tr_b16 v[198:199], v15 offset:4608
  buffer_load_dwordx4 v12, s[52:55], s15 offen offset:2048 lds
  v_mul_f32 v255, v255, v107
  v_exp_f32 v252, v252
  s_waitcnt lgkmcnt(8)
  v_mfma_f32_32x32x16_bf16 v[128:143], v[208:211], a[132:135], v[128:143]
  ds_read_b64_tr_b16 v[200:201], v14 offset:12288
  ds_read_b64_tr_b16 v[202:203], v14 offset:12800
  v_exp_f32 v253, v253
  v_exp_f32 v254, v254
  v_exp_f32 v255, v255
  v_mfma_f32_32x32x16_bf16 v[160:175], v[212:215], a[132:135], v[160:175]
  ds_read_b64_tr_b16 v[204:205], v15 offset:12288
  ds_read_b64_tr_b16 v[206:207], v15 offset:12800
  v_mul_f32 v120, v120, v104
  v_mul_f32 v121, v121, v105
  s_waitcnt lgkmcnt(8)
  v_mfma_f32_32x32x16_bf16 v[144:159], v[216:219], a[132:135], v[144:159]
  ds_read_b64_tr_b16 v[208:209], v14 offset:6144
  ds_read_b64_tr_b16 v[210:211], v14 offset:6656
  v_mul_f32 v122, v122, v106
  v_mul_f32 v123, v123, v107
  v_mfma_f32_32x32x16_bf16 v[176:191], v[220:223], a[132:135], v[176:191]
  ds_read_b64_tr_b16 v[212:213], v15 offset:6144
  ds_read_b64_tr_b16 v[214:215], v15 offset:6656
  buffer_load_dwordx4 v13, s[52:55], s15 offen offset:3072 lds
  v_fma_f32 v252, v252, v24, v24
  v_fma_f32 v253, v253, v24, v24
  v_fma_f32 v254, v254, v24, v24
  s_waitcnt lgkmcnt(8)
  v_mfma_f32_32x32x16_bf16 v[128:143], v[192:195], a[136:139], v[128:143]
  ds_read_b64_tr_b16 v[216:217], v14 offset:14336
  ds_read_b64_tr_b16 v[218:219], v14 offset:14848
  v_fma_f32 v255, v255, v24, v24
  v_rcp_f32 v252, v252
  v_mfma_f32_32x32x16_bf16 v[160:175], v[196:199], a[136:139], v[160:175]
  ds_read_b64_tr_b16 v[220:221], v15 offset:14336
  ds_read_b64_tr_b16 v[222:223], v15 offset:14848
  v_rcp_f32 v253, v253
  v_rcp_f32 v254, v254
  s_waitcnt lgkmcnt(8)
  v_mfma_f32_32x32x16_bf16 v[144:159], v[200:203], a[136:139], v[144:159]
  v_rcp_f32 v255, v255
  v_mul_f32 v120, v120, v252
  s_waitcnt vmcnt(12)
  s_barrier
  ds_read_b64_tr_b16 v[192:193], v14 offset:16384
  ds_read_b64_tr_b16 v[194:195], v14 offset:16896
  s_add_u32 s15, s85, 663552
  s_add_u32 m0, s82, 81920
  s_nop 0
  buffer_load_dwordx4 v10, s[52:55], s15 offen offset:0 lds
  v_mul_f32 v121, v121, v253
  v_mul_f32 v122, v122, v254
  v_mul_f32 v123, v123, v255
  v_mfma_f32_32x32x16_bf16 v[176:191], v[204:207], a[136:139], v[176:191]
  ds_read_b64_tr_b16 v[196:197], v15 offset:16384
  ds_read_b64_tr_b16 v[198:199], v15 offset:16896
  v_cvt_pk_bf16_f32 v104, v120, v121
  v_cvt_pk_bf16_f32 v105, v122, v123
  s_waitcnt lgkmcnt(8)
  v_mfma_f32_32x32x16_bf16 v[128:143], v[208:211], a[140:143], v[128:143]
  ds_read_b64_tr_b16 v[200:201], v14 offset:24576
  ds_read_b64_tr_b16 v[202:203], v14 offset:25088
  v_mul_f32 v252, v108, v108
  v_mul_f32 v253, v109, v109
  v_mul_f32 v254, v110, v110
  v_mfma_f32_32x32x16_bf16 v[160:175], v[212:215], a[140:143], v[160:175]
  ds_read_b64_tr_b16 v[204:205], v15 offset:24576
  ds_read_b64_tr_b16 v[206:207], v15 offset:25088
  v_mul_f32 v255, v111, v111
  v_fma_f32 v252, v252, v23, v22
  s_waitcnt lgkmcnt(8)
  v_mfma_f32_32x32x16_bf16 v[144:159], v[216:219], a[140:143], v[144:159]
  ds_read_b64_tr_b16 v[208:209], v14 offset:18432
  ds_read_b64_tr_b16 v[210:211], v14 offset:18944
  v_fma_f32 v253, v253, v23, v22
  v_fma_f32 v254, v254, v23, v22
  v_mfma_f32_32x32x16_bf16 v[176:191], v[220:223], a[140:143], v[176:191]
  ds_read_b64_tr_b16 v[212:213], v15 offset:18432
  ds_read_b64_tr_b16 v[214:215], v15 offset:18944
  buffer_load_dwordx4 v11, s[52:55], s15 offen offset:1024 lds
  v_fma_f32 v255, v255, v23, v22
  v_mul_f32 v252, v252, v108
  v_mul_f32 v253, v253, v109
  s_waitcnt lgkmcnt(8)
  v_mfma_f32_32x32x16_bf16 v[128:143], v[192:195], a[144:147], v[128:143]
  ds_read_b64_tr_b16 v[216:217], v14 offset:26624
  ds_read_b64_tr_b16 v[218:219], v14 offset:27136
  v_mul_f32 v254, v254, v110
  v_mul_f32 v255, v255, v111
  v_mfma_f32_32x32x16_bf16 v[160:175], v[196:199], a[144:147], v[160:175]
  ds_read_b64_tr_b16 v[220:221], v15 offset:26624
  ds_read_b64_tr_b16 v[222:223], v15 offset:27136
  v_exp_f32 v252, v252
  v_exp_f32 v253, v253
  s_waitcnt lgkmcnt(8)
  v_mfma_f32_32x32x16_bf16 v[144:159], v[200:203], a[144:147], v[144:159]
  ds_read_b64_tr_b16 v[192:193], v14 offset:20480
  ds_read_b64_tr_b16 v[194:195], v14 offset:20992
  v_exp_f32 v254, v254
  v_exp_f32 v255, v255
  v_mul_f32 v124, v124, v108
  v_mfma_f32_32x32x16_bf16 v[176:191], v[204:207], a[144:147], v[176:191]
  ds_read_b64_tr_b16 v[196:197], v15 offset:20480
  ds_read_b64_tr_b16 v[198:199], v15 offset:20992
  buffer_load_dwordx4 v12, s[52:55], s15 offen offset:2048 lds
  v_mul_f32 v125, v125, v109
  v_mul_f32 v126, v126, v110
  s_waitcnt lgkmcnt(8)
  v_mfma_f32_32x32x16_bf16 v[128:143], v[208:211], a[148:151], v[128:143]
  ds_read_b64_tr_b16 v[200:201], v14 offset:28672
  ds_read_b64_tr_b16 v[202:203], v14 offset:29184
  v_mul_f32 v127, v127, v111
  v_fma_f32 v252, v252, v24, v24
  v_mfma_f32_32x32x16_bf16 v[160:175], v[212:215], a[148:151], v[160:175]
  ds_read_b64_tr_b16 v[204:205], v15 offset:28672
  ds_read_b64_tr_b16 v[206:207], v15 offset:29184
  v_fma_f32 v253, v253, v24, v24
  v_fma_f32 v254, v254, v24, v24
  v_fma_f32 v255, v255, v24, v24
  s_waitcnt lgkmcnt(8)
  v_mfma_f32_32x32x16_bf16 v[144:159], v[216:219], a[148:151], v[144:159]
  ds_read_b64_tr_b16 v[208:209], v14 offset:22528
  ds_read_b64_tr_b16 v[210:211], v14 offset:23040
  v_rcp_f32 v252, v252
  v_rcp_f32 v253, v253
  v_mfma_f32_32x32x16_bf16 v[176:191], v[220:223], a[148:151], v[176:191]
  ds_read_b64_tr_b16 v[212:213], v15 offset:22528
  ds_read_b64_tr_b16 v[214:215], v15 offset:23040
  buffer_load_dwordx4 v13, s[52:55], s15 offen offset:3072 lds
  v_rcp_f32 v254, v254
  v_rcp_f32 v255, v255
  s_waitcnt lgkmcnt(8)
  v_mfma_f32_32x32x16_bf16 v[128:143], v[192:195], a[152:155], v[128:143]
  ds_read_b64_tr_b16 v[216:217], v14 offset:30720
  ds_read_b64_tr_b16 v[218:219], v14 offset:31232
  v_mul_f32 v124, v124, v252
  v_mul_f32 v125, v125, v253
  v_mul_f32 v126, v126, v254
  v_mfma_f32_32x32x16_bf16 v[160:175], v[196:199], a[152:155], v[160:175]
  ds_read_b64_tr_b16 v[220:221], v15 offset:30720
  ds_read_b64_tr_b16 v[222:223], v15 offset:31232
  v_mul_f32 v127, v127, v255
  v_cvt_pk_bf16_f32 v106, v124, v125
  s_waitcnt lgkmcnt(8)
  v_mfma_f32_32x32x16_bf16 v[144:159], v[200:203], a[152:155], v[144:159]
  v_cvt_pk_bf16_f32 v107, v126, v127
  s_add_u32 s8, s96, 131072
  buffer_store_dwordx4 v[104:107], v29, s[56:59], s8 offen offset:512 sc1
  s_waitcnt vmcnt(12)
  s_barrier
  ds_read_b64_tr_b16 v[192:193], v14 offset:32768
  ds_read_b64_tr_b16 v[194:195], v14 offset:33280
  s_add_u32 s15, s85, 884736
  s_add_u32 m0, s82, 0
  s_nop 0
  buffer_load_dwordx4 v10, s[52:55], s15 offen offset:0 lds
  v_mfma_f32_32x32x16_bf16 v[176:191], v[204:207], a[152:155], v[176:191]
  ds_read_b64_tr_b16 v[196:197], v15 offset:32768
  ds_read_b64_tr_b16 v[198:199], v15 offset:33280
  s_waitcnt lgkmcnt(8)
  v_mfma_f32_32x32x16_bf16 v[128:143], v[208:211], a[156:159], v[128:143]
  ds_read_b64_tr_b16 v[200:201], v14 offset:40960
  ds_read_b64_tr_b16 v[202:203], v14 offset:41472
  v_mfma_f32_32x32x16_bf16 v[160:175], v[212:215], a[156:159], v[160:175]
  ds_read_b64_tr_b16 v[204:205], v15 offset:40960
  ds_read_b64_tr_b16 v[206:207], v15 offset:41472
  s_waitcnt lgkmcnt(8)
  v_mfma_f32_32x32x16_bf16 v[144:159], v[216:219], a[156:159], v[144:159]
  ds_read_b64_tr_b16 v[208:209], v14 offset:34816
  ds_read_b64_tr_b16 v[210:211], v14 offset:35328
  v_mfma_f32_32x32x16_bf16 v[176:191], v[220:223], a[156:159], v[176:191]
  ds_read_b64_tr_b16 v[212:213], v15 offset:34816
  ds_read_b64_tr_b16 v[214:215], v15 offset:35328
  buffer_load_dwordx4 v11, s[52:55], s15 offen offset:1024 lds
  s_waitcnt lgkmcnt(8)
  v_mfma_f32_32x32x16_bf16 v[64:79], v[192:195], a[0:3], 0
  ds_read_b64_tr_b16 v[216:217], v14 offset:43008
  ds_read_b64_tr_b16 v[218:219], v14 offset:43520
  ds_read_b32 v236, v30 offset:256
  ds_read_b32 v240, v30 offset:384
  v_mfma_f32_32x32x16_bf16 v[96:111], v[196:199], a[0:3], 0
  ds_read_b64_tr_b16 v[220:221], v15 offset:43008
  ds_read_b64_tr_b16 v[222:223], v15 offset:43520
  ds_read_b32 v244, v30 offset:1280
  s_waitcnt lgkmcnt(11)
  v_mfma_f32_32x32x16_bf16 v[80:95], v[200:203], a[0:3], 0
  ds_read_b64_tr_b16 v[192:193], v14 offset:36864
  ds_read_b64_tr_b16 v[194:195], v14 offset:37376
  ds_read_b32 v248, v30 offset:1408
  v_mfma_f32_32x32x16_bf16 v[112:127], v[204:207], a[0:3], 0
  ds_read_b64_tr_b16 v[196:197], v15 offset:36864
  ds_read_b64_tr_b16 v[198:199], v15 offset:37376
  buffer_load_dwordx4 v12, s[52:55], s15 offen offset:2048 lds
  s_waitcnt lgkmcnt(2)
  v_mfma_f32_32x32x16_bf16 v[64:79], v[208:211], a[4:7], v[64:79]
  ds_read_b64_tr_b16 v[200:201], v14 offset:45056
  ds_read_b64_tr_b16 v[202:203], v14 offset:45568
  v_and_b32 v236, v236, v31
  v_mfma_f32_32x32x16_bf16 v[96:111], v[212:215], a[4:7], v[96:111]
  ds_read_b64_tr_b16 v[204:205], v15 offset:45056
  ds_read_b64_tr_b16 v[206:207], v15 offset:45568
  v_and_b32 v240, v240, v31
  v_and_b32 v244, v244, v31
  v_mfma_f32_32x32x16_bf16 v[80:95], v[216:219], a[4:7], v[80:95]
  ds_read_b64_tr_b16 v[208:209], v14 offset:38912
  ds_read_b64_tr_b16 v[210:211], v14 offset:39424
  v_and_b32 v248, v248, v31
  v_mfma_f32_32x32x16_bf16 v[112:127], v[220:223], a[4:7], v[112:127]
  ds_read_b64_tr_b16 v[212:213], v15 offset:38912
  ds_read_b64_tr_b16 v[214:215], v15 offset:39424
  buffer_load_dwordx4 v13, s[52:55], s15 offen offset:3072 lds
  v_mfma_f32_32x32x16_bf16 v[128:143], v[236:239], a[160:163], v[128:143]
  s_waitcnt lgkmcnt(8)
  v_mfma_f32_32x32x16_bf16 v[64:79], v[192:195], a[8:11], v[64:79]
  ds_read_b64_tr_b16 v[216:217], v14 offset:47104
  ds_read_b64_tr_b16 v[218:219], v14 offset:47616
  v_mfma_f32_32x32x16_bf16 v[160:175], v[240:243], a[160:163], v[160:175]
  v_mfma_f32_32x32x16_bf16 v[96:111], v[196:199], a[8:11], v[96:111]
  ds_read_b64_tr_b16 v[220:221], v15 offset:47104
  ds_read_b64_tr_b16 v[222:223], v15 offset:47616
  v_mfma_f32_32x32x16_bf16 v[144:159], v[244:247], a[160:163], v[144:159]
  s_waitcnt lgkmcnt(8)
  v_mfma_f32_32x32x16_bf16 v[80:95], v[200:203], a[8:11], v[80:95]
  v_mfma_f32_32x32x16_bf16 v[176:191], v[248:251], a[160:163], v[176:191]
  s_waitcnt vmcnt(12)
  s_barrier
  ds_read_b64_tr_b16 v[192:193], v14 offset:49152
  ds_read_b64_tr_b16 v[194:195], v14 offset:49664
  s_add_u32 s15, s85, 1105920
  s_add_u32 m0, s82, 16384
  s_nop 0
  buffer_load_dwordx4 v10, s[52:55], s15 offen offset:0 lds
  s_and_b32 s8, s2, 7
  s_lshr_b32 s9, s2, 3
  s_lshr_b32 s10, s8, 1
  s_lshl_b32 s10, s10, 3
  s_lshr_b32 s11, s9, 2
  s_add_u32 s10, s10, s11
  s_lshl_b32 s81, s10, 12
  s_and_b32 s8, s8, 1
  s_lshl_b32 s8, s8, 2
  s_and_b32 s9, s9, 3
  s_add_u32 s9, s9, s8
  s_mul_i32 s80, s9, 5120
  s_mul_i32 s8, s3, 20
  s_cmp_eq_u32 s3, 3
  s_cselect_b32 s8, 67, s8
  s_sub_u32 s9, 94, s8
  s_mul_i32 s10, s8, 131072
  s_add_u32 s10, s10, 0x400000
  s_add_u32 s72, s46, s10
  s_addc_u32 s73, s47, 0
  s_mov_b32 s74, 0
  s_mov_b32 s75, 0x20000
  s_mul_i32 s74, s9, 131072
  s_mul_i32 s10, s8, 40960
  s_add_u32 s76, s46, s10
  s_addc_u32 s77, s47, 0
  s_mov_b32 s78, 0
  s_mov_b32 s79, 0x20000
  s_mul_i32 s78, s9, 40960
  v_lshlrev_b32 v54, 4, v1
  v_mfma_f32_32x32x16_bf16 v[112:127], v[204:207], a[8:11], v[112:127]
  ds_read_b64_tr_b16 v[196:197], v15 offset:49152
  ds_read_b64_tr_b16 v[198:199], v15 offset:49664
  v_add_u32 v56, 4096, v54
  s_mov_b32 s93, 0x10b0000
  buffer_load_dwordx4 v[40:43], v54, s[56:59], s93 offen sc1
  s_waitcnt lgkmcnt(8)
  v_mfma_f32_32x32x16_bf16 v[64:79], v[208:211], a[12:15], v[64:79]
  ds_read_b64_tr_b16 v[200:201], v14 offset:57344
  ds_read_b64_tr_b16 v[202:203], v14 offset:57856
  v_mul_f32 v252, v128, v128
  v_mul_f32 v253, v129, v129
  v_mfma_f32_32x32x16_bf16 v[96:111], v[212:215], a[12:15], v[96:111]
  ds_read_b64_tr_b16 v[204:205], v15 offset:57344
  ds_read_b64_tr_b16 v[206:207], v15 offset:57856
  v_mul_f32 v254, v130, v130
  v_mul_f32 v255, v131, v131
  s_waitcnt lgkmcnt(8)
  v_mfma_f32_32x32x16_bf16 v[80:95], v[216:219], a[12:15], v[80:95]
  ds_read_b64_tr_b16 v[208:209], v14 offset:51200
  ds_read_b64_tr_b16 v[210:211], v14 offset:51712
  v_fma_f32 v252, v252, v23, v22
  v_fma_f32 v253, v253, v23, v22
  v_mfma_f32_32x32x16_bf16 v[112:127], v[220:223], a[12:15], v[112:127]
  ds_read_b64_tr_b16 v[212:213], v15 offset:51200
  ds_read_b64_tr_b16 v[214:215], v15 offset:51712
  buffer_load_dwordx4 v11, s[52:55], s15 offen offset:1024 lds
  v_fma_f32 v254, v254, v23, v22
  v_fma_f32 v255, v255, v23, v22
  s_waitcnt lgkmcnt(8)
  v_mfma_f32_32x32x16_bf16 v[64:79], v[192:195], a[16:19], v[64:79]
  ds_read_b64_tr_b16 v[216:217], v14 offset:59392
  ds_read_b64_tr_b16 v[218:219], v14 offset:59904
  v_mul_f32 v252, v252, v128
  v_mul_f32 v253, v253, v129
  v_mfma_f32_32x32x16_bf16 v[96:111], v[196:199], a[16:19], v[96:111]
  ds_read_b64_tr_b16 v[220:221], v15 offset:59392
  ds_read_b64_tr_b16 v[222:223], v15 offset:59904
  v_mul_f32 v254, v254, v130
  v_mul_f32 v255, v255, v131
  s_waitcnt lgkmcnt(8)
  v_mfma_f32_32x32x16_bf16 v[80:95], v[200:203], a[16:19], v[80:95]
  ds_read_b64_tr_b16 v[192:193], v14 offset:53248
  ds_read_b64_tr_b16 v[194:195], v14 offset:53760
  v_exp_f32 v252, v252
  v_exp_f32 v253, v253
  v_mfma_f32_32x32x16_bf16 v[112:127], v[204:207], a[16:19], v[112:127]
  ds_read_b64_tr_b16 v[196:197], v15 offset:53248
  ds_read_b64_tr_b16 v[198:199], v15 offset:53760
  buffer_load_dwordx4 v12, s[52:55], s15 offen offset:2048 lds
  v_exp_f32 v254, v254
  v_exp_f32 v255, v255
  s_waitcnt lgkmcnt(8)
  v_mfma_f32_32x32x16_bf16 v[64:79], v[208:211], a[20:23], v[64:79]
  ds_read_b64_tr_b16 v[200:201], v14 offset:61440
  ds_read_b64_tr_b16 v[202:203], v14 offset:61952
  v_mul_f32 v144, v144, v128
  v_mul_f32 v145, v145, v129
  v_mfma_f32_32x32x16_bf16 v[96:111], v[212:215], a[20:23], v[96:111]
  ds_read_b64_tr_b16 v[204:205], v15 offset:61440
  ds_read_b64_tr_b16 v[206:207], v15 offset:61952
  v_mul_f32 v146, v146, v130
  v_mul_f32 v147, v147, v131
  s_waitcnt lgkmcnt(8)
  v_mfma_f32_32x32x16_bf16 v[80:95], v[216:219], a[20:23], v[80:95]
  ds_read_b64_tr_b16 v[208:209], v14 offset:55296
  ds_read_b64_tr_b16 v[210:211], v14 offset:55808
  v_fma_f32 v252, v252, v24, v24
  v_fma_f32 v253, v253, v24, v24
  v_mfma_f32_32x32x16_bf16 v[112:127], v[220:223], a[20:23], v[112:127]
  ds_read_b64_tr_b16 v[212:213], v15 offset:55296
  ds_read_b64_tr_b16 v[214:215], v15 offset:55808
  buffer_load_dwordx4 v13, s[52:55], s15 offen offset:3072 lds
  v_fma_f32 v254, v254, v24, v24
  v_fma_f32 v255, v255, v24, v24
  s_waitcnt lgkmcnt(8)
  v_mfma_f32_32x32x16_bf16 v[64:79], v[192:195], a[24:27], v[64:79]
  ds_read_b64_tr_b16 v[216:217], v14 offset:63488
  ds_read_b64_tr_b16 v[218:219], v14 offset:64000
  v_rcp_f32 v252, v252
  v_rcp_f32 v253, v253
  v_mfma_f32_32x32x16_bf16 v[96:111], v[196:199], a[24:27], v[96:111]
  ds_read_b64_tr_b16 v[220:221], v15 offset:63488
  ds_read_b64_tr_b16 v[222:223], v15 offset:64000
  v_rcp_f32 v254, v254
  v_rcp_f32 v255, v255
  s_waitcnt lgkmcnt(8)
  v_mfma_f32_32x32x16_bf16 v[80:95], v[200:203], a[24:27], v[80:95]
  v_mul_f32 v144, v144, v252
  v_mul_f32 v145, v145, v253
  s_waitcnt vmcnt(13)
  s_barrier
  ds_read_b64_tr_b16 v[192:193], v16 offset:0
  ds_read_b64_tr_b16 v[194:195], v16 offset:512
  s_add_u32 s15, s85, 1327104
  s_add_u32 m0, s82, 32768
  s_nop 0
  buffer_load_dwordx4 v10, s[52:55], s15 offen offset:0 lds
  v_mul_f32 v146, v146, v254
  v_mul_f32 v147, v147, v255
  v_mfma_f32_32x32x16_bf16 v[112:127], v[204:207], a[24:27], v[112:127]
  ds_read_b64_tr_b16 v[196:197], v17 offset:0
  ds_read_b64_tr_b16 v[198:199], v17 offset:512
  v_cvt_pk_bf16_f32 v128, v144, v145
  v_cvt_pk_bf16_f32 v129, v146, v147
  s_waitcnt lgkmcnt(8)
  v_mfma_f32_32x32x16_bf16 v[64:79], v[208:211], a[28:31], v[64:79]
  ds_read_b64_tr_b16 v[200:201], v16 offset:8192
  ds_read_b64_tr_b16 v[202:203], v16 offset:8704
  v_mul_f32 v252, v132, v132
  v_mul_f32 v253, v133, v133
  v_mfma_f32_32x32x16_bf16 v[96:111], v[212:215], a[28:31], v[96:111]
  ds_read_b64_tr_b16 v[204:205], v17 offset:8192
  ds_read_b64_tr_b16 v[206:207], v17 offset:8704
  v_mul_f32 v254, v134, v134
  v_mul_f32 v255, v135, v135
  s_waitcnt lgkmcnt(8)
  v_mfma_f32_32x32x16_bf16 v[80:95], v[216:219], a[28:31], v[80:95]
  ds_read_b64_tr_b16 v[208:209], v16 offset:2048
  ds_read_b64_tr_b16 v[210:211], v16 offset:2560
  v_fma_f32 v252, v252, v23, v22
  v_fma_f32 v253, v253, v23, v22
  v_mfma_f32_32x32x16_bf16 v[112:127], v[220:223], a[28:31], v[112:127]
  ds_read_b64_tr_b16 v[212:213], v17 offset:2048
  ds_read_b64_tr_b16 v[214:215], v17 offset:2560
  buffer_load_dwordx4 v11, s[52:55], s15 offen offset:1024 lds
  v_fma_f32 v254, v254, v23, v22
  s_waitcnt lgkmcnt(8)
  v_mfma_f32_32x32x16_bf16 v[64:79], v[192:195], a[32:35], v[64:79]
  ds_read_b64_tr_b16 v[216:217], v16 offset:10240
  ds_read_b64_tr_b16 v[218:219], v16 offset:10752
  v_fma_f32 v255, v255, v23, v22
  v_mul_f32 v252, v252, v132
  v_mfma_f32_32x32x16_bf16 v[96:111], v[196:199], a[32:35], v[96:111]
  ds_read_b64_tr_b16 v[220:221], v17 offset:10240
  ds_read_b64_tr_b16 v[222:223], v17 offset:10752
  v_mul_f32 v253, v253, v133
  v_mul_f32 v254, v254, v134
  s_waitcnt lgkmcnt(8)
  v_mfma_f32_32x32x16_bf16 v[80:95], v[200:203], a[32:35], v[80:95]
  ds_read_b64_tr_b16 v[192:193], v16 offset:4096
  ds_read_b64_tr_b16 v[194:195], v16 offset:4608
  v_mul_f32 v255, v255, v135
  v_exp_f32 v252, v252
  v_mfma_f32_32x32x16_bf16 v[112:127], v[204:207], a[32:35], v[112:127]
  ds_read_b64_tr_b16 v[196:197], v17 offset:4096
  ds_read_b64_tr_b16 v[198:199], v17 offset:4608
  buffer_load_dwordx4 v12, s[52:55], s15 offen offset:2048 lds
  v_exp_f32 v253, v253
  v_exp_f32 v254, v254
  s_waitcnt lgkmcnt(8)
  v_mfma_f32_32x32x16_bf16 v[64:79], v[208:211], a[36:39], v[64:79]
  ds_read_b64_tr_b16 v[200:201], v16 offset:12288
  ds_read_b64_tr_b16 v[202:203], v16 offset:12800
  v_exp_f32 v255, v255
  v_mul_f32 v148, v148, v132
  v_mfma_f32_32x32x16_bf16 v[96:111], v[212:215], a[36:39], v[96:111]
  ds_read_b64_tr_b16 v[204:205], v17 offset:12288
  ds_read_b64_tr_b16 v[206:207], v17 offset:12800
  v_mul_f32 v149, v149, v133
  s_waitcnt lgkmcnt(8)
  v_mfma_f32_32x32x16_bf16 v[80:95], v[216:219], a[36:39], v[80:95]
  ds_read_b64_tr_b16 v[208:209], v16 offset:6144
  ds_read_b64_tr_b16 v[210:211], v16 offset:6656
  v_mul_f32 v150, v150, v134
  v_mul_f32 v151, v151, v135
  v_mfma_f32_32x32x16_bf16 v[112:127], v[220:223], a[36:39], v[112:127]
  ds_read_b64_tr_b16 v[212:213], v17 offset:6144
  ds_read_b64_tr_b16 v[214:215], v17 offset:6656
  buffer_load_dwordx4 v13, s[52:55], s15 offen offset:3072 lds
  v_fma_f32 v252, v252, v24, v24
  v_fma_f32 v253, v253, v24, v24
  s_waitcnt lgkmcnt(8)
  v_mfma_f32_32x32x16_bf16 v[64:79], v[192:195], a[40:43], v[64:79]
  ds_read_b64_tr_b16 v[216:217], v16 offset:14336
  ds_read_b64_tr_b16 v[218:219], v16 offset:14848
  v_fma_f32 v254, v254, v24, v24
  v_fma_f32 v255, v255, v24, v24
  v_mfma_f32_32x32x16_bf16 v[96:111], v[196:199], a[40:43], v[96:111]
  ds_read_b64_tr_b16 v[220:221], v17 offset:14336
  ds_read_b64_tr_b16 v[222:223], v17 offset:14848
  v_rcp_f32 v252, v252
  v_rcp_f32 v253, v253
  s_waitcnt lgkmcnt(8)
  v_mfma_f32_32x32x16_bf16 v[80:95], v[200:203], a[40:43], v[80:95]
  v_rcp_f32 v254, v254
  s_waitcnt vmcnt(13)
  s_barrier
  ds_read_b64_tr_b16 v[192:193], v16 offset:16384
  ds_read_b64_tr_b16 v[194:195], v16 offset:16896
  s_add_u32 s15, s85, 1548288
  s_add_u32 m0, s82, 49152
  s_nop 0
  buffer_load_dwordx4 v10, s[52:55], s15 offen offset:0 lds
  v_rcp_f32 v255, v255
  v_mul_f32 v148, v148, v252
  v_mfma_f32_32x32x16_bf16 v[112:127], v[204:207], a[40:43], v[112:127]
  ds_read_b64_tr_b16 v[196:197], v17 offset:16384
  ds_read_b64_tr_b16 v[198:199], v17 offset:16896
  v_mul_f32 v149, v149, v253
  v_mul_f32 v150, v150, v254
  s_waitcnt lgkmcnt(8)
  v_mfma_f32_32x32x16_bf16 v[64:79], v[208:211], a[44:47], v[64:79]
  ds_read_b64_tr_b16 v[200:201], v16 offset:24576
  ds_read_b64_tr_b16 v[202:203], v16 offset:25088
  v_mul_f32 v151, v151, v255
  v_cvt_pk_bf16_f32 v130, v148, v149
  v_mfma_f32_32x32x16_bf16 v[96:111], v[212:215], a[44:47], v[96:111]
  ds_read_b64_tr_b16 v[204:205], v17 offset:24576
  ds_read_b64_tr_b16 v[206:207], v17 offset:25088
  v_cvt_pk_bf16_f32 v131, v150, v151
  buffer_store_dwordx4 v[128:131], v29, s[56:59], s97 offen offset:0 sc1
  s_waitcnt lgkmcnt(8)
  v_mfma_f32_32x32x16_bf16 v[80:95], v[216:219], a[44:47], v[80:95]
  ds_read_b64_tr_b16 v[208:209], v16 offset:18432
  ds_read_b64_tr_b16 v[210:211], v16 offset:18944
  v_mul_f32 v252, v136, v136
  v_mul_f32 v253, v137, v137
  v_mfma_f32_32x32x16_bf16 v[112:127], v[220:223], a[44:47], v[112:127]
  ds_read_b64_tr_b16 v[212:213], v17 offset:18432
  ds_read_b64_tr_b16 v[214:215], v17 offset:18944
  buffer_load_dwordx4 v11, s[52:55], s15 offen offset:1024 lds
  v_mul_f32 v254, v138, v138
  s_waitcnt lgkmcnt(8)
  v_mfma_f32_32x32x16_bf16 v[64:79], v[192:195], a[48:51], v[64:79]
  ds_read_b64_tr_b16 v[216:217], v16 offset:26624
  ds_read_b64_tr_b16 v[218:219], v16 offset:27136
  v_mul_f32 v255, v139, v139
  v_fma_f32 v252, v252, v23, v22
  v_mfma_f32_32x32x16_bf16 v[96:111], v[196:199], a[48:51], v[96:111]
  ds_read_b64_tr_b16 v[220:221], v17 offset:26624
  ds_read_b64_tr_b16 v[222:223], v17 offset:27136
  v_fma_f32 v253, v253, v23, v22
  v_fma_f32 v254, v254, v23, v22
  s_waitcnt lgkmcnt(8)
  v_mfma_f32_32x32x16_bf16 v[80:95], v[200:203], a[48:51], v[80:95]
  ds_read_b64_tr_b16 v[192:193], v16 offset:20480
  ds_read_b64_tr_b16 v[194:195], v16 offset:20992
  v_fma_f32 v255, v255, v23, v22
  v_mul_f32 v252, v252, v136
  v_mfma_f32_32x32x16_bf16 v[112:127], v[204:207], a[48:51], v[112:127]
  ds_read_b64_tr_b16 v[196:197], v17 offset:20480
  ds_read_b64_tr_b16 v[198:199], v17 offset:20992
  buffer_load_dwordx4 v12, s[52:55], s15 offen offset:2048 lds
  v_mul_f32 v253, v253, v137
  v_mul_f32 v254, v254, v138
  s_waitcnt lgkmcnt(8)
  v_mfma_f32_32x32x16_bf16 v[64:79], v[208:211], a[52:55], v[64:79]
  ds_read_b64_tr_b16 v[200:201], v16 offset:28672
  ds_read_b64_tr_b16 v[202:203], v16 offset:29184
  v_mul_f32 v255, v255, v139
  v_exp_f32 v252, v252
  v_mfma_f32_32x32x16_bf16 v[96:111], v[212:215], a[52:55], v[96:111]
  ds_read_b64_tr_b16 v[204:205], v17 offset:28672
  ds_read_b64_tr_b16 v[206:207], v17 offset:29184
  v_exp_f32 v253, v253
  s_waitcnt lgkmcnt(8)
  v_mfma_f32_32x32x16_bf16 v[80:95], v[216:219], a[52:55], v[80:95]
  ds_read_b64_tr_b16 v[208:209], v16 offset:22528
  ds_read_b64_tr_b16 v[210:211], v16 offset:23040
  v_exp_f32 v254, v254
  v_exp_f32 v255, v255
  v_mfma_f32_32x32x16_bf16 v[112:127], v[220:223], a[52:55], v[112:127]
  ds_read_b64_tr_b16 v[212:213], v17 offset:22528
  ds_read_b64_tr_b16 v[214:215], v17 offset:23040
  buffer_load_dwordx4 v13, s[52:55], s15 offen offset:3072 lds
  v_mul_f32 v152, v152, v136
  v_mul_f32 v153, v153, v137
  s_waitcnt lgkmcnt(8)
  v_mfma_f32_32x32x16_bf16 v[64:79], v[192:195], a[56:59], v[64:79]
  ds_read_b64_tr_b16 v[216:217], v16 offset:30720
  ds_read_b64_tr_b16 v[218:219], v16 offset:31232
  v_mul_f32 v154, v154, v138
  v_mul_f32 v155, v155, v139
  v_mfma_f32_32x32x16_bf16 v[96:111], v[196:199], a[56:59], v[96:111]
  ds_read_b64_tr_b16 v[220:221], v17 offset:30720
  ds_read_b64_tr_b16 v[222:223], v17 offset:31232
  v_fma_f32 v252, v252, v24, v24
  v_fma_f32 v253, v253, v24, v24
  s_waitcnt lgkmcnt(8)
  v_mfma_f32_32x32x16_bf16 v[80:95], v[200:203], a[56:59], v[80:95]
  v_fma_f32 v254, v254, v24, v24
  s_waitcnt vmcnt(13)
  s_barrier
  ds_read_b64_tr_b16 v[192:193], v14 offset:0
  ds_read_b64_tr_b16 v[194:195], v14 offset:512
  s_add_u32 s15, s85, 1769472
  s_add_u32 m0, s82, 65536
  s_nop 0
  buffer_load_dwordx4 v10, s[52:55], s15 offen offset:0 lds
  s_waitcnt vmcnt(12)
  s_mov_b64 s[12:13], 0
  v_cmp_ne_u32 vcc, s6, v40
  s_nop 0
  s_or_b64 s[12:13], s[12:13], vcc
  v_cmp_ne_u32 vcc, s6, v41
  s_nop 0
  s_or_b64 s[12:13], s[12:13], vcc
  v_cmp_ne_u32 vcc, s6, v42
  s_nop 0
  s_or_b64 s[12:13], s[12:13], vcc
  v_cmp_ne_u32 vcc, s6, v43
  s_nop 0
  s_or_b64 s[12:13], s[12:13], vcc
  s_cmp_eq_u64 s[12:13], 0
  s_cbranch_scc0 L_slow_11
L_back_12:
  v_mfma_f32_32x32x16_bf16 v[112:127], v[204:207], a[56:59], v[112:127]
  ds_read_b64_tr_b16 v[196:197], v15 offset:0
  ds_read_b64_tr_b16 v[198:199], v15 offset:512
  v_fma_f32 v255, v255, v24, v24
  v_rcp_f32 v252, v252
  s_waitcnt lgkmcnt(8)
  v_mfma_f32_32x32x16_bf16 v[64:79], v[208:211], a[60:63], v[64:79]
  ds_read_b64_tr_b16 v[200:201], v14 offset:8192
  ds_read_b64_tr_b16 v[202:203], v14 offset:8704
  v_rcp_f32 v253, v253
  v_rcp_f32 v254, v254
  v_mfma_f32_32x32x16_bf16 v[96:111], v[212:215], a[60:63], v[96:111]
  ds_read_b64_tr_b16 v[204:205], v15 offset:8192
  ds_read_b64_tr_b16 v[206:207], v15 offset:8704
  v_rcp_f32 v255, v255
  v_mul_f32 v152, v152, v252
  s_waitcnt lgkmcnt(8)
  v_mfma_f32_32x32x16_bf16 v[80:95], v[216:219], a[60:63], v[80:95]
  ds_read_b64_tr_b16 v[208:209], v14 offset:2048
  ds_read_b64_tr_b16 v[210:211], v14 offset:2560
  v_mul_f32 v153, v153, v253
  v_mul_f32 v154, v154, v254
  v_mfma_f32_32x32x16_bf16 v[112:127], v[220:223], a[60:63], v[112:127]
  ds_read_b64_tr_b16 v[212:213], v15 offset:2048
  ds_read_b64_tr_b16 v[214:215], v15 offset:2560
  s_add_u32 m0, s82, 65536
  s_nop 0
  buffer_load_dwordx4 v11, s[52:55], s15 offen offset:1024 lds
  v_mul_f32 v155, v155, v255
  v_cvt_pk_bf16_f32 v136, v152, v153
  s_waitcnt lgkmcnt(8)
  v_mfma_f32_32x32x16_bf16 v[64:79], v[192:195], a[64:67], v[64:79]
  ds_read_b64_tr_b16 v[216:217], v14 offset:10240
  ds_read_b64_tr_b16 v[218:219], v14 offset:10752
  v_cvt_pk_bf16_f32 v137, v154, v155
  v_mul_f32 v252, v140, v140
  v_mfma_f32_32x32x16_bf16 v[96:111], v[196:199], a[64:67], v[96:111]
  ds_read_b64_tr_b16 v[220:221], v15 offset:10240
  ds_read_b64_tr_b16 v[222:223], v15 offset:10752
  v_mul_f32 v253, v141, v141
  v_mul_f32 v254, v142, v142
  s_waitcnt lgkmcnt(8)
  v_mfma_f32_32x32x16_bf16 v[80:95], v[200:203], a[64:67], v[80:95]
  ds_read_b64_tr_b16 v[192:193], v14 offset:4096
  ds_read_b64_tr_b16 v[194:195], v14 offset:4608
  v_mul_f32 v255, v143, v143
  v_mfma_f32_32x32x16_bf16 v[112:127], v[204:207], a[64:67], v[112:127]
  ds_read_b64_tr_b16 v[196:197], v15 offset:4096
  ds_read_b64_tr_b16 v[198:199], v15 offset:4608
  buffer_load_dwordx4 v12, s[52:55], s15 offen offset:2048 lds
  v_fma_f32 v252, v252, v23, v22
  v_fma_f32 v253, v253, v23, v22
  s_waitcnt lgkmcnt(8)
  v_mfma_f32_32x32x16_bf16 v[64:79], v[208:211], a[68:71], v[64:79]
  ds_read_b64_tr_b16 v[200:201], v14 offset:12288
  ds_read_b64_tr_b16 v[202:203], v14 offset:12800
  v_fma_f32 v254, v254, v23, v22
  v_fma_f32 v255, v255, v23, v22
  v_mfma_f32_32x32x16_bf16 v[96:111], v[212:215], a[68:71], v[96:111]
  ds_read_b64_tr_b16 v[204:205], v15 offset:12288
  ds_read_b64_tr_b16 v[206:207], v15 offset:12800
  v_mul_f32 v252, v252, v140
  v_mul_f32 v253, v253, v141
  s_waitcnt lgkmcnt(8)
  v_mfma_f32_32x32x16_bf16 v[80:95], v[216:219], a[68:71], v[80:95]
  ds_read_b64_tr_b16 v[208:209], v14 offset:6144
  ds_read_b64_tr_b16 v[210:211], v14 offset:6656
  v_mul_f32 v254, v254, v142
  v_mul_f32 v255, v255, v143
  v_mfma_f32_32x32x16_bf16 v[112:127], v[220:223], a[68:71], v[112:127]
  ds_read_b64_tr_b16 v[212:213], v15 offset:6144
  ds_read_b64_tr_b16 v[214:215], v15 offset:6656
  buffer_load_dwordx4 v13, s[52:55], s15 offen offset:3072 lds
  v_exp_f32 v252, v252
  v_exp_f32 v253, v253
  s_waitcnt lgkmcnt(8)
  v_mfma_f32_32x32x16_bf16 v[64:79], v[192:195], a[72:75], v[64:79]
  ds_read_b64_tr_b16 v[216:217], v14 offset:14336
  ds_read_b64_tr_b16 v[218:219], v14 offset:14848
  v_exp_f32 v254, v254
  v_exp_f32 v255, v255
  v_mfma_f32_32x32x16_bf16 v[96:111], v[196:199], a[72:75], v[96:111]
  ds_read_b64_tr_b16 v[220:221], v15 offset:14336
  ds_read_b64_tr_b16 v[222:223], v15 offset:14848
  v_mul_f32 v156, v156, v140
  v_mul_f32 v157, v157, v141
  s_waitcnt lgkmcnt(8)
  v_mfma_f32_32x32x16_bf16 v[80:95], v[200:203], a[72:75], v[80:95]
  v_mul_f32 v158, v158, v142
  s_waitcnt vmcnt(12)
  s_barrier
  ds_read_b64_tr_b16 v[192:193], v14 offset:16384
  ds_read_b64_tr_b16 v[194:195], v14 offset:16896
  s_add_u32 s15, s85, 1990656
  s_add_u32 m0, s82, 81920
  s_nop 0
  buffer_load_dwordx4 v10, s[52:55], s15 offen offset:0 lds
  v_mul_f32 v159, v159, v143
  v_fma_f32 v252, v252, v24, v24
  v_mfma_f32_32x32x16_bf16 v[112:127], v[204:207], a[72:75], v[112:127]
  ds_read_b64_tr_b16 v[196:197], v15 offset:16384
  ds_read_b64_tr_b16 v[198:199], v15 offset:16896
  v_fma_f32 v253, v253, v24, v24
  v_fma_f32 v254, v254, v24, v24
  s_waitcnt lgkmcnt(8)
  v_mfma_f32_32x32x16_bf16 v[64:79], v[208:211], a[76:79], v[64:79]
  ds_read_b64_tr_b16 v[200:201], v14 offset:24576
  ds_read_b64_tr_b16 v[202:203], v14 offset:25088
  v_fma_f32 v255, v255, v24, v24
  v_rcp_f32 v252, v252
  v_mfma_f32_32x32x16_bf16 v[96:111], v[212:215], a[76:79], v[96:111]
  ds_read_b64_tr_b16 v[204:205], v15 offset:24576
  ds_read_b64_tr_b16 v[206:207], v15 offset:25088
  v_rcp_f32 v253, v253
  v_rcp_f32 v254, v254
  s_waitcnt lgkmcnt(8)
  v_mfma_f32_32x32x16_bf16 v[80:95], v[216:219], a[76:79], v[80:95]
  ds_read_b64_tr_b16 v[208:209], v14 offset:18432
  ds_read_b64_tr_b16 v[210:211], v14 offset:18944
  v_rcp_f32 v255, v255
  v_mul_f32 v156, v156, v252
  v_mfma_f32_32x32x16_bf16 v[112:127], v[220:223], a[76:79], v[112:127]
  ds_read_b64_tr_b16 v[212:213], v15 offset:18432
  ds_read_b64_tr_b16 v[214:215], v15 offset:18944
  buffer_load_dwordx4 v11, s[52:55], s15 offen offset:1024 lds
  v_mul_f32 v157, v157, v253
  s_waitcnt lgkmcnt(8)
  v_mfma_f32_32x32x16_bf16 v[64:79], v[192:195], a[80:83], v[64:79]
  ds_read_b64_tr_b16 v[216:217], v14 offset:26624
  ds_read_b64_tr_b16 v[218:219], v14 offset:27136
  v_mul_f32 v158, v158, v254
  v_mul_f32 v159, v159, v255
  v_mfma_f32_32x32x16_bf16 v[96:111], v[196:199], a[80:83], v[96:111]
  ds_read_b64_tr_b16 v[220:221], v15 offset:26624
  ds_read_b64_tr_b16 v[222:223], v15 offset:27136
  v_cvt_pk_bf16_f32 v138, v156, v157
  v_cvt_pk_bf16_f32 v139, v158, v159
  s_waitcnt lgkmcnt(8)
  v_mfma_f32_32x32x16_bf16 v[80:95], v[200:203], a[80:83], v[80:95]
  ds_read_b64_tr_b16 v[192:193], v14 offset:20480
  ds_read_b64_tr_b16 v[194:195], v14 offset:20992
  buffer_store_dwordx4 v[136:139], v29, s[56:59], s97 offen offset:512 sc1
  v_mul_f32 v252, v160, v160
  v_mfma_f32_32x32x16_bf16 v[112:127], v[204:207], a[80:83], v[112:127]
  ds_read_b64_tr_b16 v[196:197], v15 offset:20480
  ds_read_b64_tr_b16 v[198:199], v15 offset:20992
  buffer_load_dwordx4 v12, s[52:55], s15 offen offset:2048 lds
  v_mul_f32 v253, v161, v161
  v_mul_f32 v254, v162, v162
  s_waitcnt lgkmcnt(8)
  v_mfma_f32_32x32x16_bf16 v[64:79], v[208:211], a[84:87], v[64:79]
  ds_read_b64_tr_b16 v[200:201], v14 offset:28672
  ds_read_b64_tr_b16 v[202:203], v14 offset:29184
  v_mul_f32 v255, v163, v163
  v_fma_f32 v252, v252, v23, v22
  v_mfma_f32_32x32x16_bf16 v[96:111], v[212:215], a[84:87], v[96:111]
  ds_read_b64_tr_b16 v[204:205], v15 offset:28672
  ds_read_b64_tr_b16 v[206:207], v15 offset:29184
  v_fma_f32 v253, v253, v23, v22
  s_waitcnt lgkmcnt(8)
  v_mfma_f32_32x32x16_bf16 v[80:95], v[216:219], a[84:87], v[80:95]
  ds_read_b64_tr_b16 v[208:209], v14 offset:22528
  ds_read_b64_tr_b16 v[210:211], v14 offset:23040
  v_fma_f32 v254, v254, v23, v22
  v_fma_f32 v255, v255, v23, v22
  v_mfma_f32_32x32x16_bf16 v[112:127], v[220:223], a[84:87], v[112:127]
  ds_read_b64_tr_b16 v[212:213], v15 offset:22528
  ds_read_b64_tr_b16 v[214:215], v15 offset:23040
  buffer_load_dwordx4 v13, s[52:55], s15 offen offset:3072 lds
  v_mul_f32 v252, v252, v160
  v_mul_f32 v253, v253, v161
  s_waitcnt lgkmcnt(8)
  v_mfma_f32_32x32x16_bf16 v[64:79], v[192:195], a[88:91], v[64:79]
  ds_read_b64_tr_b16 v[216:217], v14 offset:30720
  ds_read_b64_tr_b16 v[218:219], v14 offset:31232
  v_mul_f32 v254, v254, v162
  v_mul_f32 v255, v255, v163
  v_mfma_f32_32x32x16_bf16 v[96:111], v[196:199], a[88:91], v[96:111]
  ds_read_b64_tr_b16 v[220:221], v15 offset:30720
  ds_read_b64_tr_b16 v[222:223], v15 offset:31232
  v_exp_f32 v252, v252
  v_exp_f32 v253, v253
  s_waitcnt lgkmcnt(8)
  v_mfma_f32_32x32x16_bf16 v[80:95], v[200:203], a[88:91], v[80:95]
  v_exp_f32 v254, v254
  s_waitcnt vmcnt(12)
  s_barrier
  ds_read_b64_tr_b16 v[192:193], v14 offset:32768
  ds_read_b64_tr_b16 v[194:195], v14 offset:33280
  v_exp_f32 v255, v255
  v_mul_f32 v176, v176, v160
  v_mfma_f32_32x32x16_bf16 v[112:127], v[204:207], a[88:91], v[112:127]
  ds_read_b64_tr_b16 v[196:197], v15 offset:32768
  ds_read_b64_tr_b16 v[198:199], v15 offset:33280
  v_mul_f32 v177, v177, v161
  v_mul_f32 v178, v178, v162
  s_waitcnt lgkmcnt(8)
  v_mfma_f32_32x32x16_bf16 v[64:79], v[208:211], a[92:95], v[64:79]
  ds_read_b64_tr_b16 v[200:201], v14 offset:40960
  ds_read_b64_tr_b16 v[202:203], v14 offset:41472
  v_mul_f32 v179, v179, v163
  v_fma_f32 v252, v252, v24, v24
  v_mfma_f32_32x32x16_bf16 v[96:111], v[212:215], a[92:95], v[96:111]
  ds_read_b64_tr_b16 v[204:205], v15 offset:40960
  ds_read_b64_tr_b16 v[206:207], v15 offset:41472
  v_fma_f32 v253, v253, v24, v24
  v_fma_f32 v254, v254, v24, v24
  s_waitcnt lgkmcnt(8)
  v_mfma_f32_32x32x16_bf16 v[80:95], v[216:219], a[92:95], v[80:95]
  ds_read_b64_tr_b16 v[208:209], v14 offset:34816
  ds_read_b64_tr_b16 v[210:211], v14 offset:35328
  v_fma_f32 v255, v255, v24, v24
  v_rcp_f32 v252, v252
  v_mfma_f32_32x32x16_bf16 v[112:127], v[220:223], a[92:95], v[112:127]
  ds_read_b64_tr_b16 v[212:213], v15 offset:34816
  ds_read_b64_tr_b16 v[214:215], v15 offset:35328
  v_rcp_f32 v253, v253
  s_waitcnt lgkmcnt(8)
  v_mfma_f32_32x32x16_bf16 v[64:79], v[192:195], a[96:99], v[64:79]
  ds_read_b64_tr_b16 v[216:217], v14 offset:43008
  ds_read_b64_tr_b16 v[218:219], v14 offset:43520
  v_rcp_f32 v254, v254
  v_rcp_f32 v255, v255
  v_mfma_f32_32x32x16_bf16 v[96:111], v[196:199], a[96:99], v[96:111]
  ds_read_b64_tr_b16 v[220:221], v15 offset:43008
  ds_read_b64_tr_b16 v[222:223], v15 offset:43520
  v_mul_f32 v176, v176, v252
  v_mul_f32 v177, v177, v253
  s_waitcnt lgkmcnt(8)
  v_mfma_f32_32x32x16_bf16 v[80:95], v[200:203], a[96:99], v[80:95]
  ds_read_b64_tr_b16 v[192:193], v14 offset:36864
  ds_read_b64_tr_b16 v[194:195], v14 offset:37376
  v_mul_f32 v178, v178, v254
  v_mul_f32 v179, v179, v255
  v_mfma_f32_32x32x16_bf16 v[112:127], v[204:207], a[96:99], v[112:127]
  ds_read_b64_tr_b16 v[196:197], v15 offset:36864
  ds_read_b64_tr_b16 v[198:199], v15 offset:37376
  v_cvt_pk_bf16_f32 v160, v176, v177
  v_cvt_pk_bf16_f32 v161, v178, v179
  s_waitcnt lgkmcnt(8)
  v_mfma_f32_32x32x16_bf16 v[64:79], v[208:211], a[100:103], v[64:79]
  ds_read_b64_tr_b16 v[200:201], v14 offset:45056
  ds_read_b64_tr_b16 v[202:203], v14 offset:45568
  v_mul_f32 v252, v164, v164
  v_mul_f32 v253, v165, v165
  v_mfma_f32_32x32x16_bf16 v[96:111], v[212:215], a[100:103], v[96:111]
  ds_read_b64_tr_b16 v[204:205], v15 offset:45056
  ds_read_b64_tr_b16 v[206:207], v15 offset:45568
  v_mul_f32 v254, v166, v166
  s_waitcnt lgkmcnt(8)
  v_mfma_f32_32x32x16_bf16 v[80:95], v[216:219], a[100:103], v[80:95]
  ds_read_b64_tr_b16 v[208:209], v14 offset:38912
  ds_read_b64_tr_b16 v[210:211], v14 offset:39424
  v_mul_f32 v255, v167, v167
  v_fma_f32 v252, v252, v23, v22
  v_mfma_f32_32x32x16_bf16 v[112:127], v[220:223], a[100:103], v[112:127]
  ds_read_b64_tr_b16 v[212:213], v15 offset:38912
  ds_read_b64_tr_b16 v[214:215], v15 offset:39424
  v_fma_f32 v253, v253, v23, v22
  v_fma_f32 v254, v254, v23, v22
  s_waitcnt lgkmcnt(8)
  v_mfma_f32_32x32x16_bf16 v[64:79], v[192:195], a[104:107], v[64:79]
  ds_read_b64_tr_b16 v[216:217], v14 offset:47104
  ds_read_b64_tr_b16 v[218:219], v14 offset:47616
  v_fma_f32 v255, v255, v23, v22
  v_mul_f32 v252, v252, v164
  v_mfma_f32_32x32x16_bf16 v[96:111], v[196:199], a[104:107], v[96:111]
  ds_read_b64_tr_b16 v[220:221], v15 offset:47104
  ds_read_b64_tr_b16 v[222:223], v15 offset:47616
  v_mul_f32 v253, v253, v165
  v_mul_f32 v254, v254, v166
  s_waitcnt lgkmcnt(8)
  v_mfma_f32_32x32x16_bf16 v[80:95], v[200:203], a[104:107], v[80:95]
  v_mul_f32 v255, v255, v167
  s_waitcnt vmcnt(8)
  s_barrier
  ds_read_b64_tr_b16 v[192:193], v14 offset:49152
  ds_read_b64_tr_b16 v[194:195], v14 offset:49664
  v_exp_f32 v252, v252
  v_exp_f32 v253, v253
  v_mfma_f32_32x32x16_bf16 v[112:127], v[204:207], a[104:107], v[112:127]
  ds_read_b64_tr_b16 v[196:197], v15 offset:49152
  ds_read_b64_tr_b16 v[198:199], v15 offset:49664
  v_exp_f32 v254, v254
  v_exp_f32 v255, v255
  s_waitcnt lgkmcnt(8)
  v_mfma_f32_32x32x16_bf16 v[64:79], v[208:211], a[108:111], v[64:79]
  ds_read_b64_tr_b16 v[200:201], v14 offset:57344
  ds_read_b64_tr_b16 v[202:203], v14 offset:57856
  v_mul_f32 v180, v180, v164
  v_mul_f32 v181, v181, v165
  v_mfma_f32_32x32x16_bf16 v[96:111], v[212:215], a[108:111], v[96:111]
  ds_read_b64_tr_b16 v[204:205], v15 offset:57344
  ds_read_b64_tr_b16 v[206:207], v15 offset:57856
  v_mul_f32 v182, v182, v166
  v_mul_f32 v183, v183, v167
  s_waitcnt lgkmcnt(8)
  v_mfma_f32_32x32x16_bf16 v[80:95], v[216:219], a[108:111], v[80:95]
  ds_read_b64_tr_b16 v[208:209], v14 offset:51200
  ds_read_b64_tr_b16 v[210:211], v14 offset:51712
  v_fma_f32 v252, v252, v24, v24
  v_mfma_f32_32x32x16_bf16 v[112:127], v[220:223], a[108:111], v[112:127]
  ds_read_b64_tr_b16 v[212:213], v15 offset:51200
  ds_read_b64_tr_b16 v[214:215], v15 offset:51712
  v_fma_f32 v253, v253, v24, v24
  v_fma_f32 v254, v254, v24, v24
  s_waitcnt lgkmcnt(8)
  v_mfma_f32_32x32x16_bf16 v[64:79], v[192:195], a[112:115], v[64:79]
  ds_read_b64_tr_b16 v[216:217], v14 offset:59392
  ds_read_b64_tr_b16 v[218:219], v14 offset:59904
  v_fma_f32 v255, v255, v24, v24
  v_rcp_f32 v252, v252
  v_mfma_f32_32x32x16_bf16 v[96:111], v[196:199], a[112:115], v[96:111]
  ds_read_b64_tr_b16 v[220:221], v15 offset:59392
  ds_read_b64_tr_b16 v[222:223], v15 offset:59904
  v_rcp_f32 v253, v253
  v_rcp_f32 v254, v254
  s_waitcnt lgkmcnt(8)
  v_mfma_f32_32x32x16_bf16 v[80:95], v[200:203], a[112:115], v[80:95]
  ds_read_b64_tr_b16 v[192:193], v14 offset:53248
  ds_read_b64_tr_b16 v[194:195], v14 offset:53760
  v_rcp_f32 v255, v255
  v_mfma_f32_32x32x16_bf16 v[112:127], v[204:207], a[112:115], v[112:127]
  ds_read_b64_tr_b16 v[196:197], v15 offset:53248
  ds_read_b64_tr_b16 v[198:199], v15 offset:53760
  v_mul_f32 v180, v180, v252
  v_mul_f32 v181, v181, v253
  s_waitcnt lgkmcnt(8)
  v_mfma_f32_32x32x16_bf16 v[64:79], v[208:211], a[116:119], v[64:79]
  ds_read_b64_tr_b16 v[200:201], v14 offset:61440
  ds_read_b64_tr_b16 v[202:203], v14 offset:61952
  v_mul_f32 v182, v182, v254
  v_mul_f32 v183, v183, v255
  v_mfma_f32_32x32x16_bf16 v[96:111], v[212:215], a[116:119], v[96:111]
  ds_read_b64_tr_b16 v[204:205], v15 offset:61440
  ds_read_b64_tr_b16 v[206:207], v15 offset:61952
  v_cvt_pk_bf16_f32 v162, v180, v181
  v_cvt_pk_bf16_f32 v163, v182, v183
  s_waitcnt lgkmcnt(8)
  v_mfma_f32_32x32x16_bf16 v[80:95], v[216:219], a[116:119], v[80:95]
  ds_read_b64_tr_b16 v[208:209], v14 offset:55296
  ds_read_b64_tr_b16 v[210:211], v14 offset:55808
  s_add_u32 s8, s97, 131072
  buffer_store_dwordx4 v[160:163], v29, s[56:59], s8 offen offset:0 sc1
  v_mfma_f32_32x32x16_bf16 v[112:127], v[220:223], a[116:119], v[112:127]
  ds_read_b64_tr_b16 v[212:213], v15 offset:55296
  ds_read_b64_tr_b16 v[214:215], v15 offset:55808
  v_mul_f32 v252, v168, v168
  v_mul_f32 v253, v169, v169
  s_waitcnt lgkmcnt(8)
  v_mfma_f32_32x32x16_bf16 v[64:79], v[192:195], a[120:123], v[64:79]
  ds_read_b64_tr_b16 v[216:217], v14 offset:63488
  ds_read_b64_tr_b16 v[218:219], v14 offset:64000
  v_mul_f32 v254, v170, v170
  v_mul_f32 v255, v171, v171
  v_mfma_f32_32x32x16_bf16 v[96:111], v[196:199], a[120:123], v[96:111]
  ds_read_b64_tr_b16 v[220:221], v15 offset:63488
  ds_read_b64_tr_b16 v[222:223], v15 offset:64000
  v_fma_f32 v252, v252, v23, v22
  v_fma_f32 v253, v253, v23, v22
  s_waitcnt lgkmcnt(8)
  v_mfma_f32_32x32x16_bf16 v[80:95], v[200:203], a[120:123], v[80:95]
  v_fma_f32 v254, v254, v23, v22
  s_waitcnt vmcnt(4)
  s_barrier
  ds_read_b64_tr_b16 v[192:193], v16 offset:0
  ds_read_b64_tr_b16 v[194:195], v16 offset:512
  v_fma_f32 v255, v255, v23, v22
  v_mul_f32 v252, v252, v168
  v_mfma_f32_32x32x16_bf16 v[112:127], v[204:207], a[120:123], v[112:127]
  ds_read_b64_tr_b16 v[196:197], v17 offset:0
  ds_read_b64_tr_b16 v[198:199], v17 offset:512
  v_mul_f32 v253, v253, v169
  v_mul_f32 v254, v254, v170
  s_waitcnt lgkmcnt(8)
  v_mfma_f32_32x32x16_bf16 v[64:79], v[208:211], a[124:127], v[64:79]
  ds_read_b64_tr_b16 v[200:201], v16 offset:8192
  ds_read_b64_tr_b16 v[202:203], v16 offset:8704
  v_mul_f32 v255, v255, v171
  v_exp_f32 v252, v252
  v_mfma_f32_32x32x16_bf16 v[96:111], v[212:215], a[124:127], v[96:111]
  ds_read_b64_tr_b16 v[204:205], v17 offset:8192
  ds_read_b64_tr_b16 v[206:207], v17 offset:8704
  v_exp_f32 v253, v253
  v_exp_f32 v254, v254
  s_waitcnt lgkmcnt(8)
  v_mfma_f32_32x32x16_bf16 v[80:95], v[216:219], a[124:127], v[80:95]
  ds_read_b64_tr_b16 v[208:209], v16 offset:2048
  ds_read_b64_tr_b16 v[210:211], v16 offset:2560
  v_exp_f32 v255, v255
  v_mul_f32 v184, v184, v168
  v_mfma_f32_32x32x16_bf16 v[112:127], v[220:223], a[124:127], v[112:127]
  ds_read_b64_tr_b16 v[212:213], v17 offset:2048
  ds_read_b64_tr_b16 v[214:215], v17 offset:2560
  v_mul_f32 v185, v185, v169
  s_waitcnt lgkmcnt(8)
  v_mfma_f32_32x32x16_bf16 v[64:79], v[192:195], a[128:131], v[64:79]
  ds_read_b64_tr_b16 v[216:217], v16 offset:10240
  ds_read_b64_tr_b16 v[218:219], v16 offset:10752
  v_mul_f32 v186, v186, v170
  v_mul_f32 v187, v187, v171
  v_mfma_f32_32x32x16_bf16 v[96:111], v[196:199], a[128:131], v[96:111]
  ds_read_b64_tr_b16 v[220:221], v17 offset:10240
  ds_read_b64_tr_b16 v[222:223], v17 offset:10752
  v_fma_f32 v252, v252, v24, v24
  v_fma_f32 v253, v253, v24, v24
  s_waitcnt lgkmcnt(8)
  v_mfma_f32_32x32x16_bf16 v[80:95], v[200:203], a[128:131], v[80:95]
  ds_read_b64_tr_b16 v[192:193], v16 offset:4096
  ds_read_b64_tr_b16 v[194:195], v16 offset:4608
  v_fma_f32 v254, v254, v24, v24
  v_fma_f32 v255, v255, v24, v24
  v_mfma_f32_32x32x16_bf16 v[112:127], v[204:207], a[128:131], v[112:127]
  ds_read_b64_tr_b16 v[196:197], v17 offset:4096
  ds_read_b64_tr_b16 v[198:199], v17 offset:4608
  v_rcp_f32 v252, v252
  v_rcp_f32 v253, v253
  s_waitcnt lgkmcnt(8)
  v_mfma_f32_32x32x16_bf16 v[64:79], v[208:211], a[132:135], v[64:79]
  ds_read_b64_tr_b16 v[200:201], v16 offset:12288
  ds_read_b64_tr_b16 v[202:203], v16 offset:12800
  v_rcp_f32 v254, v254
  v_rcp_f32 v255, v255
  v_mfma_f32_32x32x16_bf16 v[96:111], v[212:215], a[132:135], v[96:111]
  ds_read_b64_tr_b16 v[204:205], v17 offset:12288
  ds_read_b64_tr_b16 v[206:207], v17 offset:12800
  v_mul_f32 v184, v184, v252
  s_waitcnt lgkmcnt(8)
  v_mfma_f32_32x32x16_bf16 v[80:95], v[216:219], a[132:135], v[80:95]
  ds_read_b64_tr_b16 v[208:209], v16 offset:6144
  ds_read_b64_tr_b16 v[210:211], v16 offset:6656
  v_mul_f32 v185, v185, v253
  v_mul_f32 v186, v186, v254
  v_mfma_f32_32x32x16_bf16 v[112:127], v[220:223], a[132:135], v[112:127]
  ds_read_b64_tr_b16 v[212:213], v17 offset:6144
  ds_read_b64_tr_b16 v[214:215], v17 offset:6656
  v_mul_f32 v187, v187, v255
  v_cvt_pk_bf16_f32 v168, v184, v185
  s_waitcnt lgkmcnt(8)
  v_mfma_f32_32x32x16_bf16 v[64:79], v[192:195], a[136:139], v[64:79]
  ds_read_b64_tr_b16 v[216:217], v16 offset:14336
  ds_read_b64_tr_b16 v[218:219], v16 offset:14848
  v_cvt_pk_bf16_f32 v169, v186, v187
  v_mul_f32 v252, v172, v172
  v_mfma_f32_32x32x16_bf16 v[96:111], v[196:199], a[136:139], v[96:111]
  ds_read_b64_tr_b16 v[220:221], v17 offset:14336
  ds_read_b64_tr_b16 v[222:223], v17 offset:14848
  v_mul_f32 v253, v173, v173
  v_mul_f32 v254, v174, v174
  s_waitcnt lgkmcnt(8)
  v_mfma_f32_32x32x16_bf16 v[80:95], v[200:203], a[136:139], v[80:95]
  v_mul_f32 v255, v175, v175
  s_waitcnt vmcnt(0)
  s_barrier
  ds_read_b64_tr_b16 v[192:193], v16 offset:16384
  ds_read_b64_tr_b16 v[194:195], v16 offset:16896
  v_fma_f32 v252, v252, v23, v22
  v_fma_f32 v253, v253, v23, v22
  v_mfma_f32_32x32x16_bf16 v[112:127], v[204:207], a[136:139], v[112:127]
  ds_read_b64_tr_b16 v[196:197], v17 offset:16384
  ds_read_b64_tr_b16 v[198:199], v17 offset:16896
  v_fma_f32 v254, v254, v23, v22
  s_waitcnt lgkmcnt(8)
  v_mfma_f32_32x32x16_bf16 v[64:79], v[208:211], a[140:143], v[64:79]
  ds_read_b64_tr_b16 v[200:201], v16 offset:24576
  ds_read_b64_tr_b16 v[202:203], v16 offset:25088
  v_fma_f32 v255, v255, v23, v22
  v_mul_f32 v252, v252, v172
  v_mfma_f32_32x32x16_bf16 v[96:111], v[212:215], a[140:143], v[96:111]
  ds_read_b64_tr_b16 v[204:205], v17 offset:24576
  ds_read_b64_tr_b16 v[206:207], v17 offset:25088
  v_mul_f32 v253, v253, v173
  s_waitcnt lgkmcnt(8)
  v_mfma_f32_32x32x16_bf16 v[80:95], v[216:219], a[140:143], v[80:95]
  ds_read_b64_tr_b16 v[208:209], v16 offset:18432
  ds_read_b64_tr_b16 v[210:211], v16 offset:18944
  v_mul_f32 v254, v254, v174
  v_mul_f32 v255, v255, v175
  v_mfma_f32_32x32x16_bf16 v[112:127], v[220:223], a[140:143], v[112:127]
  ds_read_b64_tr_b16 v[212:213], v17 offset:18432
  ds_read_b64_tr_b16 v[214:215], v17 offset:18944
  v_exp_f32 v252, v252
  s_waitcnt lgkmcnt(8)
  v_mfma_f32_32x32x16_bf16 v[64:79], v[192:195], a[144:147], v[64:79]
  ds_read_b64_tr_b16 v[216:217], v16 offset:26624
  ds_read_b64_tr_b16 v[218:219], v16 offset:27136
  v_exp_f32 v253, v253
  v_mfma_f32_32x32x16_bf16 v[96:111], v[196:199], a[144:147], v[96:111]
  ds_read_b64_tr_b16 v[220:221], v17 offset:26624
  ds_read_b64_tr_b16 v[222:223], v17 offset:27136
  v_exp_f32 v254, v254
  v_exp_f32 v255, v255
  s_waitcnt lgkmcnt(8)
  v_mfma_f32_32x32x16_bf16 v[80:95], v[200:203], a[144:147], v[80:95]
  ds_read_b64_tr_b16 v[192:193], v16 offset:20480
  ds_read_b64_tr_b16 v[194:195], v16 offset:20992
  v_mul_f32 v188, v188, v172
  v_mfma_f32_32x32x16_bf16 v[112:127], v[204:207], a[144:147], v[112:127]
  ds_read_b64_tr_b16 v[196:197], v17 offset:20480
  ds_read_b64_tr_b16 v[198:199], v17 offset:20992
  v_mul_f32 v189, v189, v173
  v_mul_f32 v190, v190, v174
  s_waitcnt lgkmcnt(8)
  v_mfma_f32_32x32x16_bf16 v[64:79], v[208:211], a[148:151], v[64:79]
  ds_read_b64_tr_b16 v[200:201], v16 offset:28672
  ds_read_b64_tr_b16 v[202:203], v16 offset:29184
  v_mul_f32 v191, v191, v175
  v_mfma_f32_32x32x16_bf16 v[96:111], v[212:215], a[148:151], v[96:111]
  ds_read_b64_tr_b16 v[204:205], v17 offset:28672
  ds_read_b64_tr_b16 v[206:207], v17 offset:29184
  v_fma_f32 v252, v252, v24, v24
  s_waitcnt lgkmcnt(8)
  v_mfma_f32_32x32x16_bf16 v[80:95], v[216:219], a[148:151], v[80:95]
  ds_read_b64_tr_b16 v[208:209], v16 offset:22528
  ds_read_b64_tr_b16 v[210:211], v16 offset:23040
  v_fma_f32 v253, v253, v24, v24
  v_fma_f32 v254, v254, v24, v24
  v_mfma_f32_32x32x16_bf16 v[112:127], v[220:223], a[148:151], v[112:127]
  ds_read_b64_tr_b16 v[212:213], v17 offset:22528
  ds_read_b64_tr_b16 v[214:215], v17 offset:23040
  v_fma_f32 v255, v255, v24, v24
  s_waitcnt lgkmcnt(8)
  v_mfma_f32_32x32x16_bf16 v[64:79], v[192:195], a[152:155], v[64:79]
  ds_read_b64_tr_b16 v[216:217], v16 offset:30720
  ds_read_b64_tr_b16 v[218:219], v16 offset:31232
  v_rcp_f32 v252, v252
  v_rcp_f32 v253, v253
  v_mfma_f32_32x32x16_bf16 v[96:111], v[196:199], a[152:155], v[96:111]
  ds_read_b64_tr_b16 v[220:221], v17 offset:30720
  ds_read_b64_tr_b16 v[222:223], v17 offset:31232
  v_rcp_f32 v254, v254
  s_waitcnt lgkmcnt(8)
  v_mfma_f32_32x32x16_bf16 v[80:95], v[200:203], a[152:155], v[80:95]
  v_rcp_f32 v255, v255
  v_mfma_f32_32x32x16_bf16 v[112:127], v[204:207], a[152:155], v[112:127]
  v_mul_f32 v188, v188, v252
  v_mul_f32 v189, v189, v253
  s_waitcnt lgkmcnt(4)
  v_mfma_f32_32x32x16_bf16 v[64:79], v[208:211], a[156:159], v[64:79]
  v_mul_f32 v190, v190, v254
  v_mfma_f32_32x32x16_bf16 v[96:111], v[212:215], a[156:159], v[96:111]
  v_mul_f32 v191, v191, v255
  v_cvt_pk_bf16_f32 v170, v188, v189
  s_waitcnt lgkmcnt(0)
  v_mfma_f32_32x32x16_bf16 v[80:95], v[216:219], a[156:159], v[80:95]
  v_cvt_pk_bf16_f32 v171, v190, v191
  v_mfma_f32_32x32x16_bf16 v[112:127], v[220:223], a[156:159], v[112:127]
  s_add_u32 s8, s97, 131072
  buffer_store_dwordx4 v[168:171], v29, s[56:59], s8 offen offset:512 sc1
  ds_read_b32 v236, v30 offset:512
  ds_read_b32 v240, v30 offset:640
  ds_read_b32 v244, v30 offset:1536
  ds_read_b32 v248, v30 offset:1664
  s_waitcnt lgkmcnt(0)
  v_and_b32 v236, v236, v31
  v_and_b32 v240, v240, v31
  v_and_b32 v244, v244, v31
  v_and_b32 v248, v248, v31
  v_mfma_f32_32x32x16_bf16 v[64:79], v[236:239], a[160:163], v[64:79]
  v_mfma_f32_32x32x16_bf16 v[96:111], v[240:243], a[160:163], v[96:111]
  v_mfma_f32_32x32x16_bf16 v[80:95], v[244:247], a[160:163], v[80:95]
  v_mfma_f32_32x32x16_bf16 v[112:127], v[248:251], a[160:163], v[112:127]
  s_nop 8
  v_mul_f32 v252, v64, v64
  v_mul_f32 v253, v65, v65
  v_mul_f32 v254, v66, v66
  v_mul_f32 v255, v67, v67
  v_fma_f32 v252, v252, v23, v22
  v_fma_f32 v253, v253, v23, v22
  v_fma_f32 v254, v254, v23, v22
  v_fma_f32 v255, v255, v23, v22
  v_mul_f32 v252, v252, v64
  v_mul_f32 v253, v253, v65
  v_mul_f32 v254, v254, v66
  v_mul_f32 v255, v255, v67
  v_exp_f32 v252, v252
  v_exp_f32 v253, v253
  v_exp_f32 v254, v254
  v_exp_f32 v255, v255
  v_mul_f32 v80, v80, v64
  v_mul_f32 v81, v81, v65
  v_mul_f32 v82, v82, v66
  v_mul_f32 v83, v83, v67
  v_fma_f32 v252, v252, v24, v24
  v_fma_f32 v253, v253, v24, v24
  v_fma_f32 v254, v254, v24, v24
  v_fma_f32 v255, v255, v24, v24
  v_rcp_f32 v252, v252
  v_rcp_f32 v253, v253
  v_rcp_f32 v254, v254
  v_rcp_f32 v255, v255
  v_mul_f32 v80, v80, v252
  v_mul_f32 v81, v81, v253
  v_mul_f32 v82, v82, v254
  v_mul_f32 v83, v83, v255
  v_cvt_pk_bf16_f32 v64, v80, v81
  v_cvt_pk_bf16_f32 v65, v82, v83
  v_mul_f32 v252, v68, v68
  v_mul_f32 v253, v69, v69
  v_mul_f32 v254, v70, v70
  v_mul_f32 v255, v71, v71
  v_fma_f32 v252, v252, v23, v22
  v_fma_f32 v253, v253, v23, v22
  v_fma_f32 v254, v254, v23, v22
  v_fma_f32 v255, v255, v23, v22
  v_mul_f32 v252, v252, v68
  v_mul_f32 v253, v253, v69
  v_mul_f32 v254, v254, v70
  v_mul_f32 v255, v255, v71
  v_exp_f32 v252, v252
  v_exp_f32 v253, v253
  v_exp_f32 v254, v254
  v_exp_f32 v255, v255
  v_mul_f32 v84, v84, v68
  v_mul_f32 v85, v85, v69
  v_mul_f32 v86, v86, v70
  v_mul_f32 v87, v87, v71
  v_fma_f32 v252, v252, v24, v24
  v_fma_f32 v253, v253, v24, v24
  v_fma_f32 v254, v254, v24, v24
  v_fma_f32 v255, v255, v24, v24
  v_rcp_f32 v252, v252
  v_rcp_f32 v253, v253
  v_rcp_f32 v254, v254
  v_rcp_f32 v255, v255
  v_mul_f32 v84, v84, v252
  v_mul_f32 v85, v85, v253
  v_mul_f32 v86, v86, v254
  v_mul_f32 v87, v87, v255
  v_cvt_pk_bf16_f32 v66, v84, v85
  v_cvt_pk_bf16_f32 v67, v86, v87
  buffer_store_dwordx4 v[64:67], v29, s[56:59], s98 offen offset:0 sc1
  v_mul_f32 v252, v72, v72
  v_mul_f32 v253, v73, v73
  v_mul_f32 v254, v74, v74
  v_mul_f32 v255, v75, v75
  v_fma_f32 v252, v252, v23, v22
  v_fma_f32 v253, v253, v23, v22
  v_fma_f32 v254, v254, v23, v22
  v_fma_f32 v255, v255, v23, v22
  v_mul_f32 v252, v252, v72
  v_mul_f32 v253, v253, v73
  v_mul_f32 v254, v254, v74
  v_mul_f32 v255, v255, v75
  v_exp_f32 v252, v252
  v_exp_f32 v253, v253
  v_exp_f32 v254, v254
  v_exp_f32 v255, v255
  v_mul_f32 v88, v88, v72
  v_mul_f32 v89, v89, v73
  v_mul_f32 v90, v90, v74
  v_mul_f32 v91, v91, v75
  v_fma_f32 v252, v252, v24, v24
  v_fma_f32 v253, v253, v24, v24
  v_fma_f32 v254, v254, v24, v24
  v_fma_f32 v255, v255, v24, v24
  v_rcp_f32 v252, v252
  v_rcp_f32 v253, v253
  v_rcp_f32 v254, v254
  v_rcp_f32 v255, v255
  v_mul_f32 v88, v88, v252
  v_mul_f32 v89, v89, v253
  v_mul_f32 v90, v90, v254
  v_mul_f32 v91, v91, v255
  v_cvt_pk_bf16_f32 v72, v88, v89
  v_cvt_pk_bf16_f32 v73, v90, v91
  v_mul_f32 v252, v76, v76
  v_mul_f32 v253, v77, v77
  v_mul_f32 v254, v78, v78
  v_mul_f32 v255, v79, v79
  v_fma_f32 v252, v252, v23, v22
  v_fma_f32 v253, v253, v23, v22
  v_fma_f32 v254, v254, v23, v22
  v_fma_f32 v255, v255, v23, v22
  v_mul_f32 v252, v252, v76
  v_mul_f32 v253, v253, v77
  v_mul_f32 v254, v254, v78
  v_mul_f32 v255, v255, v79
  v_exp_f32 v252, v252
  v_exp_f32 v253, v253
  v_exp_f32 v254, v254
  v_exp_f32 v255, v255
  v_mul_f32 v92, v92, v76
  v_mul_f32 v93, v93, v77
  v_mul_f32 v94, v94, v78
  v_mul_f32 v95, v95, v79
  v_fma_f32 v252, v252, v24, v24
  v_fma_f32 v253, v253, v24, v24
  v_fma_f32 v254, v254, v24, v24
  v_fma_f32 v255, v255, v24, v24
  v_rcp_f32 v252, v252
  v_rcp_f32 v253, v253
  v_rcp_f32 v254, v254
  v_rcp_f32 v255, v255
  v_mul_f32 v92, v92, v252
  v_mul_f32 v93, v93, v253
  v_mul_f32 v94, v94, v254
  v_mul_f32 v95, v95, v255
  v_cvt_pk_bf16_f32 v74, v92, v93
  v_cvt_pk_bf16_f32 v75, v94, v95
  buffer_store_dwordx4 v[72:75], v29, s[56:59], s98 offen offset:512 sc1
  v_mul_f32 v252, v96, v96
  v_mul_f32 v253, v97, v97
  v_mul_f32 v254, v98, v98
  v_mul_f32 v255, v99, v99
  v_fma_f32 v252, v252, v23, v22
  v_fma_f32 v253, v253, v23, v22
  v_fma_f32 v254, v254, v23, v22
  v_fma_f32 v255, v255, v23, v22
  v_mul_f32 v252, v252, v96
  v_mul_f32 v253, v253, v97
  v_mul_f32 v254, v254, v98
  v_mul_f32 v255, v255, v99
  v_exp_f32 v252, v252
  v_exp_f32 v253, v253
  v_exp_f32 v254, v254
  v_exp_f32 v255, v255
  v_mul_f32 v112, v112, v96
  v_mul_f32 v113, v113, v97
  v_mul_f32 v114, v114, v98
  v_mul_f32 v115, v115, v99
  v_fma_f32 v252, v252, v24, v24
  v_fma_f32 v253, v253, v24, v24
  v_fma_f32 v254, v254, v24, v24
  v_fma_f32 v255, v255, v24, v24
  v_rcp_f32 v252, v252
  v_rcp_f32 v253, v253
  v_rcp_f32 v254, v254
  v_rcp_f32 v255, v255
  v_mul_f32 v112, v112, v252
  v_mul_f32 v113, v113, v253
  v_mul_f32 v114, v114, v254
  v_mul_f32 v115, v115, v255
  v_cvt_pk_bf16_f32 v96, v112, v113
  v_cvt_pk_bf16_f32 v97, v114, v115
  v_mul_f32 v252, v100, v100
  v_mul_f32 v253, v101, v101
  v_mul_f32 v254, v102, v102
  v_mul_f32 v255, v103, v103
  v_fma_f32 v252, v252, v23, v22
  v_fma_f32 v253, v253, v23, v22
  v_fma_f32 v254, v254, v23, v22
  v_fma_f32 v255, v255, v23, v22
  v_mul_f32 v252, v252, v100
  v_mul_f32 v253, v253, v101
  v_mul_f32 v254, v254, v102
  v_mul_f32 v255, v255, v103
  v_exp_f32 v252, v252
  v_exp_f32 v253, v253
  v_exp_f32 v254, v254
  v_exp_f32 v255, v255
  v_mul_f32 v116, v116, v100
  v_mul_f32 v117, v117, v101
  v_mul_f32 v118, v118, v102
  v_mul_f32 v119, v119, v103
  v_fma_f32 v252, v252, v24, v24
  v_fma_f32 v253, v253, v24, v24
  v_fma_f32 v254, v254, v24, v24
  v_fma_f32 v255, v255, v24, v24
  v_rcp_f32 v252, v252
  v_rcp_f32 v253, v253
  v_rcp_f32 v254, v254
  v_rcp_f32 v255, v255
  v_mul_f32 v116, v116, v252
  v_mul_f32 v117, v117, v253
  v_mul_f32 v118, v118, v254
  v_mul_f32 v119, v119, v255
  v_cvt_pk_bf16_f32 v98, v116, v117
  v_cvt_pk_bf16_f32 v99, v118, v119
  s_add_u32 s8, s98, s92
  buffer_store_dwordx4 v[96:99], v29, s[56:59], s8 offen offset:0 sc1
  v_mul_f32 v252, v104, v104
  v_mul_f32 v253, v105, v105
  v_mul_f32 v254, v106, v106
  v_mul_f32 v255, v107, v107
  v_fma_f32 v252, v252, v23, v22
  v_fma_f32 v253, v253, v23, v22
  v_fma_f32 v254, v254, v23, v22
  v_fma_f32 v255, v255, v23, v22
  v_mul_f32 v252, v252, v104
  v_mul_f32 v253, v253, v105
  v_mul_f32 v254, v254, v106
  v_mul_f32 v255, v255, v107
  v_exp_f32 v252, v252
  v_exp_f32 v253, v253
  v_exp_f32 v254, v254
  v_exp_f32 v255, v255
  v_mul_f32 v120, v120, v104
  v_mul_f32 v121, v121, v105
  v_mul_f32 v122, v122, v106
  v_mul_f32 v123, v123, v107
  v_fma_f32 v252, v252, v24, v24
  v_fma_f32 v253, v253, v24, v24
  v_fma_f32 v254, v254, v24, v24
  v_fma_f32 v255, v255, v24, v24
  v_rcp_f32 v252, v252
  v_rcp_f32 v253, v253
  v_rcp_f32 v254, v254
  v_rcp_f32 v255, v255
  v_mul_f32 v120, v120, v252
  v_mul_f32 v121, v121, v253
  v_mul_f32 v122, v122, v254
  v_mul_f32 v123, v123, v255
  v_cvt_pk_bf16_f32 v104, v120, v121
  v_cvt_pk_bf16_f32 v105, v122, v123
  v_mul_f32 v252, v108, v108
  v_mul_f32 v253, v109, v109
  v_mul_f32 v254, v110, v110
  v_mul_f32 v255, v111, v111
  v_fma_f32 v252, v252, v23, v22
  v_fma_f32 v253, v253, v23, v22
  v_fma_f32 v254, v254, v23, v22
  v_fma_f32 v255, v255, v23, v22
  v_mul_f32 v252, v252, v108
  v_mul_f32 v253, v253, v109
  v_mul_f32 v254, v254, v110
  v_mul_f32 v255, v255, v111
  v_exp_f32 v252, v252
  v_exp_f32 v253, v253
  v_exp_f32 v254, v254
  v_exp_f32 v255, v255
  v_mul_f32 v124, v124, v108
  v_mul_f32 v125, v125, v109
  v_mul_f32 v126, v126, v110
  v_mul_f32 v127, v127, v111
  v_fma_f32 v252, v252, v24, v24
  v_fma_f32 v253, v253, v24, v24
  v_fma_f32 v254, v254, v24, v24
  v_fma_f32 v255, v255, v24, v24
  v_rcp_f32 v252, v252
  v_rcp_f32 v253, v253
  v_rcp_f32 v254, v254
  v_rcp_f32 v255, v255
  v_mul_f32 v124, v124, v252
  v_mul_f32 v125, v125, v253
  v_mul_f32 v126, v126, v254
  v_mul_f32 v127, v127, v255
  v_cvt_pk_bf16_f32 v106, v124, v125
  v_cvt_pk_bf16_f32 v107, v126, v127
  s_add_u32 s8, s98, s92
  buffer_store_dwordx4 v[104:107], v29, s[56:59], s8 offen offset:512 sc1
  s_waitcnt vmcnt(0)
  s_barrier
  s_lshl_b32 s8, s4, 4
  s_add_u32 s8, s8, s5
  s_lshl_b32 s8, s8, 2
  s_add_u32 s8, s8, 0x10b0c00
  v_mov_b32 v58, s6
  buffer_store_dword v58, v59, s[56:59], s8 offen sc1
  s_lshl_b32 s8, s4, 4
  s_add_u32 s8, s8, s5
  s_lshl_b32 s8, s8, 2
  s_add_u32 s8, s8, 0x10b1000
  v_mov_b32 v58, s6
  buffer_store_dword v58, v59, s[56:59], s8 offen sc1
  s_add_u32 s7, s80, 0
  buffer_load_dwordx4 a[0:3], v54, s[76:79], s7 offen offset:0 sc1
  buffer_load_dwordx4 a[4:7], v54, s[76:79], s7 offen offset:1024 sc1
  buffer_load_dwordx4 a[8:11], v54, s[76:79], s7 offen offset:2048 sc1
  buffer_load_dwordx4 a[12:15], v54, s[76:79], s7 offen offset:3072 sc1
  buffer_load_dwordx4 a[16:19], v56, s[76:79], s7 offen sc1
  s_add_u32 s7, s80, 40960
  buffer_load_dwordx4 a[20:23], v54, s[76:79], s7 offen offset:0 sc1
  buffer_load_dwordx4 a[24:27], v54, s[76:79], s7 offen offset:1024 sc1
  buffer_load_dwordx4 a[28:31], v54, s[76:79], s7 offen offset:2048 sc1
  buffer_load_dwordx4 a[32:35], v54, s[76:79], s7 offen offset:3072 sc1
  buffer_load_dwordx4 a[36:39], v56, s[76:79], s7 offen sc1
  s_add_u32 s7, s80, 81920
  buffer_load_dwordx4 a[40:43], v54, s[76:79], s7 offen offset:0 sc1
  buffer_load_dwordx4 a[44:47], v54, s[76:79], s7 offen offset:1024 sc1
  buffer_load_dwordx4 a[48:51], v54, s[76:79], s7 offen offset:2048 sc1
  buffer_load_dwordx4 a[52:55], v54, s[76:79], s7 offen offset:3072 sc1
  buffer_load_dwordx4 a[56:59], v56, s[76:79], s7 offen sc1
  s_add_u32 s7, s80, 122880
  buffer_load_dwordx4 a[60:63], v54, s[76:79], s7 offen offset:0 sc1
  buffer_load_dwordx4 a[64:67], v54, s[76:79], s7 offen offset:1024 sc1
  buffer_load_dwordx4 a[68:71], v54, s[76:79], s7 offen offset:2048 sc1
  buffer_load_dwordx4 a[72:75], v54, s[76:79], s7 offen offset:3072 sc1
  buffer_load_dwordx4 a[76:79], v56, s[76:79], s7 offen sc1
  s_add_u32 s7, s80, 163840
  buffer_load_dwordx4 a[80:83], v54, s[76:79], s7 offen offset:0 sc1
  buffer_load_dwordx4 a[84:87], v54, s[76:79], s7 offen offset:1024 sc1
  buffer_load_dwordx4 a[88:91], v54, s[76:79], s7 offen offset:2048 sc1
  buffer_load_dwordx4 a[92:95], v54, s[76:79], s7 offen offset:3072 sc1
  buffer_load_dwordx4 a[96:99], v56, s[76:79], s7 offen sc1
  s_add_u32 s7, s80, 204800
  buffer_load_dwordx4 a[100:103], v54, s[76:79], s7 offen offset:0 sc1
  buffer_load_dwordx4 a[104:107], v54, s[76:79], s7 offen offset:1024 sc1
  buffer_load_dwordx4 a[108:111], v54, s[76:79], s7 offen offset:2048 sc1
  buffer_load_dwordx4 a[112:115], v54, s[76:79], s7 offen offset:3072 sc1
  buffer_load_dwordx4 a[116:119], v56, s[76:79], s7 offen sc1
  s_add_u32 s7, s80, 245760
  buffer_load_dwordx4 a[120:123], v54, s[76:79], s7 offen offset:0 sc1
  buffer_load_dwordx4 a[124:127], v54, s[76:79], s7 offen offset:1024 sc1
  buffer_load_dwordx4 a[128:131], v54, s[76:79], s7 offen offset:2048 sc1
  buffer_load_dwordx4 a[132:135], v54, s[76:79], s7 offen offset:3072 sc1
  buffer_load_dwordx4 a[136:139], v56, s[76:79], s7 offen sc1
  s_branch L_P2
L_SSM:
  s_cmp_lt_u32 s3, 2
  s_cselect_b32 s52, s22, s24
  s_cselect_b32 s53, s23, s25
  s_mov_b32 s54, 819200
  s_mov_b32 s55, 0x20000
  s_mul_i32 s8, s5, 96
  s_and_b32 s9, s3, 1
  s_lshl_b32 s10, s9, 5
  s_add_u32 s10, s10, s8
  s_mul_i32 s83, s10, 1280
  s_lshl_b32 s10, s9, 4
  s_add_u32 s10, s10, s8
  s_add_u32 s10, s10, 64
  s_mul_i32 s84, s10, 1280
  s_lshr_b32 s10, s3, 1
  s_lshl_b32 s10, s10, 13
  s_lshl_b32 s9, s9, 11
  s_add_u32 s85, s10, s9
  s_add_u32 s14, s80, 0
  s_add_u32 m0, s81, 0
  s_nop 0
  buffer_load_dwordx4 v2, s[48:51], s14 offen offset:0 lds
  buffer_load_dwordx4 v3, s[48:51], s14 offen offset:1024 lds
  buffer_load_dwordx4 v4, s[48:51], s14 offen offset:2048 lds
  buffer_load_dwordx4 v5, s[48:51], s14 offen offset:3072 lds
  s_add_u32 s15, s83, 0
  s_add_u32 m0, s82, 0
  s_nop 0
  buffer_load_dwordx4 v2, s[52:55], s15 offen offset:0 lds
  buffer_load_dwordx4 v3, s[52:55], s15 offen offset:1024 lds
  buffer_load_dwordx4 v4, s[52:55], s15 offen offset:2048 lds
  buffer_load_dwordx4 v5, s[52:55], s15 offen offset:3072 lds
  s_add_u32 s14, s80, 128
  s_add_u32 m0, s81, 4096
  s_nop 0
  buffer_load_dwordx4 v2, s[48:51], s14 offen offset:0 lds
  buffer_load_dwordx4 v3, s[48:51], s14 offen offset:1024 lds
  buffer_load_dwordx4 v4, s[48:51], s14 offen offset:2048 lds
  buffer_load_dwordx4 v5, s[48:51], s14 offen offset:3072 lds
  s_add_u32 s15, s83, 128
  s_add_u32 m0, s82, 16384
  s_nop 0
  buffer_load_dwordx4 v2, s[52:55], s15 offen offset:0 lds
  buffer_load_dwordx4 v3, s[52:55], s15 offen offset:1024 lds
  buffer_load_dwordx4 v4, s[52:55], s15 offen offset:2048 lds
  buffer_load_dwordx4 v5, s[52:55], s15 offen offset:3072 lds
  v_and_b32 v60, 31, v1
  v_lshrrev_b32 v61, 2, v60
  v_and_b32 v61, 1, v61
  v_lshlrev_b32 v61, 4, v61
  v_and_b32 v62, 3, v60
  v_add_u32 v61, v61, v62
  v_lshrrev_b32 v62, 3, v60
  v_lshl_add_u32 v57, v62, 2, v61
  v_lshrrev_b32 v62, 1, v57
  v_and_b32 v62, 7, v62
  v_lshrrev_b32 v63, 5, v1
  v_lshlrev_b32 v61, 7, v57
  v_add_u32 v61, s81, v61
  v_add_u32 v60, 0, v63
  v_xor_b32 v60, v60, v62
  v_lshl_add_u32 v6, v60, 4, v61
  v_add_u32 v60, 2, v63
  v_xor_b32 v60, v60, v62
  v_lshl_add_u32 v7, v60, 4, v61
  v_add_u32 v60, 4, v63
  v_xor_b32 v60, v60, v62
  v_lshl_add_u32 v8, v60, 4, v61
  v_add_u32 v60, 6, v63
  v_xor_b32 v60, v60, v62
  v_lshl_add_u32 v9, v60, 4, v61
  v_mov_b32 v32, 0x3f803f80
  v_mov_b32 v241, 0
  v_mov_b32 v242, 0
  v_mov_b32 v243, 0
  v_mov_b32 v245, 0
  v_mov_b32 v246, 0
  v_mov_b32 v247, 0
  v_mov_b32 v249, 0
  v_mov_b32 v250, 0
  v_mov_b32 v251, 0
  v_mov_b32 v253, 0
  v_mov_b32 v254, 0
  v_mov_b32 v255, 0
  v_and_b32 v60, 31, v1
  v_lshrrev_b32 v61, 3, v60
  v_lshlrev_b32 v61, 10, v61
  v_and_b32 v62, 7, v60
  v_lshl_add_u32 v61, v62, 7, v61
  v_lshrrev_b32 v62, 1, v60
  v_and_b32 v62, 7, v62
  v_lshrrev_b32 v63, 5, v1
  v_add_u32 v60, 0, v63
  v_xor_b32 v60, v60, v62
  v_lshl_add_u32 v14, v60, 4, v61
  v_add_u32 v18, 65536, v14
  v_add_u32 v60, 2, v63
  v_xor_b32 v60, v60, v62
  v_lshl_add_u32 v15, v60, 4, v61
  v_add_u32 v19, 65536, v15
  v_add_u32 v60, 4, v63
  v_xor_b32 v60, v60, v62
  v_lshl_add_u32 v16, v60, 4, v61
  v_add_u32 v20, 65536, v16
  v_add_u32 v60, 6, v63
  v_xor_b32 v60, v60, v62
  v_lshl_add_u32 v17, v60, 4, v61
  v_add_u32 v21, 65536, v17
  s_waitcnt vmcnt(12)
  ds_read_b128 a[0:3], v6 offset:0
  ds_read_b128 a[4:7], v7 offset:0
  ds_read_b128 a[8:11], v8 offset:0
  ds_read_b128 a[12:15], v9 offset:0
  s_waitcnt vmcnt(8)
  s_barrier
  ds_read_b128 v[192:195], v14 offset:0
  ds_read_b128 v[196:199], v14 offset:8192
  ds_read_b128 v[200:203], v14 offset:4096
  ds_read_b128 v[204:207], v14 offset:12288
  ds_read_b128 v[208:211], v15 offset:0
  ds_read_b128 v[212:215], v15 offset:8192
  s_waitcnt lgkmcnt(6)
  s_waitcnt lgkmcnt(4)
  v_mfma_f32_32x32x16_bf16 v[64:79], a[0:3], v[192:195], 0
  ds_read_b128 v[216:219], v15 offset:4096
  s_add_u32 s14, s80, 256
  s_add_u32 m0, s81, 8192
  s_nop 0
  buffer_load_dwordx4 v2, s[48:51], s14 offen offset:0 lds
  s_waitcnt vmcnt(5)
  ds_read_b128 a[16:19], v6 offset:4096
  ds_read_b128 a[20:23], v7 offset:4096
  v_mfma_f32_32x32x16_bf16 v[80:95], a[0:3], v[196:199], 0
  ds_read_b128 v[220:223], v15 offset:12288
  buffer_load_dwordx4 v3, s[48:51], s14 offen offset:1024 lds
  ds_read_b128 a[24:27], v8 offset:4096
  ds_read_b128 a[28:31], v9 offset:4096
  s_waitcnt lgkmcnt(8)
  v_mfma_f32_32x32x16_bf16 v[96:111], a[0:3], v[200:203], 0
  ds_read_b128 v[192:195], v16 offset:0
  buffer_load_dwordx4 v4, s[48:51], s14 offen offset:2048 lds
  s_mul_i32 s8, s4, 7
  s_add_u32 s100, s8, s5
  s_cmp_ge_u32 s100, 54
  s_cselect_b32 s9, 1, 0
  s_mul_i32 s10, s9, 54
  s_sub_u32 s10, s100, s10
  s_lshr_b32 s11, s10, 1
  s_and_b32 s12, s10, 1
  s_cmp_eq_u32 s9, 0
  s_cselect_b32 s64, s36, s38
  s_cselect_b32 s65, s37, s39
  s_mov_b32 s66, 2211840
  s_mov_b32 s67, 0x20000
  v_mfma_f32_32x32x16_bf16 v[112:127], a[0:3], v[204:207], 0
  ds_read_b128 v[196:199], v16 offset:8192
  buffer_load_dwordx4 v5, s[48:51], s14 offen offset:3072 lds
  s_add_u32 s15, s83, 256
  s_add_u32 m0, s82, 32768
  s_nop 0
  buffer_load_dwordx4 v2, s[52:55], s15 offen offset:0 lds
  s_mul_i32 s13, s12, 1105920
  s_lshl_b32 s7, s11, 7
  s_add_u32 s13, s13, s7
  s_mul_i32 s7, s9, 27
  s_add_u32 s7, s7, s11
  s_lshl_b32 s7, s7, 1
  s_add_u32 s7, s7, s12
  s_lshl_b32 s7, s7, 9
  s_add_u32 s7, s7, 0x1050000
  s_waitcnt lgkmcnt(8)
  v_mfma_f32_32x32x16_bf16 v[64:79], a[4:7], v[208:211], v[64:79]
  ds_read_b128 v[200:203], v16 offset:4096
  buffer_load_dwordx4 v3, s[52:55], s15 offen offset:1024 lds
  s_cmp_lt_u32 s100, 108
  s_cselect_b32 s13, s13, 0x40000000
  s_cselect_b32 s93, s7, 0x40000000
  v_lshrrev_b32 v60, 3, v0
  v_mfma_f32_32x32x16_bf16 v[80:95], a[4:7], v[212:215], v[80:95]
  ds_read_b128 v[204:207], v16 offset:12288
  buffer_load_dwordx4 v4, s[52:55], s15 offen offset:2048 lds
  buffer_load_dwordx4 v5, s[52:55], s15 offen offset:3072 lds
  v_and_b32 v61, 7, v0
  v_mul_u32_u24 v37, 3456, v60
  v_lshl_add_u32 v37, v61, 4, v37
  s_waitcnt lgkmcnt(6)
  v_mfma_f32_32x32x16_bf16 v[96:111], a[4:7], v[216:219], v[96:111]
  ds_read_b128 v[208:211], v17 offset:0
  s_add_u32 s14, s80, 384
  s_add_u32 m0, s81, 0
  s_nop 0
  buffer_load_dwordx4 v2, s[48:51], s14 offen offset:0 lds
  buffer_load_dwordx4 v[152:155], v37, s[64:67], s13 offen
  s_add_u32 s13, s13, 110592
  buffer_load_dwordx4 v[156:159], v37, s[64:67], s13 offen
  s_add_u32 s13, s13, 110592
  v_mfma_f32_32x32x16_bf16 v[112:127], a[4:7], v[220:223], v[112:127]
  ds_read_b128 v[212:215], v17 offset:8192
  buffer_load_dwordx4 v3, s[48:51], s14 offen offset:1024 lds
  buffer_load_dwordx4 v4, s[48:51], s14 offen offset:2048 lds
  buffer_load_dwordx4 v[160:163], v37, s[64:67], s13 offen
  s_add_u32 s13, s13, 110592
  buffer_load_dwordx4 v[164:167], v37, s[64:67], s13 offen
  s_add_u32 s13, s13, 110592
  s_waitcnt lgkmcnt(4)
  v_mfma_f32_32x32x16_bf16 v[64:79], a[8:11], v[192:195], v[64:79]
  ds_read_b128 v[216:219], v17 offset:4096
  buffer_load_dwordx4 v5, s[48:51], s14 offen offset:3072 lds
  buffer_load_dwordx4 v[168:171], v37, s[64:67], s13 offen
  s_add_u32 s13, s13, 110592
  buffer_load_dwordx4 v[172:175], v37, s[64:67], s13 offen
  s_add_u32 s13, s13, 110592
  buffer_load_dwordx4 v[176:179], v37, s[64:67], s13 offen
  s_add_u32 s13, s13, 110592
  v_mfma_f32_32x32x16_bf16 v[80:95], a[8:11], v[196:199], v[80:95]
  ds_read_b128 v[220:223], v17 offset:12288
  s_add_u32 s15, s83, 384
  s_add_u32 m0, s82, 49152
  s_nop 0
  buffer_load_dwordx4 v2, s[52:55], s15 offen offset:0 lds
  buffer_load_dwordx4 v3, s[52:55], s15 offen offset:1024 lds
  buffer_load_dwordx4 v[180:183], v37, s[64:67], s13 offen
  s_add_u32 s13, s13, 110592
  buffer_load_dwordx4 v[184:187], v37, s[64:67], s13 offen
  s_add_u32 s13, s13, 110592
  s_waitcnt lgkmcnt(4)
  v_mfma_f32_32x32x16_bf16 v[96:111], a[8:11], v[200:203], v[96:111]
  buffer_load_dwordx4 v4, s[52:55], s15 offen offset:2048 lds
  buffer_load_dwordx4 v[188:191], v37, s[64:67], s13 offen
  s_mov_b32 s60, s44
  s_mov_b32 s61, s45
  s_mov_b32 s62, 0x100
  s_mov_b32 s63, 0x20000
  v_mov_b32 v56, 0
  buffer_load_dword v55, v56, s[60:63], 0 offen sc1
  buffer_load_dwordx4 v5, s[52:55], s15 offen offset:3072 lds
  s_waitcnt vmcnt(27)
  s_barrier
  ds_read_b128 v[192:195], v14 offset:16384
  s_add_u32 s15, s83, 512
  s_add_u32 m0, s82, 65536
  s_nop 0
  buffer_load_dwordx4 v2, s[52:55], s15 offen offset:0 lds
  s_waitcnt vmcnt(24)
  v_mfma_f32_32x32x16_bf16 v[112:127], a[8:11], v[204:207], v[112:127]
  ds_read_b128 v[196:199], v14 offset:24576
  ds_read_b128 a[32:35], v6 offset:8192
  s_waitcnt lgkmcnt(5)
  v_mfma_f32_32x32x16_bf16 v[64:79], a[12:15], v[208:211], v[64:79]
  ds_read_b128 v[200:203], v14 offset:20480
  buffer_load_dwordx4 v3, s[52:55], s15 offen offset:1024 lds
  v_mfma_f32_32x32x16_bf16 v[80:95], a[12:15], v[212:215], v[80:95]
  ds_read_b128 v[204:207], v14 offset:28672
  buffer_load_dwordx4 v4, s[52:55], s15 offen offset:2048 lds
  ds_read_b128 a[36:39], v7 offset:8192
  s_waitcnt lgkmcnt(6)
  v_mfma_f32_32x32x16_bf16 v[96:111], a[12:15], v[216:219], v[96:111]
  ds_read_b128 v[208:211], v15 offset:16384
  buffer_load_dwordx4 v5, s[52:55], s15 offen offset:3072 lds
  v_mfma_f32_32x32x16_bf16 v[112:127], a[12:15], v[220:223], v[112:127]
  ds_read_b128 v[212:215], v15 offset:24576
  s_add_u32 s14, s80, 512
  s_add_u32 m0, s81, 4096
  s_nop 0
  buffer_load_dwordx4 v2, s[48:51], s14 offen offset:0 lds
  ds_read_b128 a[40:43], v8 offset:8192
  s_waitcnt lgkmcnt(7)
  v_mfma_f32_32x32x16_bf16 v[64:79], a[16:19], v[192:195], v[64:79]
  ds_read_b128 v[216:219], v15 offset:20480
  buffer_load_dwordx4 v3, s[48:51], s14 offen offset:1024 lds
  ds_read_b128 a[44:47], v9 offset:8192
  v_mfma_f32_32x32x16_bf16 v[80:95], a[16:19], v[196:199], v[80:95]
  ds_read_b128 v[220:223], v15 offset:28672
  buffer_load_dwordx4 v4, s[48:51], s14 offen offset:2048 lds
  s_waitcnt lgkmcnt(7)
  v_mfma_f32_32x32x16_bf16 v[96:111], a[16:19], v[200:203], v[96:111]
  ds_read_b128 v[192:195], v16 offset:16384
  buffer_load_dwordx4 v5, s[48:51], s14 offen offset:3072 lds
  v_lshrrev_b32 v60, 5, v1
  v_mfma_f32_32x32x16_bf16 v[112:127], a[16:19], v[204:207], v[112:127]
  ds_read_b128 v[196:199], v16 offset:24576
  s_add_u32 s15, s83, 640
  s_add_u32 m0, s82, 81920
  s_nop 0
  buffer_load_dwordx4 v2, s[52:55], s15 offen offset:0 lds
  s_waitcnt lgkmcnt(6)
  v_mfma_f32_32x32x16_bf16 v[64:79], a[20:23], v[208:211], v[64:79]
  ds_read_b128 v[200:203], v16 offset:20480
  buffer_load_dwordx4 v3, s[52:55], s15 offen offset:1024 lds
  v_and_b32 v61, 31, v1
  v_mfma_f32_32x32x16_bf16 v[80:95], a[20:23], v[212:215], v[80:95]
  ds_read_b128 v[204:207], v16 offset:28672
  buffer_load_dwordx4 v4, s[52:55], s15 offen offset:2048 lds
  v_mul_u32_u24 v60, 1280, v60
  s_waitcnt lgkmcnt(4)
  v_mfma_f32_32x32x16_bf16 v[96:111], a[20:23], v[216:219], v[96:111]
  ds_read_b128 v[208:211], v17 offset:16384
  buffer_load_dwordx4 v5, s[52:55], s15 offen offset:3072 lds
  v_mfma_f32_32x32x16_bf16 v[112:127], a[20:23], v[220:223], v[112:127]
  ds_read_b128 v[212:215], v17 offset:24576
  s_add_u32 s14, s80, 640
  s_add_u32 m0, s81, 8192
  s_nop 0
  buffer_load_dwordx4 v2, s[48:51], s14 offen offset:0 lds
  v_lshl_add_u32 v60, v61, 3, v60
  s_waitcnt lgkmcnt(4)
  v_mfma_f32_32x32x16_bf16 v[64:79], a[24:27], v[192:195], v[64:79]
  ds_read_b128 v[216:219], v17 offset:20480
  buffer_load_dwordx4 v3, s[48:51], s14 offen offset:1024 lds
  v_mfma_f32_32x32x16_bf16 v[80:95], a[24:27], v[196:199], v[80:95]
  ds_read_b128 v[220:223], v17 offset:28672
  buffer_load_dwordx4 v4, s[48:51], s14 offen offset:2048 lds
  s_lshl_b32 s8, s4, 4
  s_add_u32 s8, s8, s5
  s_lshl_b32 s8, s8, 2
  s_add_u32 s8, s8, s3
  s_mul_i32 s8, s8, 2560
  buffer_load_dwordx2 v[128:129], v60, s[48:51], s8 offen offset:0
  buffer_load_dwordx2 v[130:131], v60, s[48:51], s8 offen offset:256
  buffer_load_dwordx2 v[132:133], v60, s[48:51], s8 offen offset:512
  buffer_load_dwordx2 v[134:135], v60, s[48:51], s8 offen offset:768
  buffer_load_dwordx2 v[136:137], v60, s[48:51], s8 offen offset:1024
  s_waitcnt lgkmcnt(4)
  v_mfma_f32_32x32x16_bf16 v[96:111], a[24:27], v[200:203], v[96:111]
  buffer_load_dwordx4 v5, s[48:51], s14 offen offset:3072 lds
  s_waitcnt vmcnt(40)
  s_barrier
  ds_read_b128 v[192:195], v14 offset:32768
  s_add_u32 s15, s83, 768
  s_add_u32 m0, s82, 0
  s_nop 0
  buffer_load_dwordx4 v2, s[52:55], s15 offen offset:0 lds
  s_waitcnt vmcnt(33)
  ds_read_b128 a[48:51], v6 offset:0
  ds_read_b128 a[52:55], v7 offset:0
  ds_read_b128 a[56:59], v8 offset:0
  ds_read_b128 a[60:63], v9 offset:0
  s_waitcnt vmcnt(24)
  v_mfma_f32_32x32x16_bf16 v[112:127], a[24:27], v[204:207], v[112:127]
  ds_read_b128 v[196:199], v14 offset:40960
  v_lshlrev_b32 v40, 16, v152
  v_and_b32 v41, 0xffff0000, v152
  v_lshlrev_b32 v42, 16, v153
  v_and_b32 v43, 0xffff0000, v153
  v_lshlrev_b32 v44, 16, v154
  s_waitcnt lgkmcnt(8)
  v_mfma_f32_32x32x16_bf16 v[64:79], a[28:31], v[208:211], v[64:79]
  ds_read_b128 v[200:203], v14 offset:36864
  v_and_b32 v45, 0xffff0000, v154
  v_lshlrev_b32 v46, 16, v155
  v_and_b32 v47, 0xffff0000, v155
  v_lshlrev_b32 v38, 16, v156
  v_and_b32 v156, 0xffff0000, v156
  v_add_f32 v40, v40, v38
  v_mfma_f32_32x32x16_bf16 v[80:95], a[28:31], v[212:215], v[80:95]
  ds_read_b128 v[204:207], v14 offset:45056
  buffer_load_dwordx4 v3, s[52:55], s15 offen offset:1024 lds
  v_add_f32 v41, v41, v156
  v_lshlrev_b32 v39, 16, v157
  v_and_b32 v157, 0xffff0000, v157
  v_add_f32 v42, v42, v39
  v_add_f32 v43, v43, v157
  s_waitcnt lgkmcnt(8)
  v_mfma_f32_32x32x16_bf16 v[96:111], a[28:31], v[216:219], v[96:111]
  ds_read_b128 v[208:211], v15 offset:32768
  v_lshlrev_b32 v38, 16, v158
  v_and_b32 v158, 0xffff0000, v158
  v_add_f32 v44, v44, v38
  v_add_f32 v45, v45, v158
  v_lshlrev_b32 v39, 16, v159
  v_and_b32 v159, 0xffff0000, v159
  v_mfma_f32_32x32x16_bf16 v[112:127], a[28:31], v[220:223], v[112:127]
  ds_read_b128 v[212:215], v15 offset:40960
  buffer_load_dwordx4 v4, s[52:55], s15 offen offset:2048 lds
  v_add_f32 v46, v46, v39
  v_add_f32 v47, v47, v159
  v_lshlrev_b32 v38, 16, v160
  v_and_b32 v160, 0xffff0000, v160
  v_add_f32 v40, v40, v38
  s_waitcnt lgkmcnt(4)
  v_mfma_f32_32x32x16_bf16 v[64:79], a[32:35], v[192:195], v[64:79]
  ds_read_b128 v[216:219], v15 offset:36864
  v_add_f32 v41, v41, v160
  v_lshlrev_b32 v39, 16, v161
  v_and_b32 v161, 0xffff0000, v161
  v_add_f32 v42, v42, v39
  v_add_f32 v43, v43, v161
  v_lshlrev_b32 v38, 16, v162
  v_mfma_f32_32x32x16_bf16 v[80:95], a[32:35], v[196:199], v[80:95]
  ds_read_b128 v[220:223], v15 offset:45056
  buffer_load_dwordx4 v5, s[52:55], s15 offen offset:3072 lds
  v_and_b32 v162, 0xffff0000, v162
  v_add_f32 v44, v44, v38
  v_add_f32 v45, v45, v162
  v_lshlrev_b32 v39, 16, v163
  v_and_b32 v163, 0xffff0000, v163
  s_waitcnt lgkmcnt(4)
  v_mfma_f32_32x32x16_bf16 v[96:111], a[32:35], v[200:203], v[96:111]
  ds_read_b128 v[192:195], v16 offset:32768
  v_add_f32 v46, v46, v39
  v_add_f32 v47, v47, v163
  v_lshlrev_b32 v38, 16, v164
  v_and_b32 v164, 0xffff0000, v164
  v_add_f32 v40, v40, v38
  v_add_f32 v41, v41, v164
  v_mfma_f32_32x32x16_bf16 v[112:127], a[32:35], v[204:207], v[112:127]
  ds_read_b128 v[196:199], v16 offset:40960
  s_add_u32 s14, s80, 768
  s_add_u32 m0, s81, 0
  s_nop 0
  buffer_load_dwordx4 v2, s[48:51], s14 offen offset:0 lds
  v_lshlrev_b32 v39, 16, v165
  v_and_b32 v165, 0xffff0000, v165
  v_add_f32 v42, v42, v39
  v_add_f32 v43, v43, v165
  v_lshlrev_b32 v38, 16, v166
  s_waitcnt lgkmcnt(4)
  v_mfma_f32_32x32x16_bf16 v[64:79], a[36:39], v[208:211], v[64:79]
  ds_read_b128 v[200:203], v16 offset:36864
  v_and_b32 v166, 0xffff0000, v166
  v_add_f32 v44, v44, v38
  v_add_f32 v45, v45, v166
  v_lshlrev_b32 v39, 16, v167
  v_and_b32 v167, 0xffff0000, v167
  v_add_f32 v46, v46, v39
  v_mfma_f32_32x32x16_bf16 v[80:95], a[36:39], v[212:215], v[80:95]
  ds_read_b128 v[204:207], v16 offset:45056
  buffer_load_dwordx4 v3, s[48:51], s14 offen offset:1024 lds
  v_add_f32 v47, v47, v167
  v_lshlrev_b32 v38, 16, v168
  v_and_b32 v168, 0xffff0000, v168
  v_add_f32 v40, v40, v38
  v_add_f32 v41, v41, v168
  s_waitcnt lgkmcnt(4)
  v_mfma_f32_32x32x16_bf16 v[96:111], a[36:39], v[216:219], v[96:111]
  ds_read_b128 v[208:211], v17 offset:32768
  v_lshlrev_b32 v39, 16, v169
  v_and_b32 v169, 0xffff0000, v169
  v_add_f32 v42, v42, v39
  v_add_f32 v43, v43, v169
  v_lshlrev_b32 v38, 16, v170
  v_and_b32 v170, 0xffff0000, v170
  v_mfma_f32_32x32x16_bf16 v[112:127], a[36:39], v[220:223], v[112:127]
  ds_read_b128 v[212:215], v17 offset:40960
  buffer_load_dwordx4 v4, s[48:51], s14 offen offset:2048 lds
  v_add_f32 v44, v44, v38
  v_add_f32 v45, v45, v170
  v_lshlrev_b32 v39, 16, v171
  v_and_b32 v171, 0xffff0000, v171
  v_add_f32 v46, v46, v39
  s_waitcnt lgkmcnt(4)
  v_mfma_f32_32x32x16_bf16 v[64:79], a[40:43], v[192:195], v[64:79]
  ds_read_b128 v[216:219], v17 offset:36864
  v_add_f32 v47, v47, v171
  v_lshlrev_b32 v38, 16, v172
  v_and_b32 v172, 0xffff0000, v172
  v_add_f32 v40, v40, v38
  v_add_f32 v41, v41, v172
  v_lshlrev_b32 v39, 16, v173
  v_mfma_f32_32x32x16_bf16 v[80:95], a[40:43], v[196:199], v[80:95]
  ds_read_b128 v[220:223], v17 offset:45056
  buffer_load_dwordx4 v5, s[48:51], s14 offen offset:3072 lds
  v_and_b32 v173, 0xffff0000, v173
  v_add_f32 v42, v42, v39
  v_add_f32 v43, v43, v173
  v_lshlrev_b32 v38, 16, v174
  v_and_b32 v174, 0xffff0000, v174
  s_waitcnt lgkmcnt(4)
  v_mfma_f32_32x32x16_bf16 v[96:111], a[40:43], v[200:203], v[96:111]
  v_add_f32 v44, v44, v38
  v_add_f32 v45, v45, v174
  v_lshlrev_b32 v39, 16, v175
  v_and_b32 v175, 0xffff0000, v175
  v_add_f32 v46, v46, v39
  s_waitcnt vmcnt(29)
  s_barrier
  ds_read_b128 v[192:195], v14 offset:49152
  s_add_u32 s15, s83, 896
  s_add_u32 m0, s82, 16384
  s_nop 0
  buffer_load_dwordx4 v2, s[52:55], s15 offen offset:0 lds
  s_waitcnt vmcnt(22)
  ds_read_b128 a[64:67], v6 offset:4096
  ds_read_b128 a[68:71], v7 offset:4096
  ds_read_b128 a[72:75], v8 offset:4096
  ds_read_b128 a[76:79], v9 offset:4096
  v_add_f32 v47, v47, v175
  v_mfma_f32_32x32x16_bf16 v[112:127], a[40:43], v[204:207], v[112:127]
  ds_read_b128 v[196:199], v14 offset:57344
  v_lshlrev_b32 v38, 16, v176
  v_and_b32 v176, 0xffff0000, v176
  v_add_f32 v40, v40, v38
  v_add_f32 v41, v41, v176
  v_lshlrev_b32 v39, 16, v177
  v_and_b32 v177, 0xffff0000, v177
  s_waitcnt lgkmcnt(8)
  v_mfma_f32_32x32x16_bf16 v[64:79], a[44:47], v[208:211], v[64:79]
  ds_read_b128 v[200:203], v14 offset:53248
  v_add_f32 v42, v42, v39
  v_add_f32 v43, v43, v177
  v_lshlrev_b32 v38, 16, v178
  v_and_b32 v178, 0xffff0000, v178
  v_add_f32 v44, v44, v38
  v_mfma_f32_32x32x16_bf16 v[80:95], a[44:47], v[212:215], v[80:95]
  ds_read_b128 v[204:207], v14 offset:61440
  buffer_load_dwordx4 v3, s[52:55], s15 offen offset:1024 lds
  v_add_f32 v45, v45, v178
  v_lshlrev_b32 v39, 16, v179
  v_and_b32 v179, 0xffff0000, v179
  v_add_f32 v46, v46, v39
  v_add_f32 v47, v47, v179
  v_lshlrev_b32 v38, 16, v180
  s_waitcnt lgkmcnt(8)
  v_mfma_f32_32x32x16_bf16 v[96:111], a[44:47], v[216:219], v[96:111]
  ds_read_b128 v[208:211], v15 offset:49152
  v_and_b32 v180, 0xffff0000, v180
  v_add_f32 v40, v40, v38
  v_add_f32 v41, v41, v180
  v_lshlrev_b32 v39, 16, v181
  v_and_b32 v181, 0xffff0000, v181
  v_mfma_f32_32x32x16_bf16 v[112:127], a[44:47], v[220:223], v[112:127]
  ds_read_b128 v[212:215], v15 offset:57344
  buffer_load_dwordx4 v4, s[52:55], s15 offen offset:2048 lds
  v_add_f32 v42, v42, v39
  v_add_f32 v43, v43, v181
  v_lshlrev_b32 v38, 16, v182
  v_and_b32 v182, 0xffff0000, v182
  v_add_f32 v44, v44, v38
  v_add_f32 v45, v45, v182
  s_waitcnt lgkmcnt(4)
  v_mfma_f32_32x32x16_bf16 v[64:79], a[48:51], v[192:195], v[64:79]
  ds_read_b128 v[216:219], v15 offset:53248
  v_lshlrev_b32 v39, 16, v183
  v_and_b32 v183, 0xffff0000, v183
  v_add_f32 v46, v46, v39
  v_add_f32 v47, v47, v183
  v_lshlrev_b32 v38, 16, v184
  v_mfma_f32_32x32x16_bf16 v[80:95], a[48:51], v[196:199], v[80:95]
  ds_read_b128 v[220:223], v15 offset:61440
  buffer_load_dwordx4 v5, s[52:55], s15 offen offset:3072 lds
  v_and_b32 v184, 0xffff0000, v184
  v_add_f32 v40, v40, v38
  v_add_f32 v41, v41, v184
  v_lshlrev_b32 v39, 16, v185
  v_and_b32 v185, 0xffff0000, v185
  v_add_f32 v42, v42, v39
  s_waitcnt lgkmcnt(4)
  v_mfma_f32_32x32x16_bf16 v[96:111], a[48:51], v[200:203], v[96:111]
  ds_read_b128 v[192:195], v16 offset:49152
  v_add_f32 v43, v43, v185
  v_lshlrev_b32 v38, 16, v186
  v_and_b32 v186, 0xffff0000, v186
  v_add_f32 v44, v44, v38
  v_add_f32 v45, v45, v186
  v_mfma_f32_32x32x16_bf16 v[112:127], a[48:51], v[204:207], v[112:127]
  ds_read_b128 v[196:199], v16 offset:57344
  s_add_u32 s14, s80, 896
  s_add_u32 m0, s81, 4096
  s_nop 0
  buffer_load_dwordx4 v2, s[48:51], s14 offen offset:0 lds
  v_lshlrev_b32 v39, 16, v187
  v_and_b32 v187, 0xffff0000, v187
  v_add_f32 v46, v46, v39
  v_add_f32 v47, v47, v187
  v_lshlrev_b32 v38, 16, v188
  v_and_b32 v188, 0xffff0000, v188
  s_waitcnt lgkmcnt(4)
  v_mfma_f32_32x32x16_bf16 v[64:79], a[52:55], v[208:211], v[64:79]
  ds_read_b128 v[200:203], v16 offset:53248
  v_add_f32 v40, v40, v38
  v_add_f32 v41, v41, v188
  v_lshlrev_b32 v39, 16, v189
  v_and_b32 v189, 0xffff0000, v189
  v_add_f32 v42, v42, v39
  v_mfma_f32_32x32x16_bf16 v[80:95], a[52:55], v[212:215], v[80:95]
  ds_read_b128 v[204:207], v16 offset:61440
  buffer_load_dwordx4 v3, s[48:51], s14 offen offset:1024 lds
  v_add_f32 v43, v43, v189
  v_lshlrev_b32 v38, 16, v190
  v_and_b32 v190, 0xffff0000, v190
  v_add_f32 v44, v44, v38
  v_add_f32 v45, v45, v190
  v_lshlrev_b32 v39, 16, v191
  s_waitcnt lgkmcnt(4)
  v_mfma_f32_32x32x16_bf16 v[96:111], a[52:55], v[216:219], v[96:111]
  ds_read_b128 v[208:211], v17 offset:49152
  v_and_b32 v191, 0xffff0000, v191
  v_add_f32 v46, v46, v39
  v_add_f32 v47, v47, v191
  v_permlane32_swap_b32 v40, v44
  v_permlane32_swap_b32 v41, v45
  v_mfma_f32_32x32x16_bf16 v[112:127], a[52:55], v[220:223], v[112:127]
  ds_read_b128 v[212:215], v17 offset:57344
  buffer_load_dwordx4 v4, s[48:51], s14 offen offset:2048 lds
  v_permlane32_swap_b32 v42, v46
  v_permlane32_swap_b32 v43, v47
  v_add_f32 v40, v40, v44
  v_add_f32 v41, v41, v45
  v_add_f32 v42, v42, v46
  v_add_f32 v43, v43, v47
  s_waitcnt lgkmcnt(4)
  v_mfma_f32_32x32x16_bf16 v[64:79], a[56:59], v[192:195], v[64:79]
  ds_read_b128 v[216:219], v17 offset:53248
  v_permlane16_swap_b32 v40, v42
  v_permlane16_swap_b32 v41, v43
  v_add_f32 v40, v40, v42
  v_add_f32 v41, v41, v43
  v_and_b32 v48, 8, v1
  v_cmp_ne_u32 vcc, 0, v48
  s_nop 1
  v_cndmask_b32 v48, v41, v40, vcc
  v_cndmask_b32 v49, v40, v41, vcc
  v_mfma_f32_32x32x16_bf16 v[80:95], a[56:59], v[196:199], v[80:95]
  ds_read_b128 v[220:223], v17 offset:61440
  buffer_load_dwordx4 v5, s[48:51], s14 offen offset:3072 lds
  v_add_f32_dpp v49, v48, v49 row_ror:8 row_mask:0xf bank_mask:0xf
  v_and_b32 v48, 7, v1
  v_lshlrev_b32 v48, 3, v48
  v_lshrrev_b32 v50, 5, v1
  v_lshl_add_u32 v48, v50, 2, v48
  v_bfe_u32 v50, v1, 4, 1
  s_waitcnt lgkmcnt(4)
  v_mfma_f32_32x32x16_bf16 v[96:111], a[56:59], v[200:203], v[96:111]
  v_lshl_add_u32 v48, v50, 1, v48
  v_bfe_u32 v50, v1, 3, 1
  v_add_u32 v48, v48, v50
  v_lshlrev_b32 v48, 2, v48
  s_lshl_b32 s8, s3, 8
  s_add_u32 s8, s8, 162816
  v_add_u32 v48, s8, v48
  ds_write_b32 v48, v49
  s_waitcnt lgkmcnt(0)
  s_barrier
  ds_read_b128 v[192:195], v18 offset:0
  s_add_u32 s15, s83, 1024
  s_add_u32 m0, s82, 32768
  s_nop 0
  buffer_load_dwordx4 v2, s[52:55], s15 offen offset:0 lds
  s_waitcnt vmcnt(17)
  ds_read_b128 a[80:83], v6 offset:8192
  ds_read_b128 a[84:87], v7 offset:8192
  v_mfma_f32_32x32x16_bf16 v[112:127], a[56:59], v[204:207], v[112:127]
  ds_read_b128 v[196:199], v18 offset:8192
  ds_read_b128 a[88:91], v8 offset:8192
  ds_read_b128 a[92:95], v9 offset:8192
  v_mfma_f32_32x32x16_bf16 v[64:79], a[60:63], v[208:211], v[64:79]
  ds_read_b128 v[200:203], v18 offset:4096
  v_readfirstlane_b32 s6, v55
  s_nop 1
  s_cmp_eq_u32 s6, 0
  s_cbranch_scc1 L_slow_14
L_back_15:
  v_mfma_f32_32x32x16_bf16 v[80:95], a[60:63], v[212:215], v[80:95]
  ds_read_b128 v[204:207], v18 offset:12288
  s_add_u32 m0, s82, 32768
  s_nop 0
  buffer_load_dwordx4 v3, s[52:55], s15 offen offset:1024 lds
  v_lshlrev_b32 v48, 2, v1
  v_add_u32 v48, 162816, v48
  v_mfma_f32_32x32x16_bf16 v[96:111], a[60:63], v[216:219], v[96:111]
  ds_read_b128 v[208:211], v19 offset:0
  ds_read_b32 v40, v48 offset:0
  ds_read_b32 v41, v48 offset:256
  v_mfma_f32_32x32x16_bf16 v[112:127], a[60:63], v[220:223], v[112:127]
  ds_read_b128 v[212:215], v19 offset:8192
  buffer_load_dwordx4 v4, s[52:55], s15 offen offset:2048 lds
  ds_read_b32 v42, v48 offset:512
  ds_read_b32 v43, v48 offset:768
  s_waitcnt lgkmcnt(10)
  v_mfma_f32_32x32x16_bf16 v[64:79], a[64:67], v[192:195], v[64:79]
  ds_read_b128 v[216:219], v19 offset:4096
  v_lshlrev_b32 v48, 3, v1
  s_waitcnt lgkmcnt(1)
  v_mfma_f32_32x32x16_bf16 v[80:95], a[64:67], v[196:199], v[80:95]
  ds_read_b128 v[220:223], v19 offset:12288
  buffer_load_dwordx4 v5, s[52:55], s15 offen offset:3072 lds
  v_add_f32 v40, v40, v41
  v_add_f32 v42, v42, v43
  v_mfma_f32_32x32x16_bf16 v[96:111], a[64:67], v[200:203], v[96:111]
  ds_read_b128 v[192:195], v20 offset:0
  v_add_f32 v40, v40, v42
  v_mov_b32 v41, s6
  v_mfma_f32_32x32x16_bf16 v[112:127], a[64:67], v[204:207], v[112:127]
  ds_read_b128 v[196:199], v20 offset:8192
  s_add_u32 s14, s80, 1024
  s_add_u32 m0, s81, 8192
  s_nop 0
  buffer_load_dwordx4 v2, s[48:51], s14 offen offset:0 lds
  s_cmp_eq_u32 s3, 0
  s_cselect_b32 s8, s93, 0x40000000
  buffer_store_dwordx2 v[40:41], v48, s[56:59], s8 offen sc1
  s_mul_i32 s8, s4, 7
  s_add_u32 s100, s8, s5
  s_cmp_ge_u32 s100, 40
  s_cselect_b32 s64, s24, s22
  s_cselect_b32 s65, s25, s23
  s_cselect_b32 s9, 40, 0
  s_sub_u32 s9, s100, s9
  s_mov_b32 s66, 819200
  s_mov_b32 s67, 0x20000
  s_mul_i32 s9, s9, 20480
  s_cmp_lt_u32 s100, 80
  s_cselect_b32 s9, s9, 0x40000000
  v_mfma_f32_32x32x16_bf16 v[64:79], a[68:71], v[208:211], v[64:79]
  ds_read_b128 v[200:203], v20 offset:4096
  v_lshrrev_b32 v60, 4, v0
  v_and_b32 v61, 15, v0
  v_mfma_f32_32x32x16_bf16 v[80:95], a[68:71], v[212:215], v[80:95]
  ds_read_b128 v[204:207], v20 offset:12288
  buffer_load_dwordx4 v3, s[48:51], s14 offen offset:1024 lds
  v_mul_u32_u24 v37, 1280, v60
  v_lshl_add_u32 v37, v61, 4, v37
  s_waitcnt lgkmcnt(4)
  v_mfma_f32_32x32x16_bf16 v[96:111], a[68:71], v[216:219], v[96:111]
  ds_read_b128 v[208:211], v21 offset:0
  v_and_b32 v60, 127, v0
  s_mul_i32 s8, s5, 96
  v_add_u32 v60, s8, v60
  v_lshlrev_b32 v38, 1, v60
  v_mfma_f32_32x32x16_bf16 v[112:127], a[68:71], v[220:223], v[112:127]
  ds_read_b128 v[212:215], v21 offset:8192
  buffer_load_dwordx4 v4, s[48:51], s14 offen offset:2048 lds
  s_mov_b32 s60, s18
  s_mov_b32 s61, s19
  s_mov_b32 s62, 0x500
  s_mov_b32 s63, 0x20000
  buffer_load_ushort v172, v38, s[60:63], 0 offen
  s_mov_b32 s60, s20
  s_mov_b32 s61, s21
  s_mov_b32 s62, 0x500
  s_mov_b32 s63, 0x20000
  buffer_load_ushort v173, v38, s[60:63], 0 offen
  s_waitcnt lgkmcnt(4)
  v_mfma_f32_32x32x16_bf16 v[64:79], a[72:75], v[192:195], v[64:79]
  ds_read_b128 v[216:219], v21 offset:4096
  s_mov_b32 s60, s30
  s_mov_b32 s61, s31
  s_mov_b32 s62, 0x500
  s_mov_b32 s63, 0x20000
  buffer_load_ushort v174, v38, s[60:63], 0 offen
  buffer_load_dwordx4 v[152:155], v37, s[64:67], s9 offen offset:0
  v_mfma_f32_32x32x16_bf16 v[80:95], a[72:75], v[196:199], v[80:95]
  ds_read_b128 v[220:223], v21 offset:12288
  buffer_load_dwordx4 v5, s[48:51], s14 offen offset:3072 lds
  buffer_load_dwordx4 v[156:159], v37, s[64:67], s9 offen offset:256
  buffer_load_dwordx4 v[160:163], v37, s[64:67], s9 offen offset:512
  s_waitcnt lgkmcnt(4)
  v_mfma_f32_32x32x16_bf16 v[96:111], a[72:75], v[200:203], v[96:111]
  buffer_load_dwordx4 v[164:167], v37, s[64:67], s9 offen offset:768
  buffer_load_dwordx4 v[168:171], v37, s[64:67], s9 offen offset:1024
  s_barrier
  ds_read_b128 v[192:195], v18 offset:16384
  s_add_u32 s15, s83, 1152
  s_add_u32 m0, s82, 49152
  s_nop 0
  buffer_load_dwordx4 v2, s[52:55], s15 offen offset:0 lds
  s_waitcnt vmcnt(25)
  ds_read_b128 a[96:99], v6 offset:0
  ds_read_b128 a[100:103], v7 offset:0
  ds_read_b128 a[104:107], v8 offset:0
  ds_read_b128 a[108:111], v9 offset:0
  v_mfma_f32_32x32x16_bf16 v[112:127], a[72:75], v[204:207], v[112:127]
  ds_read_b128 v[196:199], v18 offset:24576
  v_lshlrev_b32 v40, 16, v128
  v_and_b32 v41, 0xffff0000, v128
  v_mov_b32 v42, v40
  v_mov_b32 v43, v41
  v_mul_f32 v44, v40, v40
  v_mul_f32 v45, v41, v41
  s_waitcnt lgkmcnt(8)
  v_mfma_f32_32x32x16_bf16 v[64:79], a[76:79], v[208:211], v[64:79]
  ds_read_b128 v[200:203], v18 offset:20480
  v_lshlrev_b32 v40, 16, v129
  v_and_b32 v41, 0xffff0000, v129
  v_add_f32 v42, v42, v40
  v_add_f32 v43, v43, v41
  v_fmac_f32 v44, v40, v40
  v_fmac_f32 v45, v41, v41
  v_mfma_f32_32x32x16_bf16 v[80:95], a[76:79], v[212:215], v[80:95]
  ds_read_b128 v[204:207], v18 offset:28672
  buffer_load_dwordx4 v3, s[52:55], s15 offen offset:1024 lds
  v_lshlrev_b32 v40, 16, v130
  v_and_b32 v41, 0xffff0000, v130
  v_add_f32 v42, v42, v40
  v_add_f32 v43, v43, v41
  v_fmac_f32 v44, v40, v40
  v_fmac_f32 v45, v41, v41
  s_waitcnt lgkmcnt(8)
  v_mfma_f32_32x32x16_bf16 v[96:111], a[76:79], v[216:219], v[96:111]
  ds_read_b128 v[208:211], v19 offset:16384
  v_lshlrev_b32 v40, 16, v131
  v_and_b32 v41, 0xffff0000, v131
  v_add_f32 v42, v42, v40
  v_add_f32 v43, v43, v41
  v_fmac_f32 v44, v40, v40
  v_fmac_f32 v45, v41, v41
  v_mfma_f32_32x32x16_bf16 v[112:127], a[76:79], v[220:223], v[112:127]
  ds_read_b128 v[212:215], v19 offset:24576
  buffer_load_dwordx4 v4, s[52:55], s15 offen offset:2048 lds
  v_lshlrev_b32 v40, 16, v132
  v_and_b32 v41, 0xffff0000, v132
  v_add_f32 v42, v42, v40
  v_add_f32 v43, v43, v41
  v_fmac_f32 v44, v40, v40
  v_fmac_f32 v45, v41, v41
  s_waitcnt lgkmcnt(4)
  v_mfma_f32_32x32x16_bf16 v[64:79], a[80:83], v[192:195], v[64:79]
  ds_read_b128 v[216:219], v19 offset:20480
  v_lshlrev_b32 v40, 16, v133
  v_and_b32 v41, 0xffff0000, v133
  v_add_f32 v42, v42, v40
  v_add_f32 v43, v43, v41
  v_fmac_f32 v44, v40, v40
  v_fmac_f32 v45, v41, v41
  v_mfma_f32_32x32x16_bf16 v[80:95], a[80:83], v[196:199], v[80:95]
  ds_read_b128 v[220:223], v19 offset:28672
  buffer_load_dwordx4 v5, s[52:55], s15 offen offset:3072 lds
  v_lshlrev_b32 v40, 16, v134
  v_and_b32 v41, 0xffff0000, v134
  v_add_f32 v42, v42, v40
  v_add_f32 v43, v43, v41
  v_fmac_f32 v44, v40, v40
  v_fmac_f32 v45, v41, v41
  s_waitcnt lgkmcnt(4)
  v_mfma_f32_32x32x16_bf16 v[96:111], a[80:83], v[200:203], v[96:111]
  ds_read_b128 v[192:195], v20 offset:16384
  v_lshlrev_b32 v40, 16, v135
  v_and_b32 v41, 0xffff0000, v135
  v_add_f32 v42, v42, v40
  v_add_f32 v43, v43, v41
  v_fmac_f32 v44, v40, v40
  v_mfma_f32_32x32x16_bf16 v[112:127], a[80:83], v[204:207], v[112:127]
  ds_read_b128 v[196:199], v20 offset:24576
  s_add_u32 s14, s80, 1152
  s_add_u32 m0, s81, 0
  s_nop 0
  buffer_load_dwordx4 v2, s[48:51], s14 offen offset:0 lds
  v_fmac_f32 v45, v41, v41
  v_lshlrev_b32 v40, 16, v136
  v_and_b32 v41, 0xffff0000, v136
  v_add_f32 v42, v42, v40
  v_add_f32 v43, v43, v41
  v_fmac_f32 v44, v40, v40
  s_waitcnt lgkmcnt(4)
  v_mfma_f32_32x32x16_bf16 v[64:79], a[84:87], v[208:211], v[64:79]
  ds_read_b128 v[200:203], v20 offset:20480
  v_fmac_f32 v45, v41, v41
  v_lshlrev_b32 v40, 16, v137
  v_and_b32 v41, 0xffff0000, v137
  v_add_f32 v42, v42, v40
  v_add_f32 v43, v43, v41
  v_fmac_f32 v44, v40, v40
  v_mfma_f32_32x32x16_bf16 v[80:95], a[84:87], v[212:215], v[80:95]
  ds_read_b128 v[204:207], v20 offset:28672
  buffer_load_dwordx4 v3, s[48:51], s14 offen offset:1024 lds
  v_fmac_f32 v45, v41, v41
  v_add_f32 v42, v42, v43
  v_add_f32 v44, v44, v45
  s_nop 0
  v_add_f32_dpp v42, v42, v42 row_ror:8 row_mask:0xf bank_mask:0xf
  v_add_f32_dpp v44, v44, v44 row_ror:8 row_mask:0xf bank_mask:0xf
  s_nop 0
  v_add_f32_dpp v42, v42, v42 row_ror:4 row_mask:0xf bank_mask:0xf
  s_waitcnt lgkmcnt(4)
  v_mfma_f32_32x32x16_bf16 v[96:111], a[84:87], v[216:219], v[96:111]
  ds_read_b128 v[208:211], v21 offset:16384
  v_add_f32_dpp v44, v44, v44 row_ror:4 row_mask:0xf bank_mask:0xf
  v_add_f32_dpp v42, v42, v42 row_ror:2 row_mask:0xf bank_mask:0xf
  s_nop 0
  v_add_f32_dpp v44, v44, v44 row_ror:2 row_mask:0xf bank_mask:0xf
  v_add_f32_dpp v42, v42, v42 row_ror:1 row_mask:0xf bank_mask:0xf
  s_nop 0
  v_add_f32_dpp v44, v44, v44 row_ror:1 row_mask:0xf bank_mask:0xf
  v_mov_b32 v43, v42
  v_mfma_f32_32x32x16_bf16 v[112:127], a[84:87], v[220:223], v[112:127]
  ds_read_b128 v[212:215], v21 offset:24576
  buffer_load_dwordx4 v4, s[48:51], s14 offen offset:2048 lds
  v_mov_b32 v45, v44
  v_permlane16_swap_b32 v42, v43
  s_nop 0
  v_permlane16_swap_b32 v44, v45
  v_add_f32 v42, v42, v43
  v_add_f32 v44, v44, v45
  v_mul_f32 v42, 0x3acccccd, v42
  s_waitcnt lgkmcnt(4)
  v_mfma_f32_32x32x16_bf16 v[64:79], a[88:91], v[192:195], v[64:79]
  ds_read_b128 v[216:219], v21 offset:20480
  v_mul_f32 v44, 0x3acccccd, v44
  v_fma_f32 v44, -v42, v42, v44
  v_max_f32 v44, 0, v44
  v_cvt_pk_bf16_f32 v42, v42, v42
  v_lshlrev_b32 v42, 16, v42
  v_cvt_pk_bf16_f32 v44, v44, v44
  v_mfma_f32_32x32x16_bf16 v[80:95], a[88:91], v[196:199], v[80:95]
  ds_read_b128 v[220:223], v21 offset:28672
  buffer_load_dwordx4 v5, s[48:51], s14 offen offset:3072 lds
  v_lshlrev_b32 v44, 16, v44
  v_add_f32 v44, 0x3727c5ac, v44
  v_cvt_pk_bf16_f32 v44, v44, v44
  v_lshlrev_b32 v44, 16, v44
  v_sqrt_f32 v45, v44
  s_nop 0
  v_cvt_pk_bf16_f32 v45, v45, v45
  s_waitcnt lgkmcnt(4)
  v_mfma_f32_32x32x16_bf16 v[96:111], a[88:91], v[200:203], v[96:111]
  v_lshlrev_b32 v45, 16, v45
  v_lshrrev_b32 v42, 16, v42
  v_or_b32 v42, v42, v45
  v_mov_b32 v43, s6
  v_lshrrev_b32 v40, 5, v1
  v_lshlrev_b32 v40, 3, v40
  v_and_b32 v41, 31, v1
  v_cmp_eq_u32 vcc, 0, v41
  v_mov_b32 v41, 0x40000000
  s_nop 0
  v_cndmask_b32 v40, v41, v40, vcc
  s_lshl_b32 s8, s4, 4
  s_add_u32 s8, s8, s5
  s_lshl_b32 s8, s8, 2
  s_add_u32 s8, s8, s3
  s_lshl_b32 s8, s8, 4
  s_add_u32 s8, s8, 0x1000000
  buffer_store_dwordx2 v[42:43], v40, s[56:59], s8 offen sc1
  s_barrier
  ds_read_b128 v[192:195], v14 offset:0
  s_add_u32 s15, s84, 0
  s_add_u32 m0, s85, 65536
  s_nop 0
  buffer_load_dwordx4 v2, s[52:55], s15 offen offset:0 lds
  s_waitcnt vmcnt(25)
  ds_read_b128 a[112:115], v6 offset:4096
  ds_read_b128 a[116:119], v7 offset:4096
  ds_read_b128 a[120:123], v8 offset:4096
  ds_read_b128 a[124:127], v9 offset:4096
  s_waitcnt vmcnt(9)
  v_lshlrev_b32 v40, 16, v152
  v_and_b32 v41, 0xffff0000, v152
  v_mfma_f32_32x32x16_bf16 v[112:127], a[88:91], v[204:207], v[112:127]
  ds_read_b128 v[196:199], v14 offset:8192
  v_lshlrev_b32 v42, 16, v153
  v_and_b32 v153, 0xffff0000, v153
  v_add_f32 v40, v40, v42
  v_add_f32 v41, v41, v153
  v_lshlrev_b32 v42, 16, v154
  v_and_b32 v154, 0xffff0000, v154
  v_add_f32 v40, v40, v42
  v_add_f32 v41, v41, v154
  s_waitcnt lgkmcnt(8)
  v_mfma_f32_32x32x16_bf16 v[64:79], a[92:95], v[208:211], v[64:79]
  ds_read_b128 v[200:203], v14 offset:4096
  v_lshlrev_b32 v42, 16, v155
  v_and_b32 v155, 0xffff0000, v155
  v_add_f32 v40, v40, v42
  v_add_f32 v41, v41, v155
  v_lshlrev_b32 v42, 16, v156
  v_and_b32 v156, 0xffff0000, v156
  v_add_f32 v40, v40, v42
  v_add_f32 v41, v41, v156
  v_mfma_f32_32x32x16_bf16 v[80:95], a[92:95], v[212:215], v[80:95]
  ds_read_b128 v[204:207], v14 offset:12288
  v_lshlrev_b32 v42, 16, v157
  v_and_b32 v157, 0xffff0000, v157
  v_add_f32 v40, v40, v42
  v_add_f32 v41, v41, v157
  v_lshlrev_b32 v42, 16, v158
  v_and_b32 v158, 0xffff0000, v158
  v_add_f32 v40, v40, v42
  v_add_f32 v41, v41, v158
  s_waitcnt lgkmcnt(8)
  v_mfma_f32_32x32x16_bf16 v[96:111], a[92:95], v[216:219], v[96:111]
  ds_read_b128 v[208:211], v15 offset:0
  v_lshlrev_b32 v42, 16, v159
  v_and_b32 v159, 0xffff0000, v159
  v_add_f32 v40, v40, v42
  v_add_f32 v41, v41, v159
  v_lshlrev_b32 v42, 16, v160
  v_and_b32 v160, 0xffff0000, v160
  v_add_f32 v40, v40, v42
  v_add_f32 v41, v41, v160
  v_mfma_f32_32x32x16_bf16 v[112:127], a[92:95], v[220:223], v[112:127]
  ds_read_b128 v[212:215], v15 offset:8192
  v_lshlrev_b32 v42, 16, v161
  v_and_b32 v161, 0xffff0000, v161
  v_add_f32 v40, v40, v42
  v_add_f32 v41, v41, v161
  v_lshlrev_b32 v42, 16, v162
  v_and_b32 v162, 0xffff0000, v162
  v_add_f32 v40, v40, v42
  v_add_f32 v41, v41, v162
  s_waitcnt lgkmcnt(4)
  v_mfma_f32_32x32x16_bf16 v[64:79], a[96:99], v[192:195], v[64:79]
  ds_read_b128 v[216:219], v15 offset:4096
  v_lshlrev_b32 v42, 16, v163
  v_and_b32 v163, 0xffff0000, v163
  v_add_f32 v40, v40, v42
  v_add_f32 v41, v41, v163
  v_lshlrev_b32 v42, 16, v164
  v_and_b32 v164, 0xffff0000, v164
  v_add_f32 v40, v40, v42
  v_add_f32 v41, v41, v164
  v_mfma_f32_32x32x16_bf16 v[80:95], a[96:99], v[196:199], v[80:95]
  ds_read_b128 v[220:223], v15 offset:12288
  v_lshlrev_b32 v42, 16, v165
  v_and_b32 v165, 0xffff0000, v165
  v_add_f32 v40, v40, v42
  v_add_f32 v41, v41, v165
  v_lshlrev_b32 v42, 16, v166
  v_and_b32 v166, 0xffff0000, v166
  v_add_f32 v40, v40, v42
  v_add_f32 v41, v41, v166
  s_waitcnt lgkmcnt(4)
  v_mfma_f32_32x32x16_bf16 v[96:111], a[96:99], v[200:203], v[96:111]
  ds_read_b128 v[192:195], v16 offset:0
  v_lshlrev_b32 v42, 16, v167
  v_and_b32 v167, 0xffff0000, v167
  v_add_f32 v40, v40, v42
  v_add_f32 v41, v41, v167
  v_lshlrev_b32 v42, 16, v168
  v_and_b32 v168, 0xffff0000, v168
  v_add_f32 v40, v40, v42
  v_mfma_f32_32x32x16_bf16 v[112:127], a[96:99], v[204:207], v[112:127]
  ds_read_b128 v[196:199], v16 offset:8192
  buffer_load_dwordx4 v3, s[52:55], s15 offen offset:1024 lds
  v_add_f32 v41, v41, v168
  v_lshlrev_b32 v42, 16, v169
  v_and_b32 v169, 0xffff0000, v169
  v_add_f32 v40, v40, v42
  v_add_f32 v41, v41, v169
  v_lshlrev_b32 v42, 16, v170
  v_and_b32 v170, 0xffff0000, v170
  v_add_f32 v40, v40, v42
  s_waitcnt lgkmcnt(4)
  v_mfma_f32_32x32x16_bf16 v[64:79], a[100:103], v[208:211], v[64:79]
  ds_read_b128 v[200:203], v16 offset:4096
  v_add_f32 v41, v41, v170
  v_lshlrev_b32 v42, 16, v171
  v_and_b32 v171, 0xffff0000, v171
  v_add_f32 v40, v40, v42
  v_add_f32 v41, v41, v171
  v_add_f32 v40, v40, v41
  s_nop 1
  v_add_f32_dpp v40, v40, v40 row_ror:8 row_mask:0xf bank_mask:0xf
  s_nop 1
  v_add_f32_dpp v40, v40, v40 row_ror:4 row_mask:0xf bank_mask:0xf
  v_mfma_f32_32x32x16_bf16 v[80:95], a[100:103], v[212:215], v[80:95]
  ds_read_b128 v[204:207], v16 offset:12288
  v_add_f32_dpp v40, v40, v40 row_ror:2 row_mask:0xf bank_mask:0xf
  s_nop 1
  v_add_f32_dpp v40, v40, v40 row_ror:1 row_mask:0xf bank_mask:0xf
  v_lshrrev_b32 v42, 4, v0
  v_lshlrev_b32 v42, 3, v42
  v_and_b32 v43, 15, v0
  v_cmp_eq_u32 vcc, 0, v43
  v_mov_b32 v43, 0x40000000
  v_mov_b32 v41, s6
  v_cndmask_b32 v42, v43, v42, vcc
  s_lshl_b32 s8, s100, 7
  s_add_u32 s8, s8, 0x10a0000
  s_cmp_lt_u32 s100, 80
  s_cselect_b32 s8, s8, 0x40000000
  buffer_store_dwordx2 v[40:41], v42, s[56:59], s8 offen sc1
  s_mov_b32 s60, s40
  s_mov_b32 s61, s41
  s_mov_b32 s62, 0x21c000
  s_mov_b32 s63, 0x20000
  v_lshrrev_b32 v60, 3, v0
  v_and_b32 v61, 7, v0
  v_mul_u32_u24 v26, 1280, v60
  v_lshl_add_u32 v26, v61, 4, v26
  s_waitcnt lgkmcnt(4)
  v_mfma_f32_32x32x16_bf16 v[96:111], a[100:103], v[216:219], v[96:111]
  ds_read_b128 v[208:211], v17 offset:0
  v_mul_u32_u24 v27, 160, v60
  v_lshl_add_u32 v27, v61, 4, v27
  v_add_u32 v27, 147456, v27
  s_add_u32 s8, s2, 0
  s_mul_i32 s9, s8, 6554
  s_lshr_b32 s9, s9, 16
  s_mul_i32 s10, s9, 10
  s_sub_u32 s10, s8, s10
  s_mul_i32 s11, s9, 40960
  s_lshl_b32 s12, s10, 7
  s_add_u32 s11, s11, s12
  s_mul_i32 s12, s9, 43
  s_lshr_b32 s12, s12, 8
  s_mul_i32 s13, s12, 6
  s_sub_u32 s13, s9, s13
  s_lshl_b32 s7, s12, 2
  s_add_u32 s7, s7, s13
  s_add_u32 s7, s7, 40
  s_cmp_ge_u32 s12, 5
  s_cselect_b32 s9, 7, 0
  s_add_u32 s7, s7, s9
  s_cmp_eq_u32 s12, 4
  s_cselect_b32 s9, 1, 0
  s_cmp_ge_u32 s13, 2
  s_cselect_b32 s9, s9, 0
  s_mul_i32 s9, s9, 25
  s_add_u32 s7, s7, s9
  s_lshl_b32 s9, s12, 1
  s_add_u32 s9, s9, s13
  s_add_u32 s9, s9, 54
  s_cmp_ge_u32 s12, 5
  s_cselect_b32 s12, 17, 0
  s_add_u32 s9, s9, s12
  s_cmp_eq_u32 s9, 67
  s_cselect_b32 s9, 93, s9
  s_cmp_ge_u32 s13, 4
  s_cselect_b32 s12, s9, s7
  s_mul_i32 s12, s12, 40960
  v_mfma_f32_32x32x16_bf16 v[112:127], a[100:103], v[220:223], v[112:127]
  ds_read_b128 v[212:215], v17 offset:8192
  s_lshl_b32 s13, s10, 2
  s_add_u32 s13, s13, s3
  s_lshl_b32 s13, s13, 10
  s_add_u32 s12, s12, s13
  s_cmp_lt_u32 s8, 540
  s_cselect_b32 s11, s11, 0x40000000
  s_cselect_b32 s86, s12, 0x40000000
  buffer_load_dwordx4 a[164:167], v26, s[60:63], s11 offen
  s_add_u32 s8, s2, 256
  s_mul_i32 s9, s8, 6554
  s_lshr_b32 s9, s9, 16
  s_mul_i32 s10, s9, 10
  s_sub_u32 s10, s8, s10
  s_mul_i32 s11, s9, 40960
  s_lshl_b32 s12, s10, 7
  s_add_u32 s11, s11, s12
  s_mul_i32 s12, s9, 43
  s_lshr_b32 s12, s12, 8
  s_mul_i32 s13, s12, 6
  s_sub_u32 s13, s9, s13
  s_lshl_b32 s7, s12, 2
  s_add_u32 s7, s7, s13
  s_add_u32 s7, s7, 40
  s_cmp_ge_u32 s12, 5
  s_cselect_b32 s9, 7, 0
  s_add_u32 s7, s7, s9
  s_cmp_eq_u32 s12, 4
  s_cselect_b32 s9, 1, 0
  s_cmp_ge_u32 s13, 2
  s_cselect_b32 s9, s9, 0
  s_mul_i32 s9, s9, 25
  s_add_u32 s7, s7, s9
  s_lshl_b32 s9, s12, 1
  s_add_u32 s9, s9, s13
  s_add_u32 s9, s9, 54
  s_cmp_ge_u32 s12, 5
  s_cselect_b32 s12, 17, 0
  s_add_u32 s9, s9, s12
  s_cmp_eq_u32 s9, 67
  s_cselect_b32 s9, 93, s9
  s_cmp_ge_u32 s13, 4
  s_cselect_b32 s12, s9, s7
  s_mul_i32 s12, s12, 40960
  s_lshl_b32 s13, s10, 2
  s_add_u32 s13, s13, s3
  s_lshl_b32 s13, s13, 10
  s_add_u32 s12, s12, s13
  s_waitcnt lgkmcnt(4)
  v_mfma_f32_32x32x16_bf16 v[64:79], a[104:107], v[192:195], v[64:79]
  ds_read_b128 v[216:219], v17 offset:4096
  s_cmp_lt_u32 s8, 540
  s_cselect_b32 s11, s11, 0x40000000
  s_cselect_b32 s87, s12, 0x40000000
  buffer_load_dwordx4 a[168:171], v26, s[60:63], s11 offen
  s_add_u32 s8, s2, 512
  s_mul_i32 s9, s8, 6554
  s_lshr_b32 s9, s9, 16
  s_mul_i32 s10, s9, 10
  s_sub_u32 s10, s8, s10
  s_mul_i32 s11, s9, 40960
  s_lshl_b32 s12, s10, 7
  s_add_u32 s11, s11, s12
  s_mul_i32 s12, s9, 43
  s_lshr_b32 s12, s12, 8
  s_mul_i32 s13, s12, 6
  s_sub_u32 s13, s9, s13
  s_lshl_b32 s7, s12, 2
  s_add_u32 s7, s7, s13
  s_add_u32 s7, s7, 40
  s_cmp_ge_u32 s12, 5
  s_cselect_b32 s9, 7, 0
  s_add_u32 s7, s7, s9
  s_cmp_eq_u32 s12, 4
  s_cselect_b32 s9, 1, 0
  s_cmp_ge_u32 s13, 2
  s_cselect_b32 s9, s9, 0
  s_mul_i32 s9, s9, 25
  s_add_u32 s7, s7, s9
  s_lshl_b32 s9, s12, 1
  s_add_u32 s9, s9, s13
  s_add_u32 s9, s9, 54
  s_cmp_ge_u32 s12, 5
  s_cselect_b32 s12, 17, 0
  s_add_u32 s9, s9, s12
  s_cmp_eq_u32 s9, 67
  s_cselect_b32 s9, 93, s9
  s_cmp_ge_u32 s13, 4
  s_cselect_b32 s12, s9, s7
  s_mul_i32 s12, s12, 40960
  s_lshl_b32 s13, s10, 2
  s_add_u32 s13, s13, s3
  s_lshl_b32 s13, s13, 10
  s_add_u32 s12, s12, s13
  s_cmp_lt_u32 s8, 540
  s_cselect_b32 s11, s11, 0x40000000
  s_cselect_b32 s88, s12, 0x40000000
  buffer_load_dwordx4 a[172:175], v26, s[60:63], s11 offen
  v_mfma_f32_32x32x16_bf16 v[80:95], a[104:107], v[196:199], v[80:95]
  ds_read_b128 v[220:223], v17 offset:12288
  s_mov_b32 s60, s26
  s_mov_b32 s61, s27
  s_mov_b32 s62, 0xc8000
  s_mov_b32 s63, 0x20000
  s_mov_b32 s64, s28
  s_mov_b32 s65, s29
  s_mov_b32 s66, 0xc8000
  s_mov_b32 s67, 0x20000
  v_and_b32 v60, 15, v1
  v_lshrrev_b32 v61, 4, v1
  v_mul_u32_u24 v28, 1280, v60
  v_lshl_add_u32 v28, v61, 3, v28
  v_lshlrev_b32 v29, 4, v1
  s_lshl_b32 s8, s2, 2
  s_add_u32 s8, s8, s3
  s_add_u32 s8, s8, 0
  s_mul_i32 s9, s8, 1639
  s_lshr_b32 s9, s9, 16
  s_waitcnt lgkmcnt(4)
  v_mfma_f32_32x32x16_bf16 v[96:111], a[104:107], v[200:203], v[96:111]
  s_mul_i32 s10, s9, 40
  s_sub_u32 s10, s8, s10
  s_mul_i32 s11, s9, 20480
  s_lshl_b32 s12, s10, 5
  s_add_u32 s11, s11, s12
  s_mul_i32 s12, s10, 40960
  s_lshl_b32 s13, s9, 10
  s_add_u32 s12, s12, s13
  s_cmp_lt_u32 s8, 1600
  s_cselect_b32 s11, s11, 0x40000000
  s_cselect_b32 s89, s12, 0x40000000
  buffer_load_dwordx2 v[176:177], v28, s[60:63], s11 offen
  buffer_load_dwordx2 v[180:181], v28, s[64:67], s11 offen
  s_lshl_b32 s8, s2, 2
  s_add_u32 s8, s8, s3
  s_add_u32 s8, s8, 1024
  s_mul_i32 s9, s8, 1639
  s_lshr_b32 s9, s9, 16
  s_mul_i32 s10, s9, 40
  s_sub_u32 s10, s8, s10
  s_mul_i32 s11, s9, 20480
  s_lshl_b32 s12, s10, 5
  s_add_u32 s11, s11, s12
  s_mul_i32 s12, s10, 40960
  s_lshl_b32 s13, s9, 10
  s_add_u32 s12, s12, s13
  s_cmp_lt_u32 s8, 1600
  s_cselect_b32 s11, s11, 0x40000000
  s_cselect_b32 s90, s12, 0x40000000
  buffer_load_dwordx2 v[178:179], v28, s[60:63], s11 offen
  buffer_load_dwordx2 v[182:183], v28, s[64:67], s11 offen
  s_barrier
  ds_read_b128 v[192:195], v14 offset:16384
  s_add_u32 s15, s84, 128
  s_add_u32 m0, s85, 81920
  s_nop 0
  buffer_load_dwordx4 v2, s[52:55], s15 offen offset:0 lds
  ds_read_b128 a[128:131], v6 offset:8192
  ds_read_b128 a[132:135], v7 offset:8192
  ds_read_b128 a[136:139], v8 offset:8192
  ds_read_b128 a[140:143], v9 offset:8192
  v_mfma_f32_32x32x16_bf16 v[112:127], a[104:107], v[204:207], v[112:127]
  ds_read_b128 v[196:199], v14 offset:24576
  v_lshlrev_b32 v172, 16, v172
  v_lshlrev_b32 v173, 16, v173
  v_lshlrev_b32 v174, 16, v174
  s_waitcnt lgkmcnt(8)
  v_mfma_f32_32x32x16_bf16 v[64:79], a[108:111], v[208:211], v[64:79]
  ds_read_b128 v[200:203], v14 offset:20480
  v_mul_f32 v174, 0x3fb8aa3b, v174
  v_exp_f32 v174, v174
  s_nop 0
  v_cvt_pk_bf16_f32 v174, v174, v174
  v_lshlrev_b32 v174, 16, v174
  v_mfma_f32_32x32x16_bf16 v[80:95], a[108:111], v[212:215], v[80:95]
  ds_read_b128 v[204:207], v14 offset:28672
  v_mul_f32 v33, v174, v172
  v_mul_f32 v34, v174, v173
  v_mul_f32 v33, 0x3fb8aa3b, v33
  v_exp_f32 v33, v33
  s_waitcnt lgkmcnt(8)
  v_mfma_f32_32x32x16_bf16 v[96:111], a[108:111], v[216:219], v[96:111]
  ds_read_b128 v[208:211], v15 offset:16384
  v_mul_f32 v34, 0x3e22f983, v34
  v_rndne_f32 v35, v34
  v_sub_f32 v34, v34, v35
  v_cos_f32 v35, v34
  v_mfma_f32_32x32x16_bf16 v[112:127], a[108:111], v[220:223], v[112:127]
  ds_read_b128 v[212:215], v15 offset:24576
  v_sin_f32 v34, v34
  v_mul_f32 v44, v33, v35
  v_mul_f32 v45, v33, v34
  v_add_f32 v33, -1.0, v44
  v_mul_f32 v34, v172, v172
  s_waitcnt lgkmcnt(4)
  v_mfma_f32_32x32x16_bf16 v[64:79], a[112:115], v[192:195], v[64:79]
  ds_read_b128 v[216:219], v15 offset:20480
  v_fmac_f32 v34, v173, v173
  v_rcp_f32 v34, v34
  s_nop 0
  v_add_f32 v34, v34, v34
  v_mul_f32 v46, v33, v172
  v_mfma_f32_32x32x16_bf16 v[80:95], a[112:115], v[196:199], v[80:95]
  ds_read_b128 v[220:223], v15 offset:28672
  v_fmac_f32 v46, v45, v173
  v_mul_f32 v46, v46, v34
  v_mul_f32 v47, v45, v172
  v_fma_f32 v47, -v33, v173, v47
  s_waitcnt lgkmcnt(4)
  v_mfma_f32_32x32x16_bf16 v[96:111], a[112:115], v[200:203], v[96:111]
  ds_read_b128 v[192:195], v16 offset:16384
  v_mul_f32 v47, v47, v34
  v_mov_b32 v50, v44
  v_mov_b32 v51, v45
  v_mul_f32 v33, v51, v51
  v_mfma_f32_32x32x16_bf16 v[112:127], a[112:115], v[204:207], v[112:127]
  ds_read_b128 v[196:199], v16 offset:24576
  buffer_load_dwordx4 v3, s[52:55], s15 offen offset:1024 lds
  v_mul_f32 v34, v50, v51
  v_fma_f32 v50, v50, v50, -v33
  v_add_f32 v51, v34, v34
  v_mul_f32 v33, v51, v51
  s_waitcnt lgkmcnt(4)
  v_mfma_f32_32x32x16_bf16 v[64:79], a[116:119], v[208:211], v[64:79]
  ds_read_b128 v[200:203], v16 offset:20480
  v_mul_f32 v34, v50, v51
  v_fma_f32 v50, v50, v50, -v33
  v_add_f32 v51, v34, v34
  v_mul_f32 v33, v51, v51
  v_mfma_f32_32x32x16_bf16 v[80:95], a[116:119], v[212:215], v[80:95]
  ds_read_b128 v[204:207], v16 offset:28672
  v_mul_f32 v34, v50, v51
  v_fma_f32 v50, v50, v50, -v33
  v_add_f32 v51, v34, v34
  v_mul_f32 v33, v51, v51
  v_mul_f32 v34, v50, v51
  s_waitcnt lgkmcnt(4)
  v_mfma_f32_32x32x16_bf16 v[96:111], a[116:119], v[216:219], v[96:111]
  ds_read_b128 v[208:211], v17 offset:16384
  v_fma_f32 v50, v50, v50, -v33
  v_add_f32 v51, v34, v34
  v_mov_b32 v52, v50
  v_mov_b32 v53, v51
  v_mfma_f32_32x32x16_bf16 v[112:127], a[116:119], v[220:223], v[112:127]
  ds_read_b128 v[212:215], v17 offset:24576
  v_mul_f32 v33, v53, v53
  v_mul_f32 v34, v52, v53
  v_fma_f32 v52, v52, v52, -v33
  v_add_f32 v53, v34, v34
  s_waitcnt lgkmcnt(4)
  v_mfma_f32_32x32x16_bf16 v[64:79], a[120:123], v[192:195], v[64:79]
  ds_read_b128 v[216:219], v17 offset:20480
  v_mul_f32 v33, v53, v53
  v_mul_f32 v34, v52, v53
  v_fma_f32 v52, v52, v52, -v33
  v_add_f32 v53, v34, v34
  v_mfma_f32_32x32x16_bf16 v[80:95], a[120:123], v[196:199], v[80:95]
  ds_read_b128 v[220:223], v17 offset:28672
  v_mul_f32 v33, v53, v53
  v_mul_f32 v34, v52, v53
  v_fma_f32 v52, v52, v52, -v33
  v_add_f32 v53, v34, v34
  s_waitcnt lgkmcnt(4)
  v_mfma_f32_32x32x16_bf16 v[96:111], a[120:123], v[200:203], v[96:111]
  v_and_b32 v33, 127, v0
  v_lshlrev_b32 v33, 4, v33
  v_add_u32 v33, 147456, v33
  ds_write_b128 v33, v[44:47]
  s_waitcnt lgkmcnt(0)
  s_barrier
  ds_read_b128 v[192:195], v14 offset:32768
  s_add_u32 s15, s84, 256
  s_add_u32 m0, s85, 0
  s_nop 0
  buffer_load_dwordx4 v2, s[52:55], s15 offen offset:0 lds
  s_waitcnt vmcnt(12)
  v_mfma_f32_32x32x16_bf16 v[112:127], a[120:123], v[204:207], v[112:127]
  ds_read_b128 v[196:199], v14 offset:40960
  ds_read_b128 a[144:147], v6 offset:0
  v_mfma_f32_32x32x16_bf16 v[64:79], a[124:127], v[208:211], v[64:79]
  ds_read_b128 v[200:203], v14 offset:36864
  ds_read_b128 a[148:151], v7 offset:0
  v_mfma_f32_32x32x16_bf16 v[80:95], a[124:127], v[212:215], v[80:95]
  ds_read_b128 v[204:207], v14 offset:45056
  ds_read_b128 a[152:155], v8 offset:0
  v_mfma_f32_32x32x16_bf16 v[96:111], a[124:127], v[216:219], v[96:111]
  ds_read_b128 v[208:211], v15 offset:32768
  ds_read_b128 a[156:159], v9 offset:0
  v_mfma_f32_32x32x16_bf16 v[112:127], a[124:127], v[220:223], v[112:127]
  ds_read_b128 v[212:215], v15 offset:40960
  v_and_b32 v60, 31, v1
  s_waitcnt lgkmcnt(8)
  v_mfma_f32_32x32x16_bf16 v[64:79], a[128:131], v[192:195], v[64:79]
  ds_read_b128 v[216:219], v15 offset:36864
  v_lshlrev_b32 v60, 4, v60
  v_mfma_f32_32x32x16_bf16 v[80:95], a[128:131], v[196:199], v[80:95]
  ds_read_b128 v[220:223], v15 offset:45056
  v_add_u32 v60, 147456, v60
  s_waitcnt lgkmcnt(6)
  v_mfma_f32_32x32x16_bf16 v[96:111], a[128:131], v[200:203], v[96:111]
  ds_read_b128 v[192:195], v16 offset:32768
  ds_read_b128 v[34:37], v60 offset:0
  v_mfma_f32_32x32x16_bf16 v[112:127], a[128:131], v[204:207], v[112:127]
  ds_read_b128 v[196:199], v16 offset:40960
  buffer_load_dwordx4 v3, s[52:55], s15 offen offset:1024 lds
  ds_read_b128 v[38:41], v60 offset:512
  s_waitcnt lgkmcnt(6)
  v_mfma_f32_32x32x16_bf16 v[64:79], a[132:135], v[208:211], v[64:79]
  ds_read_b128 v[200:203], v16 offset:36864
  ds_read_b128 v[42:45], v60 offset:1024
  v_mfma_f32_32x32x16_bf16 v[80:95], a[132:135], v[212:215], v[80:95]
  ds_read_b128 v[204:207], v16 offset:45056
  s_waitcnt lgkmcnt(1)
  v_mfma_f32_32x32x16_bf16 v[96:111], a[132:135], v[216:219], v[96:111]
  ds_read_b128 v[208:211], v17 offset:32768
  v_and_b32 v54, 31, v1
  v_mfma_f32_32x32x16_bf16 v[112:127], a[132:135], v[220:223], v[112:127]
  ds_read_b128 v[212:215], v17 offset:40960
  v_lshlrev_b32 v54, 3, v54
  v_mfma_f32_32x32x16_bf16 v[64:79], a[136:139], v[192:195], v[64:79]
  ds_read_b128 v[216:219], v17 offset:36864
  s_mul_i32 s8, s5, 768
  s_add_u32 s8, s8, 0x10a0000
  s_add_u32 s9, s8, 5120
  s_movk_i32 s11, 512
  s_cmp_eq_u32 s5, 6
  s_cselect_b32 s10, 256, s11
  s_add_u32 s11, s9, s10
  s_add_u32 s10, s8, s10
  buffer_load_dwordx2 v[160:161], v54, s[56:59], s8 offen offset:0 sc1
  buffer_load_dwordx2 v[162:163], v54, s[56:59], s9 offen offset:0 sc1
  buffer_load_dwordx2 v[164:165], v54, s[56:59], s8 offen offset:256 sc1
  buffer_load_dwordx2 v[166:167], v54, s[56:59], s9 offen offset:256 sc1
  buffer_load_dwordx2 v[168:169], v54, s[56:59], s10 offen sc1
  buffer_load_dwordx2 v[170:171], v54, s[56:59], s11 offen sc1
  v_mfma_f32_32x32x16_bf16 v[80:95], a[136:139], v[196:199], v[80:95]
  ds_read_b128 v[220:223], v17 offset:45056
  v_lshlrev_b32 v56, 3, v57
  s_waitcnt lgkmcnt(4)
  v_mfma_f32_32x32x16_bf16 v[96:111], a[136:139], v[200:203], v[96:111]
  s_lshl_b32 s8, s4, 2
  s_add_u32 s8, s8, s3
  s_lshl_b32 s8, s8, 8
  s_add_u32 s8, s8, 0x1000000
  buffer_load_dwordx2 v[32:33], v56, s[56:59], s8 offen sc1
  s_barrier
  ds_read_b128 v[192:195], v14 offset:49152
  s_add_u32 s15, s84, 384
  s_add_u32 m0, s85, 16384
  s_nop 0
  buffer_load_dwordx4 v2, s[52:55], s15 offen offset:0 lds
  v_mfma_f32_32x32x16_bf16 v[112:127], a[136:139], v[204:207], v[112:127]
  ds_read_b128 v[196:199], v14 offset:57344
  s_waitcnt lgkmcnt(4)
  v_mfma_f32_32x32x16_bf16 v[64:79], a[140:143], v[208:211], v[64:79]
  ds_read_b128 v[200:203], v14 offset:53248
  v_mfma_f32_32x32x16_bf16 v[80:95], a[140:143], v[212:215], v[80:95]
  ds_read_b128 v[204:207], v14 offset:61440
  s_waitcnt lgkmcnt(4)
  v_mfma_f32_32x32x16_bf16 v[96:111], a[140:143], v[216:219], v[96:111]
  ds_read_b128 v[208:211], v15 offset:49152
  v_mfma_f32_32x32x16_bf16 v[112:127], a[140:143], v[220:223], v[112:127]
  ds_read_b128 v[212:215], v15 offset:57344
  s_waitcnt lgkmcnt(4)
  v_mfma_f32_32x32x16_bf16 v[64:79], a[144:147], v[192:195], v[64:79]
  ds_read_b128 v[216:219], v15 offset:53248
  v_mfma_f32_32x32x16_bf16 v[80:95], a[144:147], v[196:199], v[80:95]
  ds_read_b128 v[220:223], v15 offset:61440
  s_waitcnt lgkmcnt(4)
  v_mfma_f32_32x32x16_bf16 v[96:111], a[144:147], v[200:203], v[96:111]
  ds_read_b128 v[192:195], v16 offset:49152
  v_mfma_f32_32x32x16_bf16 v[112:127], a[144:147], v[204:207], v[112:127]
  ds_read_b128 v[196:199], v16 offset:57344
  buffer_load_dwordx4 v3, s[52:55], s15 offen offset:1024 lds
  s_waitcnt lgkmcnt(4)
  v_mfma_f32_32x32x16_bf16 v[64:79], a[148:151], v[208:211], v[64:79]
  ds_read_b128 v[200:203], v16 offset:53248
  v_mfma_f32_32x32x16_bf16 v[80:95], a[148:151], v[212:215], v[80:95]
  ds_read_b128 v[204:207], v16 offset:61440
  s_waitcnt lgkmcnt(4)
  v_mfma_f32_32x32x16_bf16 v[96:111], a[148:151], v[216:219], v[96:111]
  ds_read_b128 v[208:211], v17 offset:49152
  v_mfma_f32_32x32x16_bf16 v[112:127], a[148:151], v[220:223], v[112:127]
  ds_read_b128 v[212:215], v17 offset:57344
  s_waitcnt lgkmcnt(4)
  v_mfma_f32_32x32x16_bf16 v[64:79], a[152:155], v[192:195], v[64:79]
  ds_read_b128 v[216:219], v17 offset:53248
  v_mfma_f32_32x32x16_bf16 v[80:95], a[152:155], v[196:199], v[80:95]
  ds_read_b128 v[220:223], v17 offset:61440
  s_waitcnt lgkmcnt(4)
  v_mfma_f32_32x32x16_bf16 v[96:111], a[152:155], v[200:203], v[96:111]
  s_waitcnt vmcnt(20)
  s_barrier
  ds_read_b128 v[192:195], v18 offset:0
  s_add_u32 s15, s84, 512
  s_add_u32 m0, s85, 32768
  s_nop 0
  buffer_load_dwordx4 v2, s[52:55], s15 offen offset:0 lds
  s_waitcnt vmcnt(18)
  ds_write_b128 v27, a[164:167] offset:0
  v_mfma_f32_32x32x16_bf16 v[112:127], a[152:155], v[204:207], v[112:127]
  ds_read_b128 v[196:199], v18 offset:8192
  ds_write_b128 v27, a[168:171] offset:5120
  s_waitcnt lgkmcnt(6)
  v_mfma_f32_32x32x16_bf16 v[64:79], a[156:159], v[208:211], v[64:79]
  ds_read_b128 v[200:203], v19 offset:0
  ds_write_b128 v27, a[172:175] offset:10240
  s_waitcnt vmcnt(14)
  v_mfma_f32_32x32x16_bf16 v[80:95], a[156:159], v[212:215], v[80:95]
  ds_read_b128 v[204:207], v19 offset:8192
  v_xor_b32 v180, 0x80008000, v180
  s_waitcnt lgkmcnt(7)
  v_mfma_f32_32x32x16_bf16 v[96:111], a[156:159], v[216:219], v[96:111]
  ds_read_b128 v[208:211], v20 offset:0
  v_xor_b32 v181, 0x80008000, v181
  s_mov_b32 s8, 0x05040100
  s_mov_b32 s9, 0x07060302
  v_perm_b32 v184, v180, v176, s8
  v_perm_b32 v185, v180, v176, s9
  v_perm_b32 v186, v181, v177, s8
  v_perm_b32 v187, v181, v177, s9
  v_mfma_f32_32x32x16_bf16 v[112:127], a[156:159], v[220:223], v[112:127]
  ds_read_b128 v[212:215], v20 offset:8192
  buffer_load_dwordx4 v3, s[52:55], s15 offen offset:1024 lds
  buffer_store_dwordx4 v[184:187], v29, s[56:59], s89 offen sc1
  s_waitcnt lgkmcnt(6)
  v_mfma_f32_32x32x16_bf16 v[128:143], a[0:3], v[192:195], 0
  ds_read_b128 v[216:219], v21 offset:0
  v_xor_b32 v182, 0x80008000, v182
  v_xor_b32 v183, 0x80008000, v183
  v_mfma_f32_32x32x16_bf16 v[144:159], a[0:3], v[196:199], 0
  ds_read_b128 v[220:223], v21 offset:8192
  s_mov_b32 s8, 0x05040100
  s_mov_b32 s9, 0x07060302
  v_perm_b32 v188, v182, v178, s8
  v_perm_b32 v189, v182, v178, s9
  v_perm_b32 v190, v183, v179, s8
  v_perm_b32 v191, v183, v179, s9
  s_waitcnt lgkmcnt(4)
  v_mfma_f32_32x32x16_bf16 v[128:143], a[4:7], v[200:203], v[128:143]
  buffer_store_dwordx4 v[188:191], v29, s[56:59], s90 offen sc1
  s_waitcnt vmcnt(13)
  s_barrier
  ds_read_b128 v[192:195], v18 offset:16384
  s_add_u32 s15, s84, 640
  s_add_u32 m0, s85, 49152
  s_nop 0
  buffer_load_dwordx4 v2, s[52:55], s15 offen offset:0 lds
  v_lshrrev_b32 v60, 4, v1
  v_and_b32 v61, 15, v1
  v_lshrrev_b32 v62, 1, v60
  v_lshlrev_b32 v62, 4, v62
  v_and_b32 v60, 1, v60
  v_lshl_add_u32 v62, v60, 2, v62
  v_lshrrev_b32 v60, 2, v61
  v_add_u32 v62, v62, v60
  v_mul_u32_u24 v62, 160, v62
  v_mfma_f32_32x32x16_bf16 v[144:159], a[4:7], v[204:207], v[144:159]
  ds_read_b128 v[196:199], v18 offset:24576
  v_and_b32 v61, 3, v61
  v_lshl_add_u32 v62, v61, 3, v62
  s_lshl_b32 s8, s3, 5
  s_add_u32 s8, s8, 147456
  v_add_u32 v62, s8, v62
  ds_read_b64_tr_b16 a[176:177], v62 offset:0
  ds_read_b64_tr_b16 a[178:179], v62 offset:1280
  ds_read_b64_tr_b16 a[180:181], v62 offset:5120
  ds_read_b64_tr_b16 a[182:183], v62 offset:6400
  ds_read_b64_tr_b16 a[184:185], v62 offset:10240
  ds_read_b64_tr_b16 a[186:187], v62 offset:11520
  s_waitcnt lgkmcnt(10)
  v_mfma_f32_32x32x16_bf16 v[128:143], a[8:11], v[208:211], v[128:143]
  ds_read_b128 v[200:203], v19 offset:16384
  s_waitcnt lgkmcnt(1)
  buffer_store_dwordx4 a[176:179], v29, s[56:59], s86 offen sc1
  buffer_store_dwordx4 a[180:183], v29, s[56:59], s87 offen sc1
  buffer_store_dwordx4 a[184:187], v29, s[56:59], s88 offen sc1
  s_waitcnt vmcnt(5)
  v_xor_b32 v60, s6, v33
  v_cmp_ne_u32 vcc, 0, v60
  s_nop 1
  s_cmp_eq_u64 vcc, 0
  s_cbranch_scc0 L_slow_17
L_back_18:
  v_lshlrev_b32 v26, 16, v32
  v_mfma_f32_32x32x16_bf16 v[144:159], a[8:11], v[212:215], v[144:159]
  ds_read_b128 v[204:207], v19 offset:24576
  v_and_b32 v28, 0xffff0000, v32
  v_rcp_f32 v27, v28
  v_xor_b32 v60, s6, v161
  v_xor_b32 v61, s6, v163
  v_or_b32 v60, v60, v61
  v_xor_b32 v61, s6, v165
  v_or_b32 v60, v60, v61
  v_xor_b32 v61, s6, v167
  v_mfma_f32_32x32x16_bf16 v[128:143], a[12:15], v[216:219], v[128:143]
  ds_read_b128 v[208:211], v20 offset:16384
  v_or_b32 v60, v60, v61
  v_xor_b32 v61, s6, v169
  v_or_b32 v60, v60, v61
  v_xor_b32 v61, s6, v171
  v_or_b32 v60, v60, v61
  v_cmp_ne_u32 vcc, 0, v60
  s_nop 1
  s_cmp_eq_u64 vcc, 0
  s_cbranch_scc0 L_slow_20
L_back_21:
  v_mov_b32 v6, v160
  v_cvt_pk_bf16_f32 v60, v6, v6
  v_mfma_f32_32x32x16_bf16 v[144:159], a[12:15], v[220:223], v[144:159]
  ds_read_b128 v[212:215], v20 offset:24576
  s_add_u32 m0, s85, 49152
  s_nop 0
  buffer_load_dwordx4 v3, s[52:55], s15 offen offset:1024 lds
  v_lshlrev_b32 v60, 16, v60
  v_sub_f32 v60, v6, v60
  v_cvt_pk_bf16_f32 v6, v6, v60
  v_mov_b32 v7, v162
  v_cvt_pk_bf16_f32 v61, v7, v7
  v_lshlrev_b32 v61, 16, v61
  v_sub_f32 v61, v7, v61
  v_cvt_pk_bf16_f32 v7, v7, v61
  v_mov_b32 v8, v164
  v_mfma_f32_32x32x16_bf16 v[128:143], a[16:19], v[192:195], v[128:143]
  ds_read_b128 v[216:219], v21 offset:16384
  v_cvt_pk_bf16_f32 v60, v8, v8
  v_lshlrev_b32 v60, 16, v60
  v_sub_f32 v60, v8, v60
  v_cvt_pk_bf16_f32 v8, v8, v60
  v_mov_b32 v9, v166
  v_cvt_pk_bf16_f32 v61, v9, v9
  v_lshlrev_b32 v61, 16, v61
  v_sub_f32 v61, v9, v61
  v_mfma_f32_32x32x16_bf16 v[144:159], a[16:19], v[196:199], v[144:159]
  ds_read_b128 v[220:223], v21 offset:24576
  v_cvt_pk_bf16_f32 v9, v9, v61
  v_mov_b32 v22, v168
  v_cvt_pk_bf16_f32 v60, v22, v22
  v_lshlrev_b32 v60, 16, v60
  v_sub_f32 v60, v22, v60
  v_cvt_pk_bf16_f32 v22, v22, v60
  v_mov_b32 v23, v170
  v_cvt_pk_bf16_f32 v61, v23, v23
  v_lshlrev_b32 v61, 16, v61
  s_waitcnt lgkmcnt(4)
  v_mfma_f32_32x32x16_bf16 v[128:143], a[20:23], v[200:203], v[128:143]
  v_sub_f32 v61, v23, v61
  v_cvt_pk_bf16_f32 v23, v23, v61
  v_cmp_gt_u32 vcc, 32, v1
  s_nop 1
  v_cndmask_b32 v6, 0, v6, vcc
  v_cndmask_b32 v7, 0, v7, vcc
  v_cndmask_b32 v8, 0, v8, vcc
  v_cndmask_b32 v9, 0, v9, vcc
  v_cndmask_b32 v22, 0, v22, vcc
  v_cndmask_b32 v23, 0, v23, vcc
  v_xor_b32 v60, 0x80000000, v26
  v_lshrrev_b32 v61, 16, v60
  v_or_b32 v60, v60, v61
  v_cmp_gt_u32 vcc, 32, v1
  s_nop 1
  v_cndmask_b32 v60, 0, v60, vcc
  v_accvgpr_write_b32 a160, v60
  v_accvgpr_write_b32 a161, 0
  v_accvgpr_write_b32 a162, 0
  v_accvgpr_write_b32 a163, 0
  s_lshl_b32 s8, s3, 7
  s_add_u32 s8, s8, 162816
  v_lshl_add_u32 v60, v57, 2, s8
  ds_write_b32 v60, v27
  s_barrier
  ds_read_b128 v[192:195], v14 offset:0
  s_add_u32 s15, s84, 768
  s_add_u32 m0, s85, 65536
  s_nop 0
  buffer_load_dwordx4 v2, s[52:55], s15 offen offset:0 lds
  s_waitcnt lgkmcnt(1)
  s_lshl_b32 s8, s3, 7
  s_add_u32 s8, s8, 162816
  v_lshrrev_b32 v60, 5, v1
  v_lshl_add_u32 v60, v60, 6, s8
  v_mfma_f32_32x32x16_bf16 v[144:159], a[20:23], v[204:207], v[144:159]
  ds_read_b128 v[196:199], v14 offset:8192
  ds_read_b128 v[224:227], v60 offset:0
  ds_read_b128 v[228:231], v60 offset:16
  v_mfma_f32_32x32x16_bf16 v[128:143], a[24:27], v[208:211], v[128:143]
  ds_read_b128 v[200:203], v15 offset:0
  ds_read_b128 v[232:235], v60 offset:32
  v_mfma_f32_32x32x16_bf16 v[144:159], a[24:27], v[212:215], v[144:159]
  ds_read_b128 v[204:207], v15 offset:8192
  ds_read_b128 v[236:239], v60 offset:48
  s_waitcnt lgkmcnt(0)
  v_mfma_f32_32x32x16_bf16 v[128:143], a[28:31], v[216:219], v[128:143]
  ds_read_b128 v[208:211], v16 offset:0
  v_mov_b32 v240, v6
  v_mov_b32 v244, v7
  v_mfma_f32_32x32x16_bf16 v[144:159], a[28:31], v[220:223], v[144:159]
  ds_read_b128 v[212:215], v16 offset:8192
  buffer_load_dwordx4 v3, s[52:55], s15 offen offset:1024 lds
  v_mov_b32 v248, v8
  v_mfma_f32_32x32x16_bf16 v[128:143], a[32:35], v[192:195], v[128:143]
  ds_read_b128 v[216:219], v17 offset:0
  v_mov_b32 v252, v9
  v_mfma_f32_32x32x16_bf16 v[64:79], a[160:163], v[240:243], v[64:79]
  v_mfma_f32_32x32x16_bf16 v[144:159], a[32:35], v[196:199], v[144:159]
  ds_read_b128 v[220:223], v17 offset:8192
  v_mfma_f32_32x32x16_bf16 v[80:95], a[160:163], v[244:247], v[80:95]
  v_mfma_f32_32x32x16_bf16 v[96:111], a[160:163], v[248:251], v[96:111]
  v_mfma_f32_32x32x16_bf16 v[128:143], a[36:39], v[200:203], v[128:143]
  v_mfma_f32_32x32x16_bf16 v[112:127], a[160:163], v[252:255], v[112:127]
  s_waitcnt vmcnt(6)
  s_barrier
  ds_read_b128 v[192:195], v14 offset:16384
  s_add_u32 s15, s84, 896
  s_add_u32 m0, s85, 81920
  s_nop 0
  buffer_load_dwordx4 v2, s[52:55], s15 offen offset:0 lds
  v_and_b32 v60, 127, v0
  v_lshlrev_b32 v60, 4, v60
  v_add_u32 v60, 114688, v60
  ds_write_b128 v60, v[50:53]
  s_and_b32 s8, s2, 7
  s_lshr_b32 s9, s2, 3
  s_lshr_b32 s10, s8, 1
  s_lshl_b32 s10, s10, 3
  s_lshr_b32 s11, s9, 2
  s_add_u32 s10, s10, s11
  s_lshl_b32 s81, s10, 12
  s_and_b32 s8, s8, 1
  s_lshl_b32 s8, s8, 2
  s_and_b32 s9, s9, 3
  s_add_u32 s9, s9, s8
  s_mul_i32 s80, s9, 5120
  s_mul_i32 s8, s3, 20
  s_cmp_eq_u32 s3, 3
  s_cselect_b32 s8, 67, s8
  s_sub_u32 s9, 94, s8
  s_mul_i32 s10, s8, 131072
  s_add_u32 s10, s10, 0x400000
  s_add_u32 s72, s46, s10
  s_addc_u32 s73, s47, 0
  s_mov_b32 s74, 0
  s_mov_b32 s75, 0x20000
  s_mul_i32 s74, s9, 131072
  s_mul_i32 s10, s8, 40960
  s_add_u32 s76, s46, s10
  s_addc_u32 s77, s47, 0
  s_mov_b32 s78, 0
  s_mov_b32 s79, 0x20000
  s_mul_i32 s78, s9, 40960
  v_lshlrev_b32 v54, 4, v1
  v_add_u32 v56, 4096, v54
  v_mfma_f32_32x32x16_bf16 v[144:159], a[36:39], v[204:207], v[144:159]
  ds_read_b128 v[196:199], v14 offset:24576
  v_mul_f32 v10, v36, v64
  v_mul_f32 v12, v36, v65
  v_mul_f32 v11, v36, v80
  v_mul_f32 v13, v36, v81
  v_fma_f32 v10, -v37, v80, v10
  v_fma_f32 v12, -v37, v81, v12
  v_fma_f32 v11, v37, v64, v11
  v_fma_f32 v13, v37, v65, v13
  s_waitcnt lgkmcnt(5)
  v_mfma_f32_32x32x16_bf16 v[128:143], a[40:43], v[208:211], v[128:143]
  ds_read_b128 v[200:203], v15 offset:16384
  v_mul_f32 v64, v10, v224
  v_mul_f32 v65, v12, v225
  v_mul_f32 v80, v11, v224
  v_mul_f32 v81, v13, v225
  v_mul_f32 v10, v36, v66
  v_mul_f32 v12, v36, v67
  v_mul_f32 v11, v36, v82
  v_mul_f32 v13, v36, v83
  v_mfma_f32_32x32x16_bf16 v[144:159], a[40:43], v[212:215], v[144:159]
  ds_read_b128 v[204:207], v15 offset:24576
  v_fma_f32 v10, -v37, v82, v10
  v_fma_f32 v12, -v37, v83, v12
  v_fma_f32 v11, v37, v66, v11
  v_fma_f32 v13, v37, v67, v13
  v_mul_f32 v66, v10, v226
  v_mul_f32 v67, v12, v227
  v_mul_f32 v82, v11, v226
  v_mul_f32 v83, v13, v227
  s_waitcnt lgkmcnt(5)
  v_mfma_f32_32x32x16_bf16 v[128:143], a[44:47], v[216:219], v[128:143]
  ds_read_b128 v[208:211], v16 offset:16384
  v_mul_f32 v10, v36, v68
  v_mul_f32 v12, v36, v69
  v_mul_f32 v11, v36, v84
  v_mul_f32 v13, v36, v85
  v_fma_f32 v10, -v37, v84, v10
  v_fma_f32 v12, -v37, v85, v12
  v_fma_f32 v11, v37, v68, v11
  v_fma_f32 v13, v37, v69, v13
  v_mfma_f32_32x32x16_bf16 v[144:159], a[44:47], v[220:223], v[144:159]
  ds_read_b128 v[212:215], v16 offset:24576
  buffer_load_dwordx4 v3, s[52:55], s15 offen offset:1024 lds
  v_mul_f32 v68, v10, v228
  v_mul_f32 v69, v12, v229
  v_mul_f32 v84, v11, v228
  v_mul_f32 v85, v13, v229
  v_mul_f32 v10, v36, v70
  v_mul_f32 v12, v36, v71
  v_mul_f32 v11, v36, v86
  v_mul_f32 v13, v36, v87
  s_waitcnt lgkmcnt(4)
  v_mfma_f32_32x32x16_bf16 v[128:143], a[48:51], v[192:195], v[128:143]
  ds_read_b128 v[216:219], v17 offset:16384
  v_fma_f32 v10, -v37, v86, v10
  v_fma_f32 v12, -v37, v87, v12
  v_fma_f32 v11, v37, v70, v11
  v_fma_f32 v13, v37, v71, v13
  v_mul_f32 v70, v10, v230
  v_mul_f32 v71, v12, v231
  v_mul_f32 v86, v11, v230
  v_mul_f32 v87, v13, v231
  v_mfma_f32_32x32x16_bf16 v[144:159], a[48:51], v[196:199], v[144:159]
  ds_read_b128 v[220:223], v17 offset:24576
  v_mul_f32 v10, v36, v72
  v_mul_f32 v12, v36, v73
  v_mul_f32 v11, v36, v88
  v_mul_f32 v13, v36, v89
  v_fma_f32 v10, -v37, v88, v10
  v_fma_f32 v12, -v37, v89, v12
  v_fma_f32 v11, v37, v72, v11
  v_fma_f32 v13, v37, v73, v13
  s_waitcnt lgkmcnt(4)
  v_mfma_f32_32x32x16_bf16 v[128:143], a[52:55], v[200:203], v[128:143]
  v_mul_f32 v72, v10, v232
  v_mul_f32 v73, v12, v233
  v_mul_f32 v88, v11, v232
  v_mul_f32 v89, v13, v233
  v_mul_f32 v10, v36, v74
  v_mul_f32 v12, v36, v75
  v_mul_f32 v11, v36, v90
  s_waitcnt vmcnt(6)
  s_barrier
  ds_read_b128 v[192:195], v14 offset:32768
  s_add_u32 s15, s84, 1024
  s_add_u32 m0, s85, 0
  s_nop 0
  buffer_load_dwordx4 v2, s[52:55], s15 offen offset:0 lds
  v_mul_f32 v13, v36, v91
  v_fma_f32 v10, -v37, v90, v10
  v_fma_f32 v12, -v37, v91, v12
  v_fma_f32 v11, v37, v74, v11
  v_fma_f32 v13, v37, v75, v13
  v_mul_f32 v74, v10, v234
  v_mul_f32 v75, v12, v235
  v_mfma_f32_32x32x16_bf16 v[144:159], a[52:55], v[204:207], v[144:159]
  ds_read_b128 v[196:199], v14 offset:40960
  v_mul_f32 v90, v11, v234
  v_mul_f32 v91, v13, v235
  v_mul_f32 v10, v36, v76
  v_mul_f32 v12, v36, v77
  v_mul_f32 v11, v36, v92
  v_mul_f32 v13, v36, v93
  v_fma_f32 v10, -v37, v92, v10
  s_waitcnt lgkmcnt(4)
  v_mfma_f32_32x32x16_bf16 v[128:143], a[56:59], v[208:211], v[128:143]
  ds_read_b128 v[200:203], v15 offset:32768
  v_fma_f32 v12, -v37, v93, v12
  v_fma_f32 v11, v37, v76, v11
  v_fma_f32 v13, v37, v77, v13
  v_mul_f32 v76, v10, v236
  v_mul_f32 v77, v12, v237
  v_mul_f32 v92, v11, v236
  v_mul_f32 v93, v13, v237
  v_mfma_f32_32x32x16_bf16 v[144:159], a[56:59], v[212:215], v[144:159]
  ds_read_b128 v[204:207], v15 offset:40960
  v_mul_f32 v10, v36, v78
  v_mul_f32 v12, v36, v79
  v_mul_f32 v11, v36, v94
  v_mul_f32 v13, v36, v95
  v_fma_f32 v10, -v37, v94, v10
  v_fma_f32 v12, -v37, v95, v12
  v_fma_f32 v11, v37, v78, v11
  s_waitcnt lgkmcnt(4)
  v_mfma_f32_32x32x16_bf16 v[128:143], a[60:63], v[216:219], v[128:143]
  ds_read_b128 v[208:211], v16 offset:32768
  v_fma_f32 v13, v37, v79, v13
  v_mul_f32 v78, v10, v238
  v_mul_f32 v79, v12, v239
  v_mul_f32 v94, v11, v238
  v_mul_f32 v95, v13, v239
  v_mul_f32 v10, v40, v96
  v_mul_f32 v12, v40, v97
  v_mfma_f32_32x32x16_bf16 v[144:159], a[60:63], v[220:223], v[144:159]
  ds_read_b128 v[212:215], v16 offset:40960
  buffer_load_dwordx4 v3, s[52:55], s15 offen offset:1024 lds
  v_mul_f32 v11, v40, v112
  v_mul_f32 v13, v40, v113
  v_fma_f32 v10, -v41, v112, v10
  v_fma_f32 v12, -v41, v113, v12
  v_fma_f32 v11, v41, v96, v11
  v_fma_f32 v13, v41, v97, v13
  v_mul_f32 v96, v10, v224
  s_waitcnt lgkmcnt(4)
  v_mfma_f32_32x32x16_bf16 v[128:143], a[64:67], v[192:195], v[128:143]
  ds_read_b128 v[216:219], v17 offset:32768
  v_mul_f32 v97, v12, v225
  v_mul_f32 v112, v11, v224
  v_mul_f32 v113, v13, v225
  v_mul_f32 v10, v40, v98
  v_mul_f32 v12, v40, v99
  v_mul_f32 v11, v40, v114
  v_mul_f32 v13, v40, v115
  v_mfma_f32_32x32x16_bf16 v[144:159], a[64:67], v[196:199], v[144:159]
  ds_read_b128 v[220:223], v17 offset:40960
  v_fma_f32 v10, -v41, v114, v10
  v_fma_f32 v12, -v41, v115, v12
  v_fma_f32 v11, v41, v98, v11
  v_fma_f32 v13, v41, v99, v13
  v_mul_f32 v98, v10, v226
  v_mul_f32 v99, v12, v227
  v_mul_f32 v114, v11, v226
  s_waitcnt lgkmcnt(4)
  v_mfma_f32_32x32x16_bf16 v[128:143], a[68:71], v[200:203], v[128:143]
  v_mul_f32 v115, v13, v227
  v_mul_f32 v10, v40, v100
  v_mul_f32 v12, v40, v101
  v_mul_f32 v11, v40, v116
  v_mul_f32 v13, v40, v117
  v_fma_f32 v10, -v41, v116, v10
  v_fma_f32 v12, -v41, v117, v12
  s_waitcnt vmcnt(6)
  s_waitcnt vmcnt(6)
  s_barrier
  ds_read_b128 v[192:195], v14 offset:49152
  s_add_u32 s15, s84, 1152
  s_add_u32 m0, s85, 16384
  s_nop 0
  buffer_load_dwordx4 v2, s[52:55], s15 offen offset:0 lds
  s_lshl_b32 s8, s2, 2
  s_add_u32 s8, s8, 0x10b0000
  v_mov_b32 v58, s6
  buffer_store_dword v58, v59, s[56:59], s8 offen sc1
  v_fma_f32 v11, v41, v100, v11
  v_fma_f32 v13, v41, v101, v13
  v_mul_f32 v100, v10, v228
  v_mul_f32 v101, v12, v229
  v_mul_f32 v116, v11, v228
  v_mul_f32 v117, v13, v229
  v_mul_f32 v10, v40, v102
  v_mfma_f32_32x32x16_bf16 v[144:159], a[68:71], v[204:207], v[144:159]
  ds_read_b128 v[196:199], v14 offset:57344
  v_mul_f32 v12, v40, v103
  v_mul_f32 v11, v40, v118
  v_mul_f32 v13, v40, v119
  v_fma_f32 v10, -v41, v118, v10
  v_fma_f32 v12, -v41, v119, v12
  v_fma_f32 v11, v41, v102, v11
  v_fma_f32 v13, v41, v103, v13
  s_waitcnt lgkmcnt(4)
  v_mfma_f32_32x32x16_bf16 v[128:143], a[72:75], v[208:211], v[128:143]
  ds_read_b128 v[200:203], v15 offset:49152
  v_mul_f32 v102, v10, v230
  v_mul_f32 v103, v12, v231
  v_mul_f32 v118, v11, v230
  v_mul_f32 v119, v13, v231
  v_mul_f32 v10, v40, v104
  v_mul_f32 v12, v40, v105
  v_mul_f32 v11, v40, v120
  v_mfma_f32_32x32x16_bf16 v[144:159], a[72:75], v[212:215], v[144:159]
  ds_read_b128 v[204:207], v15 offset:57344
  v_mul_f32 v13, v40, v121
  v_fma_f32 v10, -v41, v120, v10
  v_fma_f32 v12, -v41, v121, v12
  v_fma_f32 v11, v41, v104, v11
  v_fma_f32 v13, v41, v105, v13
  v_mul_f32 v104, v10, v232
  v_mul_f32 v105, v12, v233
  s_waitcnt lgkmcnt(4)
  v_mfma_f32_32x32x16_bf16 v[128:143], a[76:79], v[216:219], v[128:143]
  ds_read_b128 v[208:211], v16 offset:49152
  v_mul_f32 v120, v11, v232
  v_mul_f32 v121, v13, v233
  v_mul_f32 v10, v40, v106
  v_mul_f32 v12, v40, v107
  v_mul_f32 v11, v40, v122
  v_mul_f32 v13, v40, v123
  v_fma_f32 v10, -v41, v122, v10
  v_mfma_f32_32x32x16_bf16 v[144:159], a[76:79], v[220:223], v[144:159]
  ds_read_b128 v[212:215], v16 offset:57344
  buffer_load_dwordx4 v3, s[52:55], s15 offen offset:1024 lds
  v_fma_f32 v12, -v41, v123, v12
  v_fma_f32 v11, v41, v106, v11
  v_fma_f32 v13, v41, v107, v13
  v_mul_f32 v106, v10, v234
  v_mul_f32 v107, v12, v235
  v_mul_f32 v122, v11, v234
  v_mul_f32 v123, v13, v235
  s_waitcnt lgkmcnt(4)
  v_mfma_f32_32x32x16_bf16 v[128:143], a[80:83], v[192:195], v[128:143]
  ds_read_b128 v[216:219], v17 offset:49152
  v_mul_f32 v10, v40, v108
  v_mul_f32 v12, v40, v109
  v_mul_f32 v11, v40, v124
  v_mul_f32 v13, v40, v125
  v_fma_f32 v10, -v41, v124, v10
  v_fma_f32 v12, -v41, v125, v12
  v_fma_f32 v11, v41, v108, v11
  v_mfma_f32_32x32x16_bf16 v[144:159], a[80:83], v[196:199], v[144:159]
  ds_read_b128 v[220:223], v17 offset:57344
  v_fma_f32 v13, v41, v109, v13
  v_mul_f32 v108, v10, v236
  v_mul_f32 v109, v12, v237
  v_mul_f32 v124, v11, v236
  v_mul_f32 v125, v13, v237
  v_mul_f32 v10, v40, v110
  v_mul_f32 v12, v40, v111
  s_waitcnt lgkmcnt(4)
  v_mfma_f32_32x32x16_bf16 v[128:143], a[84:87], v[200:203], v[128:143]
  v_mul_f32 v11, v40, v126
  v_mul_f32 v13, v40, v127
  v_fma_f32 v10, -v41, v126, v10
  v_fma_f32 v12, -v41, v127, v12
  v_fma_f32 v11, v41, v110, v11
  v_fma_f32 v13, v41, v111, v13
  v_mul_f32 v110, v10, v238
  s_waitcnt vmcnt(6)
  s_barrier
  ds_read_b128 v[192:195], v18 offset:0
  v_mul_f32 v111, v12, v239
  v_mul_f32 v126, v11, v238
  v_mul_f32 v127, v13, v239
  v_mov_b32 v26, v64
  v_mov_b32 v27, v80
  v_mov_b32 v30, v96
  v_mov_b32 v31, v112
  v_mfma_f32_32x32x16_bf16 v[144:159], a[84:87], v[204:207], v[144:159]
  ds_read_b128 v[196:199], v18 offset:8192
  v_fma_f32 v28, v34, v26, v65
  v_fma_f32 v32, v38, v30, v97
  v_fma_f32 v29, v34, v27, v81
  v_fma_f32 v33, v38, v31, v113
  v_fma_f32 v28, -v35, v27, v28
  v_fma_f32 v32, -v39, v31, v32
  v_fma_f32 v29, v35, v26, v29
  s_waitcnt lgkmcnt(4)
  v_mfma_f32_32x32x16_bf16 v[128:143], a[88:91], v[208:211], v[128:143]
  ds_read_b128 v[200:203], v19 offset:0
  v_fma_f32 v33, v39, v30, v33
  v_fma_f32 v26, v34, v28, v66
  v_fma_f32 v30, v38, v32, v98
  v_fma_f32 v27, v34, v29, v82
  v_fma_f32 v31, v38, v33, v114
  v_fma_f32 v26, -v35, v29, v26
  v_fma_f32 v30, -v39, v33, v30
  v_mfma_f32_32x32x16_bf16 v[144:159], a[88:91], v[212:215], v[144:159]
  ds_read_b128 v[204:207], v19 offset:8192
  v_fma_f32 v27, v35, v28, v27
  v_fma_f32 v31, v39, v32, v31
  v_fma_f32 v28, v34, v26, v67
  v_fma_f32 v32, v38, v30, v99
  v_fma_f32 v29, v34, v27, v83
  v_fma_f32 v33, v38, v31, v115
  v_fma_f32 v28, -v35, v27, v28
  s_waitcnt lgkmcnt(4)
  v_mfma_f32_32x32x16_bf16 v[128:143], a[92:95], v[216:219], v[128:143]
  ds_read_b128 v[208:211], v20 offset:0
  v_fma_f32 v32, -v39, v31, v32
  v_fma_f32 v29, v35, v26, v29
  v_fma_f32 v33, v39, v30, v33
  v_fma_f32 v26, v34, v28, v68
  v_fma_f32 v30, v38, v32, v100
  v_fma_f32 v27, v34, v29, v84
  v_fma_f32 v31, v38, v33, v116
  v_mfma_f32_32x32x16_bf16 v[144:159], a[92:95], v[220:223], v[144:159]
  ds_read_b128 v[212:215], v20 offset:8192
  v_fma_f32 v26, -v35, v29, v26
  v_fma_f32 v30, -v39, v33, v30
  v_fma_f32 v27, v35, v28, v27
  v_fma_f32 v31, v39, v32, v31
  v_fma_f32 v28, v34, v26, v69
  v_fma_f32 v32, v38, v30, v101
  v_fma_f32 v29, v34, v27, v85
  s_waitcnt lgkmcnt(4)
  v_mfma_f32_32x32x16_bf16 v[128:143], a[96:99], v[192:195], v[128:143]
  ds_read_b128 v[216:219], v21 offset:0
  v_fma_f32 v33, v38, v31, v117
  v_fma_f32 v28, -v35, v27, v28
  v_fma_f32 v32, -v39, v31, v32
  v_fma_f32 v29, v35, v26, v29
  v_fma_f32 v33, v39, v30, v33
  v_fma_f32 v26, v34, v28, v70
  v_fma_f32 v30, v38, v32, v102
  v_mfma_f32_32x32x16_bf16 v[144:159], a[96:99], v[196:199], v[144:159]
  ds_read_b128 v[220:223], v21 offset:8192
  v_fma_f32 v27, v34, v29, v86
  v_fma_f32 v31, v38, v33, v118
  v_fma_f32 v26, -v35, v29, v26
  v_fma_f32 v30, -v39, v33, v30
  v_fma_f32 v27, v35, v28, v27
  v_fma_f32 v31, v39, v32, v31
  v_fma_f32 v28, v34, v26, v71
  s_waitcnt lgkmcnt(4)
  v_mfma_f32_32x32x16_bf16 v[128:143], a[100:103], v[200:203], v[128:143]
  v_fma_f32 v32, v38, v30, v103
  v_fma_f32 v29, v34, v27, v87
  v_fma_f32 v33, v38, v31, v119
  v_fma_f32 v28, -v35, v27, v28
  v_fma_f32 v32, -v39, v31, v32
  v_fma_f32 v29, v35, v26, v29
  v_fma_f32 v33, v39, v30, v33
  s_waitcnt vmcnt(4)
  s_barrier
  ds_read_b128 v[192:195], v18 offset:16384
  v_fma_f32 v26, v34, v28, v72
  v_fma_f32 v30, v38, v32, v104
  v_fma_f32 v27, v34, v29, v88
  v_fma_f32 v31, v38, v33, v120
  v_fma_f32 v26, -v35, v29, v26
  v_fma_f32 v30, -v39, v33, v30
  v_fma_f32 v27, v35, v28, v27
  v_fma_f32 v31, v39, v32, v31
  v_mfma_f32_32x32x16_bf16 v[144:159], a[100:103], v[204:207], v[144:159]
  ds_read_b128 v[196:199], v18 offset:24576
  v_fma_f32 v28, v34, v26, v73
  v_fma_f32 v32, v38, v30, v105
  v_fma_f32 v29, v34, v27, v89
  v_fma_f32 v33, v38, v31, v121
  v_fma_f32 v28, -v35, v27, v28
  v_fma_f32 v32, -v39, v31, v32
  v_fma_f32 v29, v35, v26, v29
  s_waitcnt lgkmcnt(4)
  v_mfma_f32_32x32x16_bf16 v[128:143], a[104:107], v[208:211], v[128:143]
  ds_read_b128 v[200:203], v19 offset:16384
  v_fma_f32 v33, v39, v30, v33
  v_fma_f32 v26, v34, v28, v74
  v_fma_f32 v30, v38, v32, v106
  v_fma_f32 v27, v34, v29, v90
  v_fma_f32 v31, v38, v33, v122
  v_fma_f32 v26, -v35, v29, v26
  v_fma_f32 v30, -v39, v33, v30
  v_mfma_f32_32x32x16_bf16 v[144:159], a[104:107], v[212:215], v[144:159]
  ds_read_b128 v[204:207], v19 offset:24576
  v_fma_f32 v27, v35, v28, v27
  v_fma_f32 v31, v39, v32, v31
  v_fma_f32 v28, v34, v26, v75
  v_fma_f32 v32, v38, v30, v107
  v_fma_f32 v29, v34, v27, v91
  v_fma_f32 v33, v38, v31, v123
  v_fma_f32 v28, -v35, v27, v28
  s_waitcnt lgkmcnt(4)
  v_mfma_f32_32x32x16_bf16 v[128:143], a[108:111], v[216:219], v[128:143]
  ds_read_b128 v[208:211], v20 offset:16384
  v_fma_f32 v32, -v39, v31, v32
  v_fma_f32 v29, v35, v26, v29
  v_fma_f32 v33, v39, v30, v33
  v_fma_f32 v26, v34, v28, v76
  v_fma_f32 v30, v38, v32, v108
  v_fma_f32 v27, v34, v29, v92
  v_fma_f32 v31, v38, v33, v124
  v_mfma_f32_32x32x16_bf16 v[144:159], a[108:111], v[220:223], v[144:159]
  ds_read_b128 v[212:215], v20 offset:24576
  v_fma_f32 v26, -v35, v29, v26
  v_fma_f32 v30, -v39, v33, v30
  v_fma_f32 v27, v35, v28, v27
  v_fma_f32 v31, v39, v32, v31
  v_fma_f32 v28, v34, v26, v77
  v_fma_f32 v32, v38, v30, v109
  v_fma_f32 v29, v34, v27, v93
  s_waitcnt lgkmcnt(4)
  v_mfma_f32_32x32x16_bf16 v[128:143], a[112:115], v[192:195], v[128:143]
  ds_read_b128 v[216:219], v21 offset:16384
  v_fma_f32 v33, v38, v31, v125
  v_fma_f32 v28, -v35, v27, v28
  v_fma_f32 v32, -v39, v31, v32
  v_fma_f32 v29, v35, v26, v29
  v_fma_f32 v33, v39, v30, v33
  v_fma_f32 v26, v34, v28, v78
  v_fma_f32 v30, v38, v32, v110
  v_mfma_f32_32x32x16_bf16 v[144:159], a[112:115], v[196:199], v[144:159]
  ds_read_b128 v[220:223], v21 offset:24576
  v_fma_f32 v27, v34, v29, v94
  v_fma_f32 v31, v38, v33, v126
  v_fma_f32 v26, -v35, v29, v26
  v_fma_f32 v30, -v39, v33, v30
  v_fma_f32 v27, v35, v28, v27
  v_fma_f32 v31, v39, v32, v31
  v_fma_f32 v28, v34, v26, v79
  s_waitcnt lgkmcnt(4)
  v_mfma_f32_32x32x16_bf16 v[128:143], a[116:119], v[200:203], v[128:143]
  v_fma_f32 v32, v38, v30, v111
  v_fma_f32 v29, v34, v27, v95
  v_fma_f32 v33, v38, v31, v127
  v_fma_f32 v28, -v35, v27, v28
  v_fma_f32 v32, -v39, v31, v32
  v_fma_f32 v29, v35, v26, v29
  v_fma_f32 v33, v39, v30, v33
  s_waitcnt vmcnt(2)
  s_barrier
  ds_read_b128 v[192:195], v14 offset:0
  v_and_b32 v60, 31, v1
  v_mfma_f32_32x32x16_bf16 v[144:159], a[116:119], v[204:207], v[144:159]
  ds_read_b128 v[196:199], v14 offset:8192
  v_lshrrev_b32 v61, 5, v1
  s_waitcnt lgkmcnt(4)
  v_mfma_f32_32x32x16_bf16 v[128:143], a[120:123], v[208:211], v[128:143]
  ds_read_b128 v[200:203], v15 offset:0
  s_lshl_b32 s8, s3, 1
  v_add_u32 v61, s8, v61
  v_mfma_f32_32x32x16_bf16 v[144:159], a[120:123], v[212:215], v[144:159]
  ds_read_b128 v[204:207], v15 offset:8192
  v_lshlrev_b32 v61, 10, v61
  s_waitcnt lgkmcnt(4)
  v_mfma_f32_32x32x16_bf16 v[128:143], a[124:127], v[216:219], v[128:143]
  ds_read_b128 v[208:211], v16 offset:0
  v_lshl_add_u32 v60, v60, 3, v61
  v_mfma_f32_32x32x16_bf16 v[144:159], a[124:127], v[220:223], v[144:159]
  ds_read_b128 v[212:215], v16 offset:8192
  v_add_u32 v60, 98304, v60
  s_waitcnt lgkmcnt(4)
  v_mfma_f32_32x32x16_bf16 v[128:143], a[128:131], v[192:195], v[128:143]
  ds_read_b128 v[216:219], v17 offset:0
  ds_write_b64 v60, v[28:29] offset:0
  v_mfma_f32_32x32x16_bf16 v[144:159], a[128:131], v[196:199], v[144:159]
  ds_read_b128 v[220:223], v17 offset:8192
  ds_write_b64 v60, v[32:33] offset:256
  s_waitcnt lgkmcnt(6)
  v_mfma_f32_32x32x16_bf16 v[128:143], a[132:135], v[200:203], v[128:143]
  s_waitcnt vmcnt(0)
  s_waitcnt lgkmcnt(0)
  s_barrier
  ds_read_b128 v[192:195], v14 offset:16384
  v_lshlrev_b32 v61, 4, v1
  v_add_u32 v61, 114688, v61
  ds_read_b128 v[6:9], v61
  v_lshlrev_b32 v60, 3, v1
  v_mfma_f32_32x32x16_bf16 v[144:159], a[132:135], v[204:207], v[144:159]
  ds_read_b128 v[196:199], v14 offset:24576
  v_add_u32 v60, 98304, v60
  ds_read_b64 v[240:241], v60 offset:0
  ds_read_b64 v[242:243], v60 offset:1024
  v_mfma_f32_32x32x16_bf16 v[128:143], a[136:139], v[208:211], v[128:143]
  ds_read_b128 v[200:203], v15 offset:16384
  ds_read_b64 v[244:245], v60 offset:2048
  ds_read_b64 v[246:247], v60 offset:3072
  ds_read_b64 v[248:249], v60 offset:4096
  ds_read_b64 v[250:251], v60 offset:5120
  v_mfma_f32_32x32x16_bf16 v[144:159], a[136:139], v[212:215], v[144:159]
  ds_read_b128 v[204:207], v15 offset:24576
  ds_read_b64 v[252:253], v60 offset:6144
  ds_read_b64 v[254:255], v60 offset:7168
  s_waitcnt lgkmcnt(0)
  v_mfma_f32_32x32x16_bf16 v[128:143], a[140:143], v[216:219], v[128:143]
  ds_read_b128 v[208:211], v16 offset:16384
  v_fma_f32 v12, v6, v240, v242
  v_fma_f32 v13, v6, v241, v243
  v_fma_f32 v12, -v7, v241, v12
  v_fma_f32 v13, v7, v240, v13
  v_mfma_f32_32x32x16_bf16 v[144:159], a[140:143], v[220:223], v[144:159]
  ds_read_b128 v[212:215], v16 offset:24576
  v_fma_f32 v10, v6, v12, v244
  v_fma_f32 v11, v6, v13, v245
  v_fma_f32 v10, -v7, v13, v10
  v_mfma_f32_32x32x16_bf16 v[128:143], a[144:147], v[192:195], v[128:143]
  ds_read_b128 v[216:219], v17 offset:16384
  v_fma_f32 v11, v7, v12, v11
  v_fma_f32 v12, v6, v10, v246
  v_fma_f32 v13, v6, v11, v247
  v_mfma_f32_32x32x16_bf16 v[144:159], a[144:147], v[196:199], v[144:159]
  ds_read_b128 v[220:223], v17 offset:24576
  v_fma_f32 v12, -v7, v11, v12
  v_fma_f32 v13, v7, v10, v13
  v_fma_f32 v10, v6, v12, v248
  v_fma_f32 v11, v6, v13, v249
  v_mfma_f32_32x32x16_bf16 v[128:143], a[148:151], v[200:203], v[128:143]
  v_fma_f32 v10, -v7, v13, v10
  v_fma_f32 v11, v7, v12, v11
  v_fma_f32 v12, v6, v10, v250
  v_mfma_f32_32x32x16_bf16 v[144:159], a[148:151], v[204:207], v[144:159]
  v_fma_f32 v13, v6, v11, v251
  v_fma_f32 v12, -v7, v11, v12
  v_fma_f32 v13, v7, v10, v13
  v_fma_f32 v10, v6, v12, v252
  s_waitcnt lgkmcnt(2)
  v_mfma_f32_32x32x16_bf16 v[128:143], a[152:155], v[208:211], v[128:143]
  v_fma_f32 v11, v6, v13, v253
  v_fma_f32 v10, -v7, v13, v10
  v_fma_f32 v11, v7, v12, v11
  v_mfma_f32_32x32x16_bf16 v[144:159], a[152:155], v[212:215], v[144:159]
  v_fma_f32 v12, v6, v10, v254
  v_fma_f32 v13, v6, v11, v255
  v_fma_f32 v12, -v7, v11, v12
  v_fma_f32 v13, v7, v10, v13
  s_waitcnt lgkmcnt(0)
  v_mfma_f32_32x32x16_bf16 v[128:143], a[156:159], v[216:219], v[128:143]
  v_mov_b32 v26, v12
  v_mov_b32 v27, s6
  v_mov_b32 v28, v13
  v_mfma_f32_32x32x16_bf16 v[144:159], a[156:159], v[220:223], v[144:159]
  v_mov_b32 v29, s6
  v_lshlrev_b32 v60, 4, v1
  s_mul_i32 s8, s4, 14336
  s_lshl_b32 s9, s5, 11
  s_add_u32 s8, s8, s9
  s_add_u32 s8, s8, 0x1010000
  s_cmp_eq_u32 s3, 0
  s_cselect_b32 s8, s8, 0x40000000
  buffer_store_dwordx4 v[26:29], v60, s[56:59], s8 offen sc1
  v_mov_b32 v241, 0
  v_mov_b32 v242, 0
  v_mov_b32 v243, 0
  v_mov_b32 v245, 0
  v_mov_b32 v246, 0
  v_mov_b32 v247, 0
  v_mov_b32 v249, 0
  v_mov_b32 v250, 0
  v_mov_b32 v251, 0
  v_mov_b32 v253, 0
  v_mov_b32 v254, 0
  v_mov_b32 v255, 0
  v_mov_b32 v240, v22
  v_mov_b32 v244, v23
  s_nop 0
  v_mfma_f32_32x32x16_bf16 v[128:143], a[160:163], v[240:243], v[128:143]
  v_mfma_f32_32x32x16_bf16 v[144:159], a[160:163], v[244:247], v[144:159]
  s_lshl_b32 s9, s5, 11
  s_add_u32 s9, s9, 0x1010000
  s_lshl_b32 s10, s3, 2
  s_add_u32 s11, s10, 1
  s_sub_u32 s12, s4, s11
  s_mul_i32 s12, s12, 14336
  s_add_u32 s12, s12, s9
  s_cmp_ge_u32 s4, s11
  s_cselect_b32 s86, s12, 0x40000000
  s_add_u32 s11, s10, 2
  s_sub_u32 s12, s4, s11
  s_mul_i32 s12, s12, 14336
  s_add_u32 s12, s12, s9
  s_cmp_ge_u32 s4, s11
  s_cselect_b32 s87, s12, 0x40000000
  s_add_u32 s11, s10, 3
  s_sub_u32 s12, s4, s11
  s_mul_i32 s12, s12, 14336
  s_add_u32 s12, s12, s9
  s_cmp_ge_u32 s4, s11
  s_cselect_b32 s88, s12, 0x40000000
  s_add_u32 s11, s10, 4
  s_sub_u32 s12, s4, s11
  s_mul_i32 s12, s12, 14336
  s_add_u32 s12, s12, s9
  s_cmp_ge_u32 s4, s11
  s_cselect_b32 s89, s12, 0x40000000
  v_lshlrev_b32 v16, 4, v1
  buffer_load_dwordx4 v[240:243], v16, s[56:59], s86 offen offset:0 sc1
  buffer_load_dwordx4 v[244:247], v16, s[56:59], s87 offen offset:0 sc1
  buffer_load_dwordx4 v[248:251], v16, s[56:59], s88 offen offset:0 sc1
  buffer_load_dwordx4 v[252:255], v16, s[56:59], s89 offen offset:0 sc1
  v_mul_f32 v10, v44, v128
  v_mul_f32 v12, v44, v129
  v_mul_f32 v11, v44, v144
  v_mul_f32 v13, v44, v145
  v_fma_f32 v10, -v45, v144, v10
  v_fma_f32 v12, -v45, v145, v12
  v_fma_f32 v11, v45, v128, v11
  v_fma_f32 v13, v45, v129, v13
  v_mul_f32 v128, v10, v224
  v_mul_f32 v129, v12, v225
  v_mul_f32 v144, v11, v224
  v_mul_f32 v145, v13, v225
  v_mul_f32 v10, v44, v130
  v_mul_f32 v12, v44, v131
  v_mul_f32 v11, v44, v146
  v_mul_f32 v13, v44, v147
  v_fma_f32 v10, -v45, v146, v10
  v_fma_f32 v12, -v45, v147, v12
  v_fma_f32 v11, v45, v130, v11
  v_fma_f32 v13, v45, v131, v13
  v_mul_f32 v130, v10, v226
  v_mul_f32 v131, v12, v227
  v_mul_f32 v146, v11, v226
  v_mul_f32 v147, v13, v227
  v_mul_f32 v10, v44, v132
  v_mul_f32 v12, v44, v133
  v_mul_f32 v11, v44, v148
  v_mul_f32 v13, v44, v149
  v_fma_f32 v10, -v45, v148, v10
  v_fma_f32 v12, -v45, v149, v12
  v_fma_f32 v11, v45, v132, v11
  v_fma_f32 v13, v45, v133, v13
  v_mul_f32 v132, v10, v228
  v_mul_f32 v133, v12, v229
  v_mul_f32 v148, v11, v228
  v_mul_f32 v149, v13, v229
  v_mul_f32 v10, v44, v134
  v_mul_f32 v12, v44, v135
  v_mul_f32 v11, v44, v150
  v_mul_f32 v13, v44, v151
  v_fma_f32 v10, -v45, v150, v10
  v_fma_f32 v12, -v45, v151, v12
  v_fma_f32 v11, v45, v134, v11
  v_fma_f32 v13, v45, v135, v13
  v_mul_f32 v134, v10, v230
  v_mul_f32 v135, v12, v231
  v_mul_f32 v150, v11, v230
  v_mul_f32 v151, v13, v231
  v_mul_f32 v10, v44, v136
  v_mul_f32 v12, v44, v137
  v_mul_f32 v11, v44, v152
  v_mul_f32 v13, v44, v153
  v_fma_f32 v10, -v45, v152, v10
  v_fma_f32 v12, -v45, v153, v12
  v_fma_f32 v11, v45, v136, v11
  v_fma_f32 v13, v45, v137, v13
  v_mul_f32 v136, v10, v232
  v_mul_f32 v137, v12, v233
  v_mul_f32 v152, v11, v232
  v_mul_f32 v153, v13, v233
  v_mul_f32 v10, v44, v138
  v_mul_f32 v12, v44, v139
  v_mul_f32 v11, v44, v154
  v_mul_f32 v13, v44, v155
  v_fma_f32 v10, -v45, v154, v10
  v_fma_f32 v12, -v45, v155, v12
  v_fma_f32 v11, v45, v138, v11
  v_fma_f32 v13, v45, v139, v13
  v_mul_f32 v138, v10, v234
  v_mul_f32 v139, v12, v235
  v_mul_f32 v154, v11, v234
  v_mul_f32 v155, v13, v235
  v_mul_f32 v10, v44, v140
  v_mul_f32 v12, v44, v141
  v_mul_f32 v11, v44, v156
  v_mul_f32 v13, v44, v157
  v_fma_f32 v10, -v45, v156, v10
  v_fma_f32 v12, -v45, v157, v12
  v_fma_f32 v11, v45, v140, v11
  v_fma_f32 v13, v45, v141, v13
  v_mul_f32 v140, v10, v236
  v_mul_f32 v141, v12, v237
  v_mul_f32 v156, v11, v236
  v_mul_f32 v157, v13, v237
  v_mul_f32 v10, v44, v142
  v_mul_f32 v12, v44, v143
  v_mul_f32 v11, v44, v158
  v_mul_f32 v13, v44, v159
  v_fma_f32 v10, -v45, v158, v10
  v_fma_f32 v12, -v45, v159, v12
  v_fma_f32 v11, v45, v142, v11
  v_fma_f32 v13, v45, v143, v13
  v_mul_f32 v142, v10, v238
  v_mul_f32 v143, v12, v239
  v_mul_f32 v158, v11, v238
  v_mul_f32 v159, v13, v239
  v_mov_b32 v192, v128
  v_mov_b32 v193, v144
  v_fma_f32 v194, v42, v192, v129
  v_fma_f32 v195, v42, v193, v145
  v_fma_f32 v194, -v43, v193, v194
  v_fma_f32 v195, v43, v192, v195
  v_fma_f32 v192, v42, v194, v130
  v_fma_f32 v193, v42, v195, v146
  v_fma_f32 v192, -v43, v195, v192
  v_fma_f32 v193, v43, v194, v193
  v_fma_f32 v194, v42, v192, v131
  v_fma_f32 v195, v42, v193, v147
  v_fma_f32 v194, -v43, v193, v194
  v_fma_f32 v195, v43, v192, v195
  v_fma_f32 v192, v42, v194, v132
  v_fma_f32 v193, v42, v195, v148
  v_fma_f32 v192, -v43, v195, v192
  v_fma_f32 v193, v43, v194, v193
  v_fma_f32 v194, v42, v192, v133
  v_fma_f32 v195, v42, v193, v149
  v_fma_f32 v194, -v43, v193, v194
  v_fma_f32 v195, v43, v192, v195
  v_fma_f32 v192, v42, v194, v134
  v_fma_f32 v193, v42, v195, v150
  v_fma_f32 v192, -v43, v195, v192
  v_fma_f32 v193, v43, v194, v193
  v_fma_f32 v194, v42, v192, v135
  v_fma_f32 v195, v42, v193, v151
  v_fma_f32 v194, -v43, v193, v194
  v_fma_f32 v195, v43, v192, v195
  v_fma_f32 v192, v42, v194, v136
  v_fma_f32 v193, v42, v195, v152
  v_fma_f32 v192, -v43, v195, v192
  v_fma_f32 v193, v43, v194, v193
  v_fma_f32 v194, v42, v192, v137
  v_fma_f32 v195, v42, v193, v153
  v_fma_f32 v194, -v43, v193, v194
  v_fma_f32 v195, v43, v192, v195
  v_fma_f32 v192, v42, v194, v138
  v_fma_f32 v193, v42, v195, v154
  v_fma_f32 v192, -v43, v195, v192
  v_fma_f32 v193, v43, v194, v193
  v_fma_f32 v194, v42, v192, v139
  v_fma_f32 v195, v42, v193, v155
  v_fma_f32 v194, -v43, v193, v194
  v_fma_f32 v195, v43, v192, v195
  v_fma_f32 v192, v42, v194, v140
  v_fma_f32 v193, v42, v195, v156
  v_fma_f32 v192, -v43, v195, v192
  v_fma_f32 v193, v43, v194, v193
  v_fma_f32 v194, v42, v192, v141
  v_fma_f32 v195, v42, v193, v157
  v_fma_f32 v194, -v43, v193, v194
  v_fma_f32 v195, v43, v192, v195
  v_fma_f32 v192, v42, v194, v142
  v_fma_f32 v193, v42, v195, v158
  v_fma_f32 v192, -v43, v195, v192
  v_fma_f32 v193, v43, v194, v193
  v_fma_f32 v194, v42, v192, v143
  v_fma_f32 v195, v42, v193, v159
  v_fma_f32 v194, -v43, v193, v194
  v_fma_f32 v195, v43, v192, v195
  v_and_b32 v60, 31, v1
  v_lshrrev_b32 v61, 5, v1
  s_lshl_b32 s8, s3, 1
  v_add_u32 v61, s8, v61
  v_lshlrev_b32 v61, 10, v61
  v_lshl_add_u32 v60, v60, 3, v61
  v_add_u32 v60, 98304, v60
  ds_write_b64 v60, v[194:195] offset:512
  v_bfe_u32 v60, v1, 4, 1
  v_mul_u32_u24 v14, 2176, v60
  v_lshrrev_b32 v60, 5, v1
  v_mul_u32_u24 v60, 1088, v60
  v_add_u32 v14, v14, v60
  v_bfe_u32 v60, v1, 2, 2
  v_mul_u32_u24 v60, 272, v60
  v_add_u32 v14, v14, v60
  v_and_b32 v60, 3, v1
  v_lshl_add_u32 v14, v60, 2, v14
  s_mul_i32 s8, s3, 17408
  v_add_u32 v14, s8, v14
  v_lshrrev_b32 v60, 4, v1
  v_mul_u32_u24 v15, 272, v60
  v_and_b32 v60, 15, v1
  v_lshl_add_u32 v15, v60, 4, v15
  v_add_u32 v15, s8, v15
  v_lshlrev_b32 v17, 4, v1
  s_lshl_b32 s8, s4, 2
  s_add_u32 s8, s8, s3
  s_lshl_b32 s8, s8, 11
  v_add_u32 v17, s8, v17
  s_mul_i32 s9, s5, 6
  s_mul_i32 s9, s9, 131072
  s_add_u32 s90, s9, 0x400000
  s_waitcnt lgkmcnt(0)
  s_barrier
  v_lshlrev_b32 v61, 4, v1
  v_add_u32 v61, 115712, v61
  ds_read_b128 v[22:25], v61
  v_lshlrev_b32 v60, 3, v1
  v_add_u32 v60, 98816, v60
  ds_read_b64 v[224:225], v60 offset:0
  ds_read_b64 v[226:227], v60 offset:1024
  ds_read_b64 v[228:229], v60 offset:2048
  ds_read_b64 v[230:231], v60 offset:3072
  ds_read_b64 v[232:233], v60 offset:4096
  ds_read_b64 v[234:235], v60 offset:5120
  ds_read_b64 v[236:237], v60 offset:6144
  ds_read_b64 v[238:239], v60 offset:7168
  s_waitcnt lgkmcnt(0)
  v_fma_f32 v12, v22, v224, v226
  v_fma_f32 v13, v22, v225, v227
  v_fma_f32 v12, -v23, v225, v12
  v_fma_f32 v13, v23, v224, v13
  v_fma_f32 v10, v22, v12, v228
  v_fma_f32 v11, v22, v13, v229
  v_fma_f32 v10, -v23, v13, v10
  v_fma_f32 v11, v23, v12, v11
  v_fma_f32 v12, v22, v10, v230
  v_fma_f32 v13, v22, v11, v231
  v_fma_f32 v12, -v23, v11, v12
  v_fma_f32 v13, v23, v10, v13
  v_fma_f32 v10, v22, v12, v232
  v_fma_f32 v11, v22, v13, v233
  v_fma_f32 v10, -v23, v13, v10
  v_fma_f32 v11, v23, v12, v11
  v_fma_f32 v12, v22, v10, v234
  v_fma_f32 v13, v22, v11, v235
  v_fma_f32 v12, -v23, v11, v12
  v_fma_f32 v13, v23, v10, v13
  v_fma_f32 v10, v22, v12, v236
  v_fma_f32 v11, v22, v13, v237
  v_fma_f32 v10, -v23, v13, v10
  v_fma_f32 v11, v23, v12, v11
  v_fma_f32 v12, v22, v10, v238
  v_fma_f32 v13, v22, v11, v239
  v_fma_f32 v12, -v23, v11, v12
  v_fma_f32 v13, v23, v10, v13
  v_mov_b32 v26, v12
  v_mov_b32 v27, s6
  v_mov_b32 v28, v13
  v_mov_b32 v29, s6
  v_lshlrev_b32 v60, 4, v1
  s_mul_i32 s8, s4, 14336
  s_lshl_b32 s9, s5, 11
  s_add_u32 s8, s8, s9
  s_add_u32 s8, s8, 0x1010400
  s_cmp_eq_u32 s3, 0
  s_cselect_b32 s8, s8, 0x40000000
  buffer_store_dwordx4 v[26:29], v60, s[56:59], s8 offen sc1
  buffer_load_dwordx4 v[224:227], v16, s[56:59], s86 offen offset:1024 sc1
  buffer_load_dwordx4 v[228:231], v16, s[56:59], s87 offen offset:1024 sc1
  buffer_load_dwordx4 v[232:235], v16, s[56:59], s88 offen offset:1024 sc1
  buffer_load_dwordx4 v[236:239], v16, s[56:59], s89 offen offset:1024 sc1
  s_waitcnt vmcnt(4)
  s_cmp_ge_u32 s86, 0x40000000
  s_cselect_b32 s8, 0, s6
  v_xor_b32 v60, s8, v241
  v_xor_b32 v61, s8, v243
  v_or_b32 v62, v60, v61
  s_cmp_ge_u32 s87, 0x40000000
  s_cselect_b32 s8, 0, s6
  v_xor_b32 v60, s8, v245
  v_xor_b32 v61, s8, v247
  v_or3_b32 v62, v60, v61, v62
  s_cmp_ge_u32 s88, 0x40000000
  s_cselect_b32 s8, 0, s6
  v_xor_b32 v60, s8, v249
  v_xor_b32 v61, s8, v251
  v_or3_b32 v62, v60, v61, v62
  s_cmp_ge_u32 s89, 0x40000000
  s_cselect_b32 s8, 0, s6
  v_xor_b32 v60, s8, v253
  v_xor_b32 v61, s8, v255
  v_or3_b32 v62, v60, v61, v62
  v_cmp_ne_u32 vcc, 0, v62
  s_nop 1
  s_cmp_eq_u64 vcc, 0
  s_cbranch_scc0 L_slow_23
L_back_24:
  v_mov_b32 v241, v242
  v_mov_b32 v245, v246
  v_mov_b32 v249, v250
  v_mov_b32 v253, v254
  v_fma_f32 v10, v8, v252, v248
  v_fma_f32 v11, v8, v253, v249
  v_fma_f32 v10, -v9, v253, v10
  v_fma_f32 v11, v9, v252, v11
  v_fma_f32 v12, v8, v10, v244
  v_fma_f32 v13, v8, v11, v245
  v_fma_f32 v12, -v9, v11, v12
  v_fma_f32 v13, v9, v10, v13
  v_fma_f32 v10, v8, v12, v240
  v_fma_f32 v11, v8, v13, v241
  v_fma_f32 v10, -v9, v13, v10
  v_fma_f32 v11, v9, v12, v11
  v_lshlrev_b32 v60, 3, v1
  s_lshl_b32 s8, s3, 9
  s_add_u32 s8, s8, 106496
  v_add_u32 v61, s8, v60
  ds_write_b64 v61, v[10:11]
  v_mul_f32 v20, v9, v9
  v_mul_f32 v21, v8, v9
  v_fma_f32 v62, v8, v8, -v20
  v_add_f32 v63, v21, v21
  v_mul_f32 v20, v63, v63
  v_mul_f32 v21, v62, v63
  v_fma_f32 v62, v62, v62, -v20
  v_add_f32 v63, v21, v21
  v_add_u32 v60, 106496, v60
  s_waitcnt lgkmcnt(0)
  s_barrier
  ds_read_b64 v[240:241], v60 offset:0
  ds_read_b64 v[242:243], v60 offset:512
  ds_read_b64 v[244:245], v60 offset:1024
  ds_read_b64 v[246:247], v60 offset:1536
  s_waitcnt lgkmcnt(0)
  v_fma_f32 v10, v62, v246, v244
  v_fma_f32 v11, v62, v247, v245
  v_fma_f32 v10, -v63, v247, v10
  v_fma_f32 v11, v63, v246, v11
  v_fma_f32 v12, v62, v10, v242
  v_fma_f32 v13, v62, v11, v243
  v_fma_f32 v12, -v63, v11, v12
  v_fma_f32 v13, v63, v10, v13
  v_fma_f32 v10, v62, v12, v240
  v_fma_f32 v11, v62, v13, v241
  v_fma_f32 v10, -v63, v13, v10
  v_fma_f32 v11, v63, v12, v11
  v_mov_b32 v20, v10
  v_mov_b32 v21, v11
  v_lshlrev_b32 v60, 3, v1
  v_add_u32 v60, 98304, v60
  ds_read_b64 v[240:241], v60 offset:0
  ds_read_b64 v[242:243], v60 offset:1024
  ds_read_b64 v[244:245], v60 offset:2048
  ds_read_b64 v[246:247], v60 offset:3072
  ds_read_b64 v[248:249], v60 offset:4096
  ds_read_b64 v[250:251], v60 offset:5120
  ds_read_b64 v[252:253], v60 offset:6144
  ds_read_b64 v[254:255], v60 offset:7168
  s_lshl_b32 s8, s3, 11
  v_add_u32 v61, s8, v60
  ds_read_b64 v[18:19], v61
  s_waitcnt lgkmcnt(0)
  s_cmp_eq_u32 s3, 0
  s_cbranch_scc1 L_chain_26
  v_fma_f32 v10, v6, v20, v240
  v_fma_f32 v11, v6, v21, v241
  v_fma_f32 v10, -v7, v21, v10
  v_fma_f32 v11, v7, v20, v11
  v_fma_f32 v20, v6, v10, v242
  v_fma_f32 v21, v6, v11, v243
  v_fma_f32 v20, -v7, v11, v20
  v_fma_f32 v21, v7, v10, v21
  s_cmp_eq_u32 s3, 1
  s_cbranch_scc1 L_chain_26
  v_fma_f32 v10, v6, v20, v244
  v_fma_f32 v11, v6, v21, v245
  v_fma_f32 v10, -v7, v21, v10
  v_fma_f32 v11, v7, v20, v11
  v_fma_f32 v20, v6, v10, v246
  v_fma_f32 v21, v6, v11, v247
  v_fma_f32 v20, -v7, v11, v20
  v_fma_f32 v21, v7, v10, v21
  s_cmp_eq_u32 s3, 2
  s_cbranch_scc1 L_chain_26
  v_fma_f32 v10, v6, v20, v248
  v_fma_f32 v11, v6, v21, v249
  v_fma_f32 v10, -v7, v21, v10
  v_fma_f32 v11, v7, v20, v11
  v_fma_f32 v20, v6, v10, v250
  v_fma_f32 v21, v6, v11, v251
  v_fma_f32 v20, -v7, v11, v20
  v_fma_f32 v21, v7, v10, v21
L_chain_26:
  s_nop 1
  v_fma_f32 v10, v6, v20, v18
  v_fma_f32 v11, v6, v21, v19
  v_fma_f32 v10, -v7, v21, v10
  v_fma_f32 v11, v7, v20, v11
  s_nop 1
  v_permlane32_swap_b32 v20, v10
  v_permlane32_swap_b32 v21, v11
  s_nop 1
  v_mov_b32 v194, v20
  v_mov_b32 v195, v21
  v_mov_b32 v198, v10
  v_mov_b32 v199, v11
  v_fma_f32 v192, v34, v194, v64
  v_fma_f32 v196, v38, v198, v96
  v_fma_f32 v193, v34, v195, v80
  v_fma_f32 v197, v38, v199, v112
  v_fma_f32 v192, -v35, v195, v192
  v_fma_f32 v196, -v39, v199, v196
  v_fma_f32 v193, v35, v194, v193
  v_fma_f32 v197, v39, v198, v197
  v_cvt_pk_bf16_f32 v208, v192, v193
  v_cvt_pk_bf16_f32 v209, v196, v197
  ds_write_b32 v14, v208 offset:0
  ds_write_b32 v14, v209 offset:4352
  v_fma_f32 v194, v34, v192, v65
  v_fma_f32 v198, v38, v196, v97
  v_fma_f32 v195, v34, v193, v81
  v_fma_f32 v199, v38, v197, v113
  v_fma_f32 v194, -v35, v193, v194
  v_fma_f32 v198, -v39, v197, v198
  v_fma_f32 v195, v35, v192, v195
  v_fma_f32 v199, v39, v196, v199
  v_cvt_pk_bf16_f32 v210, v194, v195
  v_cvt_pk_bf16_f32 v211, v198, v199
  ds_write_b32 v14, v210 offset:16
  ds_write_b32 v14, v211 offset:4368
  v_fma_f32 v192, v34, v194, v66
  v_fma_f32 v196, v38, v198, v98
  v_fma_f32 v193, v34, v195, v82
  v_fma_f32 v197, v38, v199, v114
  v_fma_f32 v192, -v35, v195, v192
  v_fma_f32 v196, -v39, v199, v196
  v_fma_f32 v193, v35, v194, v193
  v_fma_f32 v197, v39, v198, v197
  v_cvt_pk_bf16_f32 v208, v192, v193
  v_cvt_pk_bf16_f32 v209, v196, v197
  ds_write_b32 v14, v208 offset:32
  ds_write_b32 v14, v209 offset:4384
  v_fma_f32 v194, v34, v192, v67
  v_fma_f32 v198, v38, v196, v99
  v_fma_f32 v195, v34, v193, v83
  v_fma_f32 v199, v38, v197, v115
  v_fma_f32 v194, -v35, v193, v194
  v_fma_f32 v198, -v39, v197, v198
  v_fma_f32 v195, v35, v192, v195
  v_fma_f32 v199, v39, v196, v199
  v_cvt_pk_bf16_f32 v210, v194, v195
  v_cvt_pk_bf16_f32 v211, v198, v199
  ds_write_b32 v14, v210 offset:48
  ds_write_b32 v14, v211 offset:4400
  v_fma_f32 v192, v34, v194, v68
  v_fma_f32 v196, v38, v198, v100
  v_fma_f32 v193, v34, v195, v84
  v_fma_f32 v197, v38, v199, v116
  v_fma_f32 v192, -v35, v195, v192
  v_fma_f32 v196, -v39, v199, v196
  v_fma_f32 v193, v35, v194, v193
  v_fma_f32 v197, v39, v198, v197
  v_cvt_pk_bf16_f32 v208, v192, v193
  v_cvt_pk_bf16_f32 v209, v196, v197
  ds_write_b32 v14, v208 offset:64
  ds_write_b32 v14, v209 offset:4416
  v_fma_f32 v194, v34, v192, v69
  v_fma_f32 v198, v38, v196, v101
  v_fma_f32 v195, v34, v193, v85
  v_fma_f32 v199, v38, v197, v117
  v_fma_f32 v194, -v35, v193, v194
  v_fma_f32 v198, -v39, v197, v198
  v_fma_f32 v195, v35, v192, v195
  v_fma_f32 v199, v39, v196, v199
  v_cvt_pk_bf16_f32 v210, v194, v195
  v_cvt_pk_bf16_f32 v211, v198, v199
  ds_write_b32 v14, v210 offset:80
  ds_write_b32 v14, v211 offset:4432
  v_fma_f32 v192, v34, v194, v70
  v_fma_f32 v196, v38, v198, v102
  v_fma_f32 v193, v34, v195, v86
  v_fma_f32 v197, v38, v199, v118
  v_fma_f32 v192, -v35, v195, v192
  v_fma_f32 v196, -v39, v199, v196
  v_fma_f32 v193, v35, v194, v193
  v_fma_f32 v197, v39, v198, v197
  v_cvt_pk_bf16_f32 v208, v192, v193
  v_cvt_pk_bf16_f32 v209, v196, v197
  ds_write_b32 v14, v208 offset:96
  ds_write_b32 v14, v209 offset:4448
  v_fma_f32 v194, v34, v192, v71
  v_fma_f32 v198, v38, v196, v103
  v_fma_f32 v195, v34, v193, v87
  v_fma_f32 v199, v38, v197, v119
  v_fma_f32 v194, -v35, v193, v194
  v_fma_f32 v198, -v39, v197, v198
  v_fma_f32 v195, v35, v192, v195
  v_fma_f32 v199, v39, v196, v199
  v_cvt_pk_bf16_f32 v210, v194, v195
  v_cvt_pk_bf16_f32 v211, v198, v199
  ds_write_b32 v14, v210 offset:112
  ds_write_b32 v14, v211 offset:4464
  v_fma_f32 v192, v34, v194, v72
  v_fma_f32 v196, v38, v198, v104
  v_fma_f32 v193, v34, v195, v88
  v_fma_f32 v197, v38, v199, v120
  v_fma_f32 v192, -v35, v195, v192
  v_fma_f32 v196, -v39, v199, v196
  v_fma_f32 v193, v35, v194, v193
  v_fma_f32 v197, v39, v198, v197
  v_cvt_pk_bf16_f32 v208, v192, v193
  v_cvt_pk_bf16_f32 v209, v196, v197
  ds_write_b32 v14, v208 offset:128
  ds_write_b32 v14, v209 offset:4480
  v_fma_f32 v194, v34, v192, v73
  v_fma_f32 v198, v38, v196, v105
  v_fma_f32 v195, v34, v193, v89
  v_fma_f32 v199, v38, v197, v121
  v_fma_f32 v194, -v35, v193, v194
  v_fma_f32 v198, -v39, v197, v198
  v_fma_f32 v195, v35, v192, v195
  v_fma_f32 v199, v39, v196, v199
  v_cvt_pk_bf16_f32 v210, v194, v195
  v_cvt_pk_bf16_f32 v211, v198, v199
  ds_write_b32 v14, v210 offset:144
  ds_write_b32 v14, v211 offset:4496
  v_fma_f32 v192, v34, v194, v74
  v_fma_f32 v196, v38, v198, v106
  v_fma_f32 v193, v34, v195, v90
  v_fma_f32 v197, v38, v199, v122
  v_fma_f32 v192, -v35, v195, v192
  v_fma_f32 v196, -v39, v199, v196
  v_fma_f32 v193, v35, v194, v193
  v_fma_f32 v197, v39, v198, v197
  v_cvt_pk_bf16_f32 v208, v192, v193
  v_cvt_pk_bf16_f32 v209, v196, v197
  ds_write_b32 v14, v208 offset:160
  ds_write_b32 v14, v209 offset:4512
  v_fma_f32 v194, v34, v192, v75
  v_fma_f32 v198, v38, v196, v107
  v_fma_f32 v195, v34, v193, v91
  v_fma_f32 v199, v38, v197, v123
  v_fma_f32 v194, -v35, v193, v194
  v_fma_f32 v198, -v39, v197, v198
  v_fma_f32 v195, v35, v192, v195
  v_fma_f32 v199, v39, v196, v199
  v_cvt_pk_bf16_f32 v210, v194, v195
  v_cvt_pk_bf16_f32 v211, v198, v199
  ds_write_b32 v14, v210 offset:176
  ds_write_b32 v14, v211 offset:4528
  v_fma_f32 v192, v34, v194, v76
  v_fma_f32 v196, v38, v198, v108
  v_fma_f32 v193, v34, v195, v92
  v_fma_f32 v197, v38, v199, v124
  v_fma_f32 v192, -v35, v195, v192
  v_fma_f32 v196, -v39, v199, v196
  v_fma_f32 v193, v35, v194, v193
  v_fma_f32 v197, v39, v198, v197
  v_cvt_pk_bf16_f32 v208, v192, v193
  v_cvt_pk_bf16_f32 v209, v196, v197
  ds_write_b32 v14, v208 offset:192
  ds_write_b32 v14, v209 offset:4544
  v_fma_f32 v194, v34, v192, v77
  v_fma_f32 v198, v38, v196, v109
  v_fma_f32 v195, v34, v193, v93
  v_fma_f32 v199, v38, v197, v125
  v_fma_f32 v194, -v35, v193, v194
  v_fma_f32 v198, -v39, v197, v198
  v_fma_f32 v195, v35, v192, v195
  v_fma_f32 v199, v39, v196, v199
  v_cvt_pk_bf16_f32 v210, v194, v195
  v_cvt_pk_bf16_f32 v211, v198, v199
  ds_write_b32 v14, v210 offset:208
  ds_write_b32 v14, v211 offset:4560
  v_fma_f32 v192, v34, v194, v78
  v_fma_f32 v196, v38, v198, v110
  v_fma_f32 v193, v34, v195, v94
  v_fma_f32 v197, v38, v199, v126
  v_fma_f32 v192, -v35, v195, v192
  v_fma_f32 v196, -v39, v199, v196
  v_fma_f32 v193, v35, v194, v193
  v_fma_f32 v197, v39, v198, v197
  v_cvt_pk_bf16_f32 v208, v192, v193
  v_cvt_pk_bf16_f32 v209, v196, v197
  ds_write_b32 v14, v208 offset:224
  ds_write_b32 v14, v209 offset:4576
  v_fma_f32 v194, v34, v192, v79
  v_fma_f32 v198, v38, v196, v111
  v_fma_f32 v195, v34, v193, v95
  v_fma_f32 v199, v38, v197, v127
  v_fma_f32 v194, -v35, v193, v194
  v_fma_f32 v198, -v39, v197, v198
  v_fma_f32 v195, v35, v192, v195
  v_fma_f32 v199, v39, v196, v199
  v_cvt_pk_bf16_f32 v210, v194, v195
  v_cvt_pk_bf16_f32 v211, v198, v199
  ds_write_b32 v14, v210 offset:240
  ds_write_b32 v14, v211 offset:4592
  s_waitcnt lgkmcnt(0)
  ds_read_b128 v[64:67], v15 offset:0
  ds_read_b128 v[68:71], v15 offset:1088
  ds_read_b128 v[72:75], v15 offset:2176
  ds_read_b128 v[76:79], v15 offset:3264
  ds_read_b128 v[80:83], v15 offset:4352
  ds_read_b128 v[84:87], v15 offset:5440
  ds_read_b128 v[88:91], v15 offset:6528
  ds_read_b128 v[92:95], v15 offset:7616
  s_waitcnt lgkmcnt(7)
  s_add_u32 s10, s90, 0
  buffer_store_dwordx4 v[64:67], v17, s[56:59], s10 offen offset:0 sc1
  s_waitcnt lgkmcnt(6)
  buffer_store_dwordx4 v[68:71], v17, s[56:59], s10 offen offset:1024 sc1
  s_waitcnt lgkmcnt(5)
  s_add_u32 s10, s90, 131072
  buffer_store_dwordx4 v[72:75], v17, s[56:59], s10 offen offset:0 sc1
  s_waitcnt lgkmcnt(4)
  buffer_store_dwordx4 v[76:79], v17, s[56:59], s10 offen offset:1024 sc1
  s_waitcnt lgkmcnt(3)
  s_add_u32 s10, s90, 262144
  buffer_store_dwordx4 v[80:83], v17, s[56:59], s10 offen offset:0 sc1
  s_waitcnt lgkmcnt(2)
  buffer_store_dwordx4 v[84:87], v17, s[56:59], s10 offen offset:1024 sc1
  s_waitcnt lgkmcnt(1)
  s_add_u32 s10, s90, 393216
  buffer_store_dwordx4 v[88:91], v17, s[56:59], s10 offen offset:0 sc1
  s_waitcnt lgkmcnt(0)
  buffer_store_dwordx4 v[92:95], v17, s[56:59], s10 offen offset:1024 sc1
  s_waitcnt vmcnt(0)
  s_cmp_ge_u32 s86, 0x40000000
  s_cselect_b32 s8, 0, s6
  v_xor_b32 v60, s8, v225
  v_xor_b32 v61, s8, v227
  v_or_b32 v62, v60, v61
  s_cmp_ge_u32 s87, 0x40000000
  s_cselect_b32 s8, 0, s6
  v_xor_b32 v60, s8, v229
  v_xor_b32 v61, s8, v231
  v_or3_b32 v62, v60, v61, v62
  s_cmp_ge_u32 s88, 0x40000000
  s_cselect_b32 s8, 0, s6
  v_xor_b32 v60, s8, v233
  v_xor_b32 v61, s8, v235
  v_or3_b32 v62, v60, v61, v62
  s_cmp_ge_u32 s89, 0x40000000
  s_cselect_b32 s8, 0, s6
  v_xor_b32 v60, s8, v237
  v_xor_b32 v61, s8, v239
  v_or3_b32 v62, v60, v61, v62
  v_cmp_ne_u32 vcc, 0, v62
  s_nop 1
  s_cmp_eq_u64 vcc, 0
  s_cbranch_scc0 L_slow_27
L_back_28:
  v_mov_b32 v225, v226
  v_mov_b32 v229, v230
  v_mov_b32 v233, v234
  v_mov_b32 v237, v238
  v_fma_f32 v10, v24, v236, v232
  v_fma_f32 v11, v24, v237, v233
  v_fma_f32 v10, -v25, v237, v10
  v_fma_f32 v11, v25, v236, v11
  v_fma_f32 v12, v24, v10, v228
  v_fma_f32 v13, v24, v11, v229
  v_fma_f32 v12, -v25, v11, v12
  v_fma_f32 v13, v25, v10, v13
  v_fma_f32 v10, v24, v12, v224
  v_fma_f32 v11, v24, v13, v225
  v_fma_f32 v10, -v25, v13, v10
  v_fma_f32 v11, v25, v12, v11
  v_lshlrev_b32 v60, 3, v1
  s_lshl_b32 s8, s3, 9
  s_add_u32 s8, s8, 108544
  v_add_u32 v61, s8, v60
  ds_write_b64 v61, v[10:11]
  v_mul_f32 v20, v25, v25
  v_mul_f32 v21, v24, v25
  v_fma_f32 v62, v24, v24, -v20
  v_add_f32 v63, v21, v21
  v_mul_f32 v20, v63, v63
  v_mul_f32 v21, v62, v63
  v_fma_f32 v62, v62, v62, -v20
  v_add_f32 v63, v21, v21
  v_add_u32 v60, 108544, v60
  s_waitcnt lgkmcnt(0)
  s_barrier
  ds_read_b64 v[224:225], v60 offset:0
  ds_read_b64 v[226:227], v60 offset:512
  ds_read_b64 v[228:229], v60 offset:1024
  ds_read_b64 v[230:231], v60 offset:1536
  s_waitcnt lgkmcnt(0)
  v_fma_f32 v10, v62, v230, v228
  v_fma_f32 v11, v62, v231, v229
  v_fma_f32 v10, -v63, v231, v10
  v_fma_f32 v11, v63, v230, v11
  v_fma_f32 v12, v62, v10, v226
  v_fma_f32 v13, v62, v11, v227
  v_fma_f32 v12, -v63, v11, v12
  v_fma_f32 v13, v63, v10, v13
  v_fma_f32 v10, v62, v12, v224
  v_fma_f32 v11, v62, v13, v225
  v_fma_f32 v10, -v63, v13, v10
  v_fma_f32 v11, v63, v12, v11
  v_mov_b32 v20, v10
  v_mov_b32 v21, v11
  v_lshlrev_b32 v60, 3, v1
  v_add_u32 v60, 98816, v60
  ds_read_b64 v[224:225], v60 offset:0
  ds_read_b64 v[226:227], v60 offset:1024
  ds_read_b64 v[228:229], v60 offset:2048
  ds_read_b64 v[230:231], v60 offset:3072
  ds_read_b64 v[232:233], v60 offset:4096
  ds_read_b64 v[234:235], v60 offset:5120
  ds_read_b64 v[236:237], v60 offset:6144
  ds_read_b64 v[238:239], v60 offset:7168
  s_lshl_b32 s8, s3, 11
  v_add_u32 v61, s8, v60
  ds_read_b64 v[18:19], v61
  s_waitcnt lgkmcnt(0)
  s_cmp_eq_u32 s3, 0
  s_cbranch_scc1 L_chain_30
  v_fma_f32 v10, v22, v20, v224
  v_fma_f32 v11, v22, v21, v225
  v_fma_f32 v10, -v23, v21, v10
  v_fma_f32 v11, v23, v20, v11
  v_fma_f32 v20, v22, v10, v226
  v_fma_f32 v21, v22, v11, v227
  v_fma_f32 v20, -v23, v11, v20
  v_fma_f32 v21, v23, v10, v21
  s_cmp_eq_u32 s3, 1
  s_cbranch_scc1 L_chain_30
  v_fma_f32 v10, v22, v20, v228
  v_fma_f32 v11, v22, v21, v229
  v_fma_f32 v10, -v23, v21, v10
  v_fma_f32 v11, v23, v20, v11
  v_fma_f32 v20, v22, v10, v230
  v_fma_f32 v21, v22, v11, v231
  v_fma_f32 v20, -v23, v11, v20
  v_fma_f32 v21, v23, v10, v21
  s_cmp_eq_u32 s3, 2
  s_cbranch_scc1 L_chain_30
  v_fma_f32 v10, v22, v20, v232
  v_fma_f32 v11, v22, v21, v233
  v_fma_f32 v10, -v23, v21, v10
  v_fma_f32 v11, v23, v20, v11
  v_fma_f32 v20, v22, v10, v234
  v_fma_f32 v21, v22, v11, v235
  v_fma_f32 v20, -v23, v11, v20
  v_fma_f32 v21, v23, v10, v21
L_chain_30:
  s_nop 1
  v_fma_f32 v10, v22, v20, v18
  v_fma_f32 v11, v22, v21, v19
  v_fma_f32 v10, -v23, v21, v10
  v_fma_f32 v11, v23, v20, v11
  s_nop 1
  v_permlane32_swap_b32 v20, v10
  v_permlane32_swap_b32 v21, v11
  s_nop 1
  v_mov_b32 v202, v20
  v_mov_b32 v203, v21
  v_fma_f32 v200, v42, v202, v128
  v_fma_f32 v201, v42, v203, v144
  v_fma_f32 v200, -v43, v203, v200
  v_fma_f32 v201, v43, v202, v201
  v_cvt_pk_bf16_f32 v208, v200, v201
  ds_write_b32 v14, v208 offset:8704
  v_fma_f32 v202, v42, v200, v129
  v_fma_f32 v203, v42, v201, v145
  v_fma_f32 v202, -v43, v201, v202
  v_fma_f32 v203, v43, v200, v203
  v_cvt_pk_bf16_f32 v210, v202, v203
  ds_write_b32 v14, v210 offset:8720
  v_fma_f32 v200, v42, v202, v130
  v_fma_f32 v201, v42, v203, v146
  v_fma_f32 v200, -v43, v203, v200
  v_fma_f32 v201, v43, v202, v201
  v_cvt_pk_bf16_f32 v208, v200, v201
  ds_write_b32 v14, v208 offset:8736
  v_fma_f32 v202, v42, v200, v131
  v_fma_f32 v203, v42, v201, v147
  v_fma_f32 v202, -v43, v201, v202
  v_fma_f32 v203, v43, v200, v203
  v_cvt_pk_bf16_f32 v210, v202, v203
  ds_write_b32 v14, v210 offset:8752
  v_fma_f32 v200, v42, v202, v132
  v_fma_f32 v201, v42, v203, v148
  v_fma_f32 v200, -v43, v203, v200
  v_fma_f32 v201, v43, v202, v201
  v_cvt_pk_bf16_f32 v208, v200, v201
  ds_write_b32 v14, v208 offset:8768
  v_fma_f32 v202, v42, v200, v133
  v_fma_f32 v203, v42, v201, v149
  v_fma_f32 v202, -v43, v201, v202
  v_fma_f32 v203, v43, v200, v203
  v_cvt_pk_bf16_f32 v210, v202, v203
  ds_write_b32 v14, v210 offset:8784
  v_fma_f32 v200, v42, v202, v134
  v_fma_f32 v201, v42, v203, v150
  v_fma_f32 v200, -v43, v203, v200
  v_fma_f32 v201, v43, v202, v201
  v_cvt_pk_bf16_f32 v208, v200, v201
  ds_write_b32 v14, v208 offset:8800
  v_fma_f32 v202, v42, v200, v135
  v_fma_f32 v203, v42, v201, v151
  v_fma_f32 v202, -v43, v201, v202
  v_fma_f32 v203, v43, v200, v203
  v_cvt_pk_bf16_f32 v210, v202, v203
  ds_write_b32 v14, v210 offset:8816
  v_fma_f32 v200, v42, v202, v136
  v_fma_f32 v201, v42, v203, v152
  v_fma_f32 v200, -v43, v203, v200
  v_fma_f32 v201, v43, v202, v201
  v_cvt_pk_bf16_f32 v208, v200, v201
  ds_write_b32 v14, v208 offset:8832
  v_fma_f32 v202, v42, v200, v137
  v_fma_f32 v203, v42, v201, v153
  v_fma_f32 v202, -v43, v201, v202
  v_fma_f32 v203, v43, v200, v203
  v_cvt_pk_bf16_f32 v210, v202, v203
  ds_write_b32 v14, v210 offset:8848
  v_fma_f32 v200, v42, v202, v138
  v_fma_f32 v201, v42, v203, v154
  v_fma_f32 v200, -v43, v203, v200
  v_fma_f32 v201, v43, v202, v201
  v_cvt_pk_bf16_f32 v208, v200, v201
  ds_write_b32 v14, v208 offset:8864
  v_fma_f32 v202, v42, v200, v139
  v_fma_f32 v203, v42, v201, v155
  v_fma_f32 v202, -v43, v201, v202
  v_fma_f32 v203, v43, v200, v203
  v_cvt_pk_bf16_f32 v210, v202, v203
  ds_write_b32 v14, v210 offset:8880
  v_fma_f32 v200, v42, v202, v140
  v_fma_f32 v201, v42, v203, v156
  v_fma_f32 v200, -v43, v203, v200
  v_fma_f32 v201, v43, v202, v201
  v_cvt_pk_bf16_f32 v208, v200, v201
  ds_write_b32 v14, v208 offset:8896
  v_fma_f32 v202, v42, v200, v141
  v_fma_f32 v203, v42, v201, v157
  v_fma_f32 v202, -v43, v201, v202
  v_fma_f32 v203, v43, v200, v203
  v_cvt_pk_bf16_f32 v210, v202, v203
  ds_write_b32 v14, v210 offset:8912
  v_fma_f32 v200, v42, v202, v142
  v_fma_f32 v201, v42, v203, v158
  v_fma_f32 v200, -v43, v203, v200
  v_fma_f32 v201, v43, v202, v201
  v_cvt_pk_bf16_f32 v208, v200, v201
  ds_write_b32 v14, v208 offset:8928
  v_fma_f32 v202, v42, v200, v143
  v_fma_f32 v203, v42, v201, v159
  v_fma_f32 v202, -v43, v201, v202
  v_fma_f32 v203, v43, v200, v203
  v_cvt_pk_bf16_f32 v210, v202, v203
  ds_write_b32 v14, v210 offset:8944
  s_waitcnt lgkmcnt(0)
  ds_read_b128 v[128:131], v15 offset:8704
  ds_read_b128 v[132:135], v15 offset:9792
  ds_read_b128 v[136:139], v15 offset:10880
  ds_read_b128 v[140:143], v15 offset:11968
  s_waitcnt lgkmcnt(3)
  s_add_u32 s10, s90, 524288
  s_cmp_eq_u32 s5, 6
  s_cselect_b32 s10, 0x40000000, s10
  buffer_store_dwordx4 v[128:131], v17, s[56:59], s10 offen offset:0 sc1
  s_waitcnt lgkmcnt(2)
  buffer_store_dwordx4 v[132:135], v17, s[56:59], s10 offen offset:1024 sc1
  s_waitcnt lgkmcnt(1)
  s_add_u32 s10, s90, 655360
  s_cmp_eq_u32 s5, 6
  s_cselect_b32 s10, 0x40000000, s10
  buffer_store_dwordx4 v[136:139], v17, s[56:59], s10 offen offset:0 sc1
  s_waitcnt lgkmcnt(0)
  buffer_store_dwordx4 v[140:143], v17, s[56:59], s10 offen offset:1024 sc1
  s_waitcnt vmcnt(0)
  s_barrier
  s_lshl_b32 s8, s4, 4
  s_add_u32 s8, s8, s5
  s_lshl_b32 s8, s8, 2
  s_add_u32 s8, s8, 0x10b0c00
  v_mov_b32 v58, s6
  buffer_store_dword v58, v59, s[56:59], s8 offen sc1
  s_mov_b32 s93, 0x10b0000
  buffer_load_dwordx4 v[240:243], v54, s[56:59], s93 offen sc1
  s_waitcnt vmcnt(0)
  s_mov_b64 s[12:13], 0
  v_cmp_ne_u32 vcc, s6, v240
  s_nop 0
  s_or_b64 s[12:13], s[12:13], vcc
  v_cmp_ne_u32 vcc, s6, v241
  s_nop 0
  s_or_b64 s[12:13], s[12:13], vcc
  v_cmp_ne_u32 vcc, s6, v242
  s_nop 0
  s_or_b64 s[12:13], s[12:13], vcc
  v_cmp_ne_u32 vcc, s6, v243
  s_nop 0
  s_or_b64 s[12:13], s[12:13], vcc
  s_cmp_eq_u64 s[12:13], 0
  s_cbranch_scc0 L_slow_31
L_back_32:
  s_add_u32 s7, s80, 0
  buffer_load_dwordx4 a[0:3], v54, s[76:79], s7 offen offset:0 sc1
  buffer_load_dwordx4 a[4:7], v54, s[76:79], s7 offen offset:1024 sc1
  buffer_load_dwordx4 a[8:11], v54, s[76:79], s7 offen offset:2048 sc1
  buffer_load_dwordx4 a[12:15], v54, s[76:79], s7 offen offset:3072 sc1
  buffer_load_dwordx4 a[16:19], v56, s[76:79], s7 offen sc1
  s_add_u32 s7, s80, 40960
  buffer_load_dwordx4 a[20:23], v54, s[76:79], s7 offen offset:0 sc1
  buffer_load_dwordx4 a[24:27], v54, s[76:79], s7 offen offset:1024 sc1
  buffer_load_dwordx4 a[28:31], v54, s[76:79], s7 offen offset:2048 sc1
  buffer_load_dwordx4 a[32:35], v54, s[76:79], s7 offen offset:3072 sc1
  buffer_load_dwordx4 a[36:39], v56, s[76:79], s7 offen sc1
  s_add_u32 s7, s80, 81920
  buffer_load_dwordx4 a[40:43], v54, s[76:79], s7 offen offset:0 sc1
  buffer_load_dwordx4 a[44:47], v54, s[76:79], s7 offen offset:1024 sc1
  buffer_load_dwordx4 a[48:51], v54, s[76:79], s7 offen offset:2048 sc1
  buffer_load_dwordx4 a[52:55], v54, s[76:79], s7 offen offset:3072 sc1
  buffer_load_dwordx4 a[56:59], v56, s[76:79], s7 offen sc1
  s_add_u32 s7, s80, 122880
  buffer_load_dwordx4 a[60:63], v54, s[76:79], s7 offen offset:0 sc1
  buffer_load_dwordx4 a[64:67], v54, s[76:79], s7 offen offset:1024 sc1
  buffer_load_dwordx4 a[68:71], v54, s[76:79], s7 offen offset:2048 sc1
  buffer_load_dwordx4 a[72:75], v54, s[76:79], s7 offen offset:3072 sc1
  buffer_load_dwordx4 a[76:79], v56, s[76:79], s7 offen sc1
  s_add_u32 s7, s80, 163840
  buffer_load_dwordx4 a[80:83], v54, s[76:79], s7 offen offset:0 sc1
  buffer_load_dwordx4 a[84:87], v54, s[76:79], s7 offen offset:1024 sc1
  buffer_load_dwordx4 a[88:91], v54, s[76:79], s7 offen offset:2048 sc1
  buffer_load_dwordx4 a[92:95], v54, s[76:79], s7 offen offset:3072 sc1
  buffer_load_dwordx4 a[96:99], v56, s[76:79], s7 offen sc1
  s_add_u32 s7, s80, 204800
  buffer_load_dwordx4 a[100:103], v54, s[76:79], s7 offen offset:0 sc1
  buffer_load_dwordx4 a[104:107], v54, s[76:79], s7 offen offset:1024 sc1
  buffer_load_dwordx4 a[108:111], v54, s[76:79], s7 offen offset:2048 sc1
  buffer_load_dwordx4 a[112:115], v54, s[76:79], s7 offen offset:3072 sc1
  buffer_load_dwordx4 a[116:119], v56, s[76:79], s7 offen sc1
  s_add_u32 s7, s80, 245760
  buffer_load_dwordx4 a[120:123], v54, s[76:79], s7 offen offset:0 sc1
  buffer_load_dwordx4 a[124:127], v54, s[76:79], s7 offen offset:1024 sc1
  buffer_load_dwordx4 a[128:131], v54, s[76:79], s7 offen offset:2048 sc1
  buffer_load_dwordx4 a[132:135], v54, s[76:79], s7 offen offset:3072 sc1
  buffer_load_dwordx4 a[136:139], v56, s[76:79], s7 offen sc1
  s_branch L_P2
L_P2:
  v_and_b32 v4, 15, v1
  v_lshlrev_b32 v4, 2, v4
  s_lshr_b32 s10, s81, 13
  s_lshl_b32 s10, s10, 6
  s_add_u32 s10, s10, 0x10b0c00
  v_and_b32 v60, 15, v1
  v_lshrrev_b32 v61, 4, v1
  v_mul_u32_u24 v5, 1280, v60
  v_lshl_add_u32 v5, v61, 3, v5
  v_lshlrev_b32 v6, 3, v61
  v_lshlrev_b32 v7, 3, v60
  v_mul_u32_u24 v8, 2560, v60
  v_lshl_add_u32 v8, v61, 4, v8
  s_lshr_b32 s86, s81, 10
  s_add_u32 s86, s86, s3
  s_lshl_b32 s86, s86, 4
  s_lshr_b32 s87, s80, 5
  s_mov_b32 s60, s16
  s_mov_b32 s61, s17
  s_mov_b32 s62, 0x280000
  s_mov_b32 s63, 0x20000
  s_mov_b32 s64, s32
  s_mov_b32 s65, s33
  s_mov_b32 s66, 0x500
  s_mov_b32 s67, 0x20000
  s_mul_i32 s88, s86, 1280
  s_add_u32 s88, s88, s87
  s_mov_b32 s94, 0
  v_and_b32 v60, 15, v1
  v_cmp_gt_u32 vcc, 7, v60
  s_nop 1
  s_mov_b64 s[98:99], vcc
  s_mov_b32 s89, s10
  s_cmp_lt_u32 s3, 2
  s_cbranch_scc1 L_zm_37
  s_not_b64 s[98:99], s[98:99]
  s_add_u32 s10, s10, 1024
L_zm_37:
  buffer_load_dword v9, v4, s[56:59], s10 offen sc1
  s_branch L_p1c_36
L_p1_34:
  s_sleep 3
  buffer_load_dword v9, v4, s[56:59], s10 offen sc1
L_p1c_36:
  s_waitcnt vmcnt(0)
  v_cmp_ne_u32 vcc, s6, v9
  s_nop 1
  s_and_b64 vcc, vcc, s[98:99]
  s_cmp_eq_u64 vcc, 0
  s_cbranch_scc1 L_p1ok_35
  s_add_u32 s94, s94, 1
  s_cmp_lt_u32 s94, 0x40000
  s_cbranch_scc1 L_p1_34
L_p1ok_35:
  s_add_u32 s13, s81, 0
  buffer_load_dwordx4 a[140:143], v54, s[72:75], s13 offen offset:0 sc1
  buffer_load_dwordx4 a[144:147], v54, s[72:75], s13 offen offset:1024 sc1
  buffer_load_dwordx4 a[148:151], v54, s[72:75], s13 offen offset:2048 sc1
  buffer_load_dwordx4 a[152:155], v54, s[72:75], s13 offen offset:3072 sc1
  s_add_u32 s13, s81, 131072
  buffer_load_dwordx4 a[156:159], v54, s[72:75], s13 offen offset:0 sc1
  buffer_load_dwordx4 a[160:163], v54, s[72:75], s13 offen offset:1024 sc1
  buffer_load_dwordx4 a[164:167], v54, s[72:75], s13 offen offset:2048 sc1
  buffer_load_dwordx4 a[168:171], v54, s[72:75], s13 offen offset:3072 sc1
  s_add_u32 s13, s81, 262144
  buffer_load_dwordx4 a[172:175], v54, s[72:75], s13 offen offset:0 sc1
  buffer_load_dwordx4 a[176:179], v54, s[72:75], s13 offen offset:1024 sc1
  buffer_load_dwordx4 a[180:183], v54, s[72:75], s13 offen offset:2048 sc1
  buffer_load_dwordx4 a[184:187], v54, s[72:75], s13 offen offset:3072 sc1
  s_add_u32 s13, s81, 393216
  buffer_load_dwordx4 a[188:191], v54, s[72:75], s13 offen offset:0 sc1
  buffer_load_dwordx4 a[192:195], v54, s[72:75], s13 offen offset:1024 sc1
  buffer_load_dwordx4 a[196:199], v54, s[72:75], s13 offen offset:2048 sc1
  buffer_load_dwordx4 a[200:203], v54, s[72:75], s13 offen offset:3072 sc1
  s_add_u32 s13, s81, 524288
  buffer_load_dwordx4 a[204:207], v54, s[72:75], s13 offen offset:0 sc1
  buffer_load_dwordx4 a[208:211], v54, s[72:75], s13 offen offset:1024 sc1
  buffer_load_dwordx4 a[212:215], v54, s[72:75], s13 offen offset:2048 sc1
  buffer_load_dwordx4 a[216:219], v54, s[72:75], s13 offen offset:3072 sc1
  s_add_u32 s13, s81, 655360
  buffer_load_dwordx4 a[220:223], v54, s[72:75], s13 offen offset:0 sc1
  buffer_load_dwordx4 a[224:227], v54, s[72:75], s13 offen offset:1024 sc1
  buffer_load_dwordx4 a[228:231], v54, s[72:75], s13 offen offset:2048 sc1
  buffer_load_dwordx4 a[232:235], v54, s[72:75], s13 offen offset:3072 sc1
  s_mul_i32 s8, s3, 7
  s_add_u32 s8, s8, 43
  s_mul_i32 s9, s8, 131072
  s_add_u32 s90, s81, s9
  s_mul_i32 s9, s8, 40960
  s_add_u32 s91, s80, s9
  v_lshlrev_b32 v13, 4, v1
  s_cmp_lt_u32 s3, 2
  s_cbranch_scc0 L_P2_D
  s_waitcnt vmcnt(23)
  v_mfma_f32_16x16x32_bf16 v[64:67], a[0:3], a[140:143], 0
  s_waitcnt vmcnt(22)
  v_mfma_f32_16x16x32_bf16 v[68:71], a[0:3], a[144:147], 0
  s_waitcnt vmcnt(21)
  v_mfma_f32_16x16x32_bf16 v[72:75], a[0:3], a[148:151], 0
  s_waitcnt vmcnt(20)
  v_mfma_f32_16x16x32_bf16 v[76:79], a[0:3], a[152:155], 0
  s_add_u32 s13, s81, 786432
  buffer_load_dwordx4 a[236:239], v54, s[72:75], s13 offen offset:0 sc1
  v_mfma_f32_16x16x32_bf16 v[80:83], a[4:7], a[140:143], 0
  v_mfma_f32_16x16x32_bf16 v[84:87], a[4:7], a[144:147], 0
  s_add_u32 s7, s80, 286720
  buffer_load_dwordx4 a[0:3], v54, s[76:79], s7 offen offset:0 sc1
  v_mfma_f32_16x16x32_bf16 v[88:91], a[4:7], a[148:151], 0
  v_mfma_f32_16x16x32_bf16 v[92:95], a[4:7], a[152:155], 0
  buffer_load_dwordx4 a[240:243], v54, s[72:75], s13 offen offset:1024 sc1
  v_mfma_f32_16x16x32_bf16 v[96:99], a[8:11], a[140:143], 0
  v_mfma_f32_16x16x32_bf16 v[100:103], a[8:11], a[144:147], 0
  buffer_load_dwordx4 a[4:7], v54, s[76:79], s7 offen offset:1024 sc1
  v_mfma_f32_16x16x32_bf16 v[104:107], a[8:11], a[148:151], 0
  v_mfma_f32_16x16x32_bf16 v[108:111], a[8:11], a[152:155], 0
  buffer_load_dwordx4 a[244:247], v54, s[72:75], s13 offen offset:2048 sc1
  v_mfma_f32_16x16x32_bf16 v[112:115], a[12:15], a[140:143], 0
  v_mfma_f32_16x16x32_bf16 v[116:119], a[12:15], a[144:147], 0
  buffer_load_dwordx4 a[8:11], v54, s[76:79], s7 offen offset:2048 sc1
  v_mfma_f32_16x16x32_bf16 v[120:123], a[12:15], a[148:151], 0
  v_mfma_f32_16x16x32_bf16 v[124:127], a[12:15], a[152:155], 0
  buffer_load_dwordx4 a[248:251], v54, s[72:75], s13 offen offset:3072 sc1
  v_mfma_f32_16x16x32_bf16 v[128:131], a[16:19], a[140:143], 0
  v_mfma_f32_16x16x32_bf16 v[132:135], a[16:19], a[144:147], 0
  buffer_load_dwordx4 a[12:15], v54, s[76:79], s7 offen offset:3072 sc1
  v_mfma_f32_16x16x32_bf16 v[136:139], a[16:19], a[148:151], 0
  v_mfma_f32_16x16x32_bf16 v[140:143], a[16:19], a[152:155], 0
  s_waitcnt vmcnt(27)
  v_mfma_f32_16x16x32_bf16 v[64:67], a[20:23], a[156:159], v[64:67]
  s_waitcnt vmcnt(26)
  v_mfma_f32_16x16x32_bf16 v[68:71], a[20:23], a[160:163], v[68:71]
  buffer_load_dwordx4 a[16:19], v56, s[76:79], s7 offen sc1
  s_waitcnt vmcnt(26)
  v_mfma_f32_16x16x32_bf16 v[72:75], a[20:23], a[164:167], v[72:75]
  s_waitcnt vmcnt(25)
  v_mfma_f32_16x16x32_bf16 v[76:79], a[20:23], a[168:171], v[76:79]
  s_add_u32 s13, s81, 917504
  buffer_load_dwordx4 a[140:143], v54, s[72:75], s13 offen offset:0 sc1
  buffer_load_dwordx2 v[224:225], v5, s[60:63], s88 offen offset:0
  buffer_load_dwordx2 v[234:235], v6, s[64:67], s87 offen offset:0
  buffer_load_dwordx2 v[226:227], v5, s[60:63], s88 offen offset:32
  v_mfma_f32_16x16x32_bf16 v[80:83], a[24:27], a[156:159], v[80:83]
  v_mfma_f32_16x16x32_bf16 v[84:87], a[24:27], a[160:163], v[84:87]
  s_add_u32 s7, s80, 327680
  buffer_load_dwordx4 a[20:23], v54, s[76:79], s7 offen offset:0 sc1
  v_mfma_f32_16x16x32_bf16 v[88:91], a[24:27], a[164:167], v[88:91]
  v_mfma_f32_16x16x32_bf16 v[92:95], a[24:27], a[168:171], v[92:95]
  buffer_load_dwordx4 a[144:147], v54, s[72:75], s13 offen offset:1024 sc1
  buffer_load_dwordx2 v[236:237], v6, s[64:67], s87 offen offset:32
  buffer_load_dwordx2 v[228:229], v5, s[60:63], s88 offen offset:64
  v_mfma_f32_16x16x32_bf16 v[96:99], a[28:31], a[156:159], v[96:99]
  v_mfma_f32_16x16x32_bf16 v[100:103], a[28:31], a[160:163], v[100:103]
  buffer_load_dwordx4 a[24:27], v54, s[76:79], s7 offen offset:1024 sc1
  v_mfma_f32_16x16x32_bf16 v[104:107], a[28:31], a[164:167], v[104:107]
  v_mfma_f32_16x16x32_bf16 v[108:111], a[28:31], a[168:171], v[108:111]
  buffer_load_dwordx4 a[148:151], v54, s[72:75], s13 offen offset:2048 sc1
  buffer_load_dwordx2 v[238:239], v6, s[64:67], s87 offen offset:64
  buffer_load_dwordx2 v[230:231], v5, s[60:63], s88 offen offset:96
  v_mfma_f32_16x16x32_bf16 v[112:115], a[32:35], a[156:159], v[112:115]
  v_mfma_f32_16x16x32_bf16 v[116:119], a[32:35], a[160:163], v[116:119]
  buffer_load_dwordx4 a[28:31], v54, s[76:79], s7 offen offset:2048 sc1
  v_mfma_f32_16x16x32_bf16 v[120:123], a[32:35], a[164:167], v[120:123]
  v_mfma_f32_16x16x32_bf16 v[124:127], a[32:35], a[168:171], v[124:127]
  buffer_load_dwordx4 a[152:155], v54, s[72:75], s13 offen offset:3072 sc1
  buffer_load_dwordx2 v[240:241], v6, s[64:67], s87 offen offset:96
  buffer_load_dwordx2 v[232:233], v5, s[60:63], s88 offen offset:128
  v_mfma_f32_16x16x32_bf16 v[128:131], a[36:39], a[156:159], v[128:131]
  v_mfma_f32_16x16x32_bf16 v[132:135], a[36:39], a[160:163], v[132:135]
  buffer_load_dwordx4 a[32:35], v54, s[76:79], s7 offen offset:3072 sc1
  v_mfma_f32_16x16x32_bf16 v[136:139], a[36:39], a[164:167], v[136:139]
  v_mfma_f32_16x16x32_bf16 v[140:143], a[36:39], a[168:171], v[140:143]
  buffer_load_dwordx2 v[242:243], v6, s[64:67], s87 offen offset:128
  s_lshl_b32 s8, s86, 3
  s_add_u32 s8, s8, 0x1000000
  buffer_load_dword v246, v7, s[56:59], s8 offen sc1
  s_waitcnt vmcnt(43)
  v_mfma_f32_16x16x32_bf16 v[64:67], a[40:43], a[172:175], v[64:67]
  s_waitcnt vmcnt(42)
  v_mfma_f32_16x16x32_bf16 v[68:71], a[40:43], a[176:179], v[68:71]
  buffer_load_dwordx4 a[36:39], v56, s[76:79], s7 offen sc1
  s_waitcnt vmcnt(42)
  v_mfma_f32_16x16x32_bf16 v[72:75], a[40:43], a[180:183], v[72:75]
  s_waitcnt vmcnt(41)
  v_mfma_f32_16x16x32_bf16 v[76:79], a[40:43], a[184:187], v[76:79]
  s_add_u32 s13, s81, 1048576
  buffer_load_dwordx4 a[156:159], v54, s[72:75], s13 offen offset:0 sc1
  v_mfma_f32_16x16x32_bf16 v[80:83], a[44:47], a[172:175], v[80:83]
  v_mfma_f32_16x16x32_bf16 v[84:87], a[44:47], a[176:179], v[84:87]
  s_add_u32 s7, s80, 368640
  buffer_load_dwordx4 a[40:43], v54, s[76:79], s7 offen offset:0 sc1
  v_mfma_f32_16x16x32_bf16 v[88:91], a[44:47], a[180:183], v[88:91]
  v_mfma_f32_16x16x32_bf16 v[92:95], a[44:47], a[184:187], v[92:95]
  buffer_load_dwordx4 a[160:163], v54, s[72:75], s13 offen offset:1024 sc1
  v_mfma_f32_16x16x32_bf16 v[96:99], a[48:51], a[172:175], v[96:99]
  v_mfma_f32_16x16x32_bf16 v[100:103], a[48:51], a[176:179], v[100:103]
  buffer_load_dwordx4 a[44:47], v54, s[76:79], s7 offen offset:1024 sc1
  v_mfma_f32_16x16x32_bf16 v[104:107], a[48:51], a[180:183], v[104:107]
  v_mfma_f32_16x16x32_bf16 v[108:111], a[48:51], a[184:187], v[108:111]
  buffer_load_dwordx4 a[164:167], v54, s[72:75], s13 offen offset:2048 sc1
  v_mfma_f32_16x16x32_bf16 v[112:115], a[52:55], a[172:175], v[112:115]
  v_mfma_f32_16x16x32_bf16 v[116:119], a[52:55], a[176:179], v[116:119]
  buffer_load_dwordx4 a[48:51], v54, s[76:79], s7 offen offset:2048 sc1
  v_mfma_f32_16x16x32_bf16 v[120:123], a[52:55], a[180:183], v[120:123]
  v_mfma_f32_16x16x32_bf16 v[124:127], a[52:55], a[184:187], v[124:127]
  buffer_load_dwordx4 a[168:171], v54, s[72:75], s13 offen offset:3072 sc1
  v_mfma_f32_16x16x32_bf16 v[128:131], a[56:59], a[172:175], v[128:131]
  v_mfma_f32_16x16x32_bf16 v[132:135], a[56:59], a[176:179], v[132:135]
  buffer_load_dwordx4 a[52:55], v54, s[76:79], s7 offen offset:3072 sc1
  v_mfma_f32_16x16x32_bf16 v[136:139], a[56:59], a[180:183], v[136:139]
  v_mfma_f32_16x16x32_bf16 v[140:143], a[56:59], a[184:187], v[140:143]
  s_waitcnt vmcnt(48)
  v_mfma_f32_16x16x32_bf16 v[64:67], a[60:63], a[188:191], v[64:67]
  s_waitcnt vmcnt(47)
  v_mfma_f32_16x16x32_bf16 v[68:71], a[60:63], a[192:195], v[68:71]
  buffer_load_dwordx4 a[56:59], v56, s[76:79], s7 offen sc1
  s_waitcnt vmcnt(47)
  v_mfma_f32_16x16x32_bf16 v[72:75], a[60:63], a[196:199], v[72:75]
  s_waitcnt vmcnt(46)
  v_mfma_f32_16x16x32_bf16 v[76:79], a[60:63], a[200:203], v[76:79]
  s_add_u32 s13, s81, 1179648
  buffer_load_dwordx4 a[172:175], v54, s[72:75], s13 offen offset:0 sc1
  v_mfma_f32_16x16x32_bf16 v[80:83], a[64:67], a[188:191], v[80:83]
  v_mfma_f32_16x16x32_bf16 v[84:87], a[64:67], a[192:195], v[84:87]
  s_add_u32 s7, s80, 409600
  buffer_load_dwordx4 a[60:63], v54, s[76:79], s7 offen offset:0 sc1
  v_mfma_f32_16x16x32_bf16 v[88:91], a[64:67], a[196:199], v[88:91]
  v_mfma_f32_16x16x32_bf16 v[92:95], a[64:67], a[200:203], v[92:95]
  buffer_load_dwordx4 a[176:179], v54, s[72:75], s13 offen offset:1024 sc1
  v_mfma_f32_16x16x32_bf16 v[96:99], a[68:71], a[188:191], v[96:99]
  v_mfma_f32_16x16x32_bf16 v[100:103], a[68:71], a[192:195], v[100:103]
  buffer_load_dwordx4 a[64:67], v54, s[76:79], s7 offen offset:1024 sc1
  v_mfma_f32_16x16x32_bf16 v[104:107], a[68:71], a[196:199], v[104:107]
  v_mfma_f32_16x16x32_bf16 v[108:111], a[68:71], a[200:203], v[108:111]
  buffer_load_dwordx4 a[180:183], v54, s[72:75], s13 offen offset:2048 sc1
  v_mfma_f32_16x16x32_bf16 v[112:115], a[72:75], a[188:191], v[112:115]
  v_mfma_f32_16x16x32_bf16 v[116:119], a[72:75], a[192:195], v[116:119]
  buffer_load_dwordx4 a[68:71], v54, s[76:79], s7 offen offset:2048 sc1
  v_mfma_f32_16x16x32_bf16 v[120:123], a[72:75], a[196:199], v[120:123]
  v_mfma_f32_16x16x32_bf16 v[124:127], a[72:75], a[200:203], v[124:127]
  buffer_load_dwordx4 a[184:187], v54, s[72:75], s13 offen offset:3072 sc1
  v_mfma_f32_16x16x32_bf16 v[128:131], a[76:79], a[188:191], v[128:131]
  v_mfma_f32_16x16x32_bf16 v[132:135], a[76:79], a[192:195], v[132:135]
  buffer_load_dwordx4 a[72:75], v54, s[76:79], s7 offen offset:3072 sc1
  v_mfma_f32_16x16x32_bf16 v[136:139], a[76:79], a[196:199], v[136:139]
  v_mfma_f32_16x16x32_bf16 v[140:143], a[76:79], a[200:203], v[140:143]
  s_waitcnt vmcnt(53)
  v_mfma_f32_16x16x32_bf16 v[64:67], a[80:83], a[204:207], v[64:67]
  s_waitcnt vmcnt(52)
  v_mfma_f32_16x16x32_bf16 v[68:71], a[80:83], a[208:211], v[68:71]
  buffer_load_dwordx4 a[76:79], v56, s[76:79], s7 offen sc1
  s_waitcnt vmcnt(52)
  v_mfma_f32_16x16x32_bf16 v[72:75], a[80:83], a[212:215], v[72:75]
  s_waitcnt vmcnt(51)
  v_mfma_f32_16x16x32_bf16 v[76:79], a[80:83], a[216:219], v[76:79]
  s_add_u32 s13, s81, 1310720
  buffer_load_dwordx4 a[188:191], v54, s[72:75], s13 offen offset:0 sc1
  v_mfma_f32_16x16x32_bf16 v[80:83], a[84:87], a[204:207], v[80:83]
  v_mfma_f32_16x16x32_bf16 v[84:87], a[84:87], a[208:211], v[84:87]
  s_add_u32 s7, s80, 450560
  buffer_load_dwordx4 a[80:83], v54, s[76:79], s7 offen offset:0 sc1
  v_mfma_f32_16x16x32_bf16 v[88:91], a[84:87], a[212:215], v[88:91]
  v_mfma_f32_16x16x32_bf16 v[92:95], a[84:87], a[216:219], v[92:95]
  buffer_load_dwordx4 a[192:195], v54, s[72:75], s13 offen offset:1024 sc1
  v_mfma_f32_16x16x32_bf16 v[96:99], a[88:91], a[204:207], v[96:99]
  v_mfma_f32_16x16x32_bf16 v[100:103], a[88:91], a[208:211], v[100:103]
  buffer_load_dwordx4 a[84:87], v54, s[76:79], s7 offen offset:1024 sc1
  v_mfma_f32_16x16x32_bf16 v[104:107], a[88:91], a[212:215], v[104:107]
  v_mfma_f32_16x16x32_bf16 v[108:111], a[88:91], a[216:219], v[108:111]
  buffer_load_dwordx4 a[196:199], v54, s[72:75], s13 offen offset:2048 sc1
  v_mfma_f32_16x16x32_bf16 v[112:115], a[92:95], a[204:207], v[112:115]
  v_mfma_f32_16x16x32_bf16 v[116:119], a[92:95], a[208:211], v[116:119]
  buffer_load_dwordx4 a[88:91], v54, s[76:79], s7 offen offset:2048 sc1
  v_mfma_f32_16x16x32_bf16 v[120:123], a[92:95], a[212:215], v[120:123]
  v_mfma_f32_16x16x32_bf16 v[124:127], a[92:95], a[216:219], v[124:127]
  buffer_load_dwordx4 a[200:203], v54, s[72:75], s13 offen offset:3072 sc1
  v_mfma_f32_16x16x32_bf16 v[128:131], a[96:99], a[204:207], v[128:131]
  v_mfma_f32_16x16x32_bf16 v[132:135], a[96:99], a[208:211], v[132:135]
  buffer_load_dwordx4 a[92:95], v54, s[76:79], s7 offen offset:3072 sc1
  v_mfma_f32_16x16x32_bf16 v[136:139], a[96:99], a[212:215], v[136:139]
  v_mfma_f32_16x16x32_bf16 v[140:143], a[96:99], a[216:219], v[140:143]
  s_waitcnt vmcnt(58)
  v_mfma_f32_16x16x32_bf16 v[64:67], a[100:103], a[220:223], v[64:67]
  s_waitcnt vmcnt(57)
  v_mfma_f32_16x16x32_bf16 v[68:71], a[100:103], a[224:227], v[68:71]
  buffer_load_dwordx4 a[96:99], v56, s[76:79], s7 offen sc1
  s_waitcnt vmcnt(57)
  v_mfma_f32_16x16x32_bf16 v[72:75], a[100:103], a[228:231], v[72:75]
  s_waitcnt vmcnt(56)
  v_mfma_f32_16x16x32_bf16 v[76:79], a[100:103], a[232:235], v[76:79]
  s_add_u32 s13, s81, 1441792
  buffer_load_dwordx4 a[204:207], v54, s[72:75], s13 offen offset:0 sc1
  v_mfma_f32_16x16x32_bf16 v[80:83], a[104:107], a[220:223], v[80:83]
  v_mfma_f32_16x16x32_bf16 v[84:87], a[104:107], a[224:227], v[84:87]
  s_add_u32 s7, s80, 491520
  buffer_load_dwordx4 a[100:103], v54, s[76:79], s7 offen offset:0 sc1
  v_mfma_f32_16x16x32_bf16 v[88:91], a[104:107], a[228:231], v[88:91]
  v_mfma_f32_16x16x32_bf16 v[92:95], a[104:107], a[232:235], v[92:95]
  buffer_load_dwordx4 a[208:211], v54, s[72:75], s13 offen offset:1024 sc1
  v_mfma_f32_16x16x32_bf16 v[96:99], a[108:111], a[220:223], v[96:99]
  v_mfma_f32_16x16x32_bf16 v[100:103], a[108:111], a[224:227], v[100:103]
  buffer_load_dwordx4 a[104:107], v54, s[76:79], s7 offen offset:1024 sc1
  v_mfma_f32_16x16x32_bf16 v[104:107], a[108:111], a[228:231], v[104:107]
  v_mfma_f32_16x16x32_bf16 v[108:111], a[108:111], a[232:235], v[108:111]
  buffer_load_dwordx4 a[212:215], v54, s[72:75], s13 offen offset:2048 sc1
  v_mfma_f32_16x16x32_bf16 v[112:115], a[112:115], a[220:223], v[112:115]
  v_mfma_f32_16x16x32_bf16 v[116:119], a[112:115], a[224:227], v[116:119]
  buffer_load_dwordx4 a[108:111], v54, s[76:79], s7 offen offset:2048 sc1
  v_mfma_f32_16x16x32_bf16 v[120:123], a[112:115], a[228:231], v[120:123]
  v_mfma_f32_16x16x32_bf16 v[124:127], a[112:115], a[232:235], v[124:127]
  buffer_load_dwordx4 a[216:219], v54, s[72:75], s13 offen offset:3072 sc1
  v_mfma_f32_16x16x32_bf16 v[128:131], a[116:119], a[220:223], v[128:131]
  v_mfma_f32_16x16x32_bf16 v[132:135], a[116:119], a[224:227], v[132:135]
  buffer_load_dwordx4 a[112:115], v54, s[76:79], s7 offen offset:3072 sc1
  v_mfma_f32_16x16x32_bf16 v[136:139], a[116:119], a[228:231], v[136:139]
  v_mfma_f32_16x16x32_bf16 v[140:143], a[116:119], a[232:235], v[140:143]
  s_waitcnt vmcnt(63)
  v_mfma_f32_16x16x32_bf16 v[64:67], a[120:123], a[236:239], v[64:67]
  s_waitcnt vmcnt(61)
  v_mfma_f32_16x16x32_bf16 v[68:71], a[120:123], a[240:243], v[68:71]
  buffer_load_dwordx4 a[116:119], v56, s[76:79], s7 offen sc1
  s_waitcnt vmcnt(60)
  v_mfma_f32_16x16x32_bf16 v[72:75], a[120:123], a[244:247], v[72:75]
  s_waitcnt vmcnt(58)
  v_mfma_f32_16x16x32_bf16 v[76:79], a[120:123], a[248:251], v[76:79]
  s_add_u32 s13, s81, 1572864
  buffer_load_dwordx4 a[220:223], v54, s[72:75], s13 offen offset:0 sc1
  v_mfma_f32_16x16x32_bf16 v[80:83], a[124:127], a[236:239], v[80:83]
  v_mfma_f32_16x16x32_bf16 v[84:87], a[124:127], a[240:243], v[84:87]
  s_add_u32 s7, s80, 532480
  buffer_load_dwordx4 a[120:123], v54, s[76:79], s7 offen offset:0 sc1
  v_mfma_f32_16x16x32_bf16 v[88:91], a[124:127], a[244:247], v[88:91]
  v_mfma_f32_16x16x32_bf16 v[92:95], a[124:127], a[248:251], v[92:95]
  buffer_load_dwordx4 a[224:227], v54, s[72:75], s13 offen offset:1024 sc1
  v_mfma_f32_16x16x32_bf16 v[96:99], a[128:131], a[236:239], v[96:99]
  v_mfma_f32_16x16x32_bf16 v[100:103], a[128:131], a[240:243], v[100:103]
  buffer_load_dwordx4 a[124:127], v54, s[76:79], s7 offen offset:1024 sc1
  v_mfma_f32_16x16x32_bf16 v[104:107], a[128:131], a[244:247], v[104:107]
  v_mfma_f32_16x16x32_bf16 v[108:111], a[128:131], a[248:251], v[108:111]
  buffer_load_dwordx4 a[228:231], v54, s[72:75], s13 offen offset:2048 sc1
  v_mfma_f32_16x16x32_bf16 v[112:115], a[132:135], a[236:239], v[112:115]
  v_mfma_f32_16x16x32_bf16 v[116:119], a[132:135], a[240:243], v[116:119]
  buffer_load_dwordx4 a[128:131], v54, s[76:79], s7 offen offset:2048 sc1
  v_mfma_f32_16x16x32_bf16 v[120:123], a[132:135], a[244:247], v[120:123]
  v_mfma_f32_16x16x32_bf16 v[124:127], a[132:135], a[248:251], v[124:127]
  buffer_load_dwordx4 a[232:235], v54, s[72:75], s13 offen offset:3072 sc1
  v_mfma_f32_16x16x32_bf16 v[128:131], a[136:139], a[236:239], v[128:131]
  v_mfma_f32_16x16x32_bf16 v[132:135], a[136:139], a[240:243], v[132:135]
  buffer_load_dwordx4 a[132:135], v54, s[76:79], s7 offen offset:3072 sc1
  v_mfma_f32_16x16x32_bf16 v[136:139], a[136:139], a[244:247], v[136:139]
  v_mfma_f32_16x16x32_bf16 v[140:143], a[136:139], a[248:251], v[140:143]
  s_waitcnt vmcnt(63)
  v_mfma_f32_16x16x32_bf16 v[64:67], a[0:3], a[140:143], v[64:67]
  s_waitcnt vmcnt(58)
  v_mfma_f32_16x16x32_bf16 v[68:71], a[0:3], a[144:147], v[68:71]
  buffer_load_dwordx4 a[136:139], v56, s[76:79], s7 offen sc1
  s_waitcnt vmcnt(55)
  v_mfma_f32_16x16x32_bf16 v[72:75], a[0:3], a[148:151], v[72:75]
  s_waitcnt vmcnt(51)
  v_mfma_f32_16x16x32_bf16 v[76:79], a[0:3], a[152:155], v[76:79]
  s_add_u32 s13, s81, 1703936
  buffer_load_dwordx4 a[236:239], v54, s[72:75], s13 offen offset:0 sc1
  v_mfma_f32_16x16x32_bf16 v[80:83], a[4:7], a[140:143], v[80:83]
  v_mfma_f32_16x16x32_bf16 v[84:87], a[4:7], a[144:147], v[84:87]
  s_add_u32 s7, s80, 573440
  buffer_load_dwordx4 a[0:3], v54, s[76:79], s7 offen offset:0 sc1
  v_mfma_f32_16x16x32_bf16 v[88:91], a[4:7], a[148:151], v[88:91]
  v_mfma_f32_16x16x32_bf16 v[92:95], a[4:7], a[152:155], v[92:95]
  buffer_load_dwordx4 a[240:243], v54, s[72:75], s13 offen offset:1024 sc1
  v_mfma_f32_16x16x32_bf16 v[96:99], a[8:11], a[140:143], v[96:99]
  v_mfma_f32_16x16x32_bf16 v[100:103], a[8:11], a[144:147], v[100:103]
  buffer_load_dwordx4 a[4:7], v54, s[76:79], s7 offen offset:1024 sc1
  v_mfma_f32_16x16x32_bf16 v[104:107], a[8:11], a[148:151], v[104:107]
  v_mfma_f32_16x16x32_bf16 v[108:111], a[8:11], a[152:155], v[108:111]
  buffer_load_dwordx4 a[244:247], v54, s[72:75], s13 offen offset:2048 sc1
  v_mfma_f32_16x16x32_bf16 v[112:115], a[12:15], a[140:143], v[112:115]
  v_mfma_f32_16x16x32_bf16 v[116:119], a[12:15], a[144:147], v[116:119]
  buffer_load_dwordx4 a[8:11], v54, s[76:79], s7 offen offset:2048 sc1
  v_mfma_f32_16x16x32_bf16 v[120:123], a[12:15], a[148:151], v[120:123]
  v_mfma_f32_16x16x32_bf16 v[124:127], a[12:15], a[152:155], v[124:127]
  buffer_load_dwordx4 a[248:251], v54, s[72:75], s13 offen offset:3072 sc1
  v_mfma_f32_16x16x32_bf16 v[128:131], a[16:19], a[140:143], v[128:131]
  v_mfma_f32_16x16x32_bf16 v[132:135], a[16:19], a[144:147], v[132:135]
  buffer_load_dwordx4 a[12:15], v54, s[76:79], s7 offen offset:3072 sc1
  v_mfma_f32_16x16x32_bf16 v[136:139], a[16:19], a[148:151], v[136:139]
  v_mfma_f32_16x16x32_bf16 v[140:143], a[16:19], a[152:155], v[140:143]
  s_waitcnt vmcnt(52)
  v_mfma_f32_16x16x32_bf16 v[64:67], a[20:23], a[156:159], v[64:67]
  s_waitcnt vmcnt(50)
  v_mfma_f32_16x16x32_bf16 v[68:71], a[20:23], a[160:163], v[68:71]
  buffer_load_dwordx4 a[16:19], v56, s[76:79], s7 offen sc1
  s_waitcnt vmcnt(49)
  v_mfma_f32_16x16x32_bf16 v[72:75], a[20:23], a[164:167], v[72:75]
  s_waitcnt vmcnt(47)
  v_mfma_f32_16x16x32_bf16 v[76:79], a[20:23], a[168:171], v[76:79]
  s_add_u32 s13, s81, 1835008
  buffer_load_dwordx4 a[140:143], v54, s[72:75], s13 offen offset:0 sc1
  v_mfma_f32_16x16x32_bf16 v[80:83], a[24:27], a[156:159], v[80:83]
  v_mfma_f32_16x16x32_bf16 v[84:87], a[24:27], a[160:163], v[84:87]
  s_add_u32 s7, s80, 614400
  buffer_load_dwordx4 a[20:23], v54, s[76:79], s7 offen offset:0 sc1
  v_mfma_f32_16x16x32_bf16 v[88:91], a[24:27], a[164:167], v[88:91]
  v_mfma_f32_16x16x32_bf16 v[92:95], a[24:27], a[168:171], v[92:95]
  buffer_load_dwordx4 a[144:147], v54, s[72:75], s13 offen offset:1024 sc1
  v_mfma_f32_16x16x32_bf16 v[96:99], a[28:31], a[156:159], v[96:99]
  v_mfma_f32_16x16x32_bf16 v[100:103], a[28:31], a[160:163], v[100:103]
  buffer_load_dwordx4 a[24:27], v54, s[76:79], s7 offen offset:1024 sc1
  v_mfma_f32_16x16x32_bf16 v[104:107], a[28:31], a[164:167], v[104:107]
  v_mfma_f32_16x16x32_bf16 v[108:111], a[28:31], a[168:171], v[108:111]
  buffer_load_dwordx4 a[148:151], v54, s[72:75], s13 offen offset:2048 sc1
  v_mfma_f32_16x16x32_bf16 v[112:115], a[32:35], a[156:159], v[112:115]
  v_mfma_f32_16x16x32_bf16 v[116:119], a[32:35], a[160:163], v[116:119]
  buffer_load_dwordx4 a[28:31], v54, s[76:79], s7 offen offset:2048 sc1
  v_mfma_f32_16x16x32_bf16 v[120:123], a[32:35], a[164:167], v[120:123]
  v_mfma_f32_16x16x32_bf16 v[124:127], a[32:35], a[168:171], v[124:127]
  buffer_load_dwordx4 a[152:155], v54, s[72:75], s13 offen offset:3072 sc1
  v_mfma_f32_16x16x32_bf16 v[128:131], a[36:39], a[156:159], v[128:131]
  v_mfma_f32_16x16x32_bf16 v[132:135], a[36:39], a[160:163], v[132:135]
  buffer_load_dwordx4 a[32:35], v54, s[76:79], s7 offen offset:3072 sc1
  v_mfma_f32_16x16x32_bf16 v[136:139], a[36:39], a[164:167], v[136:139]
  v_mfma_f32_16x16x32_bf16 v[140:143], a[36:39], a[168:171], v[140:143]
  s_waitcnt vmcnt(52)
  v_mfma_f32_16x16x32_bf16 v[64:67], a[40:43], a[172:175], v[64:67]
  s_waitcnt vmcnt(50)
  v_mfma_f32_16x16x32_bf16 v[68:71], a[40:43], a[176:179], v[68:71]
  buffer_load_dwordx4 a[36:39], v56, s[76:79], s7 offen sc1
  s_waitcnt vmcnt(49)
  v_mfma_f32_16x16x32_bf16 v[72:75], a[40:43], a[180:183], v[72:75]
  s_waitcnt vmcnt(47)
  v_mfma_f32_16x16x32_bf16 v[76:79], a[40:43], a[184:187], v[76:79]
  s_add_u32 s13, s81, 1966080
  buffer_load_dwordx4 a[156:159], v54, s[72:75], s13 offen offset:0 sc1
  buffer_load_dword v9, v4, s[56:59], s89 offen sc1
  v_mfma_f32_16x16x32_bf16 v[80:83], a[44:47], a[172:175], v[80:83]
  v_mfma_f32_16x16x32_bf16 v[84:87], a[44:47], a[176:179], v[84:87]
  s_add_u32 s7, s80, 655360
  buffer_load_dwordx4 a[40:43], v54, s[76:79], s7 offen offset:0 sc1
  v_mfma_f32_16x16x32_bf16 v[88:91], a[44:47], a[180:183], v[88:91]
  v_mfma_f32_16x16x32_bf16 v[92:95], a[44:47], a[184:187], v[92:95]
  buffer_load_dwordx4 a[160:163], v54, s[72:75], s13 offen offset:1024 sc1
  v_mfma_f32_16x16x32_bf16 v[96:99], a[48:51], a[172:175], v[96:99]
  v_mfma_f32_16x16x32_bf16 v[100:103], a[48:51], a[176:179], v[100:103]
  buffer_load_dwordx4 a[44:47], v54, s[76:79], s7 offen offset:1024 sc1
  v_mfma_f32_16x16x32_bf16 v[104:107], a[48:51], a[180:183], v[104:107]
  v_mfma_f32_16x16x32_bf16 v[108:111], a[48:51], a[184:187], v[108:111]
  buffer_load_dwordx4 a[164:167], v54, s[72:75], s13 offen offset:2048 sc1
  v_mfma_f32_16x16x32_bf16 v[112:115], a[52:55], a[172:175], v[112:115]
  v_mfma_f32_16x16x32_bf16 v[116:119], a[52:55], a[176:179], v[116:119]
  buffer_load_dwordx4 a[48:51], v54, s[76:79], s7 offen offset:2048 sc1
  v_mfma_f32_16x16x32_bf16 v[120:123], a[52:55], a[180:183], v[120:123]
  v_mfma_f32_16x16x32_bf16 v[124:127], a[52:55], a[184:187], v[124:127]
  buffer_load_dwordx4 a[168:171], v54, s[72:75], s13 offen offset:3072 sc1
  v_mfma_f32_16x16x32_bf16 v[128:131], a[56:59], a[172:175], v[128:131]
  v_mfma_f32_16x16x32_bf16 v[132:135], a[56:59], a[176:179], v[132:135]
  buffer_load_dwordx4 a[52:55], v54, s[76:79], s7 offen offset:3072 sc1
  v_mfma_f32_16x16x32_bf16 v[136:139], a[56:59], a[180:183], v[136:139]
  v_mfma_f32_16x16x32_bf16 v[140:143], a[56:59], a[184:187], v[140:143]
  s_waitcnt vmcnt(53)
  v_mfma_f32_16x16x32_bf16 v[64:67], a[60:63], a[188:191], v[64:67]
  s_waitcnt vmcnt(51)
  v_mfma_f32_16x16x32_bf16 v[68:71], a[60:63], a[192:195], v[68:71]
  buffer_load_dwordx4 a[56:59], v56, s[76:79], s7 offen sc1
  s_waitcnt vmcnt(50)
  v_mfma_f32_16x16x32_bf16 v[72:75], a[60:63], a[196:199], v[72:75]
  s_waitcnt vmcnt(48)
  v_mfma_f32_16x16x32_bf16 v[76:79], a[60:63], a[200:203], v[76:79]
  s_add_u32 s13, s81, 2097152
  buffer_load_dwordx4 a[172:175], v54, s[72:75], s13 offen offset:0 sc1
  v_mfma_f32_16x16x32_bf16 v[80:83], a[64:67], a[188:191], v[80:83]
  v_mfma_f32_16x16x32_bf16 v[84:87], a[64:67], a[192:195], v[84:87]
  s_add_u32 s7, s80, 696320
  buffer_load_dwordx4 a[60:63], v54, s[76:79], s7 offen offset:0 sc1
  v_mfma_f32_16x16x32_bf16 v[88:91], a[64:67], a[196:199], v[88:91]
  v_mfma_f32_16x16x32_bf16 v[92:95], a[64:67], a[200:203], v[92:95]
  buffer_load_dwordx4 a[176:179], v54, s[72:75], s13 offen offset:1024 sc1
  v_mfma_f32_16x16x32_bf16 v[96:99], a[68:71], a[188:191], v[96:99]
  v_mfma_f32_16x16x32_bf16 v[100:103], a[68:71], a[192:195], v[100:103]
  buffer_load_dwordx4 a[64:67], v54, s[76:79], s7 offen offset:1024 sc1
  v_mfma_f32_16x16x32_bf16 v[104:107], a[68:71], a[196:199], v[104:107]
  v_mfma_f32_16x16x32_bf16 v[108:111], a[68:71], a[200:203], v[108:111]
  buffer_load_dwordx4 a[180:183], v54, s[72:75], s13 offen offset:2048 sc1
  v_mfma_f32_16x16x32_bf16 v[112:115], a[72:75], a[188:191], v[112:115]
  v_mfma_f32_16x16x32_bf16 v[116:119], a[72:75], a[192:195], v[116:119]
  buffer_load_dwordx4 a[68:71], v54, s[76:79], s7 offen offset:2048 sc1
  v_mfma_f32_16x16x32_bf16 v[120:123], a[72:75], a[196:199], v[120:123]
  v_mfma_f32_16x16x32_bf16 v[124:127], a[72:75], a[200:203], v[124:127]
  buffer_load_dwordx4 a[184:187], v54, s[72:75], s13 offen offset:3072 sc1
  v_mfma_f32_16x16x32_bf16 v[128:131], a[76:79], a[188:191], v[128:131]
  v_mfma_f32_16x16x32_bf16 v[132:135], a[76:79], a[192:195], v[132:135]
  buffer_load_dwordx4 a[72:75], v54, s[76:79], s7 offen offset:3072 sc1
  v_mfma_f32_16x16x32_bf16 v[136:139], a[76:79], a[196:199], v[136:139]
  v_mfma_f32_16x16x32_bf16 v[140:143], a[76:79], a[200:203], v[140:143]
  s_waitcnt vmcnt(53)
  v_mfma_f32_16x16x32_bf16 v[64:67], a[80:83], a[204:207], v[64:67]
  s_waitcnt vmcnt(51)
  v_mfma_f32_16x16x32_bf16 v[68:71], a[80:83], a[208:211], v[68:71]
  buffer_load_dwordx4 a[76:79], v56, s[76:79], s7 offen sc1
  s_waitcnt vmcnt(50)
  v_mfma_f32_16x16x32_bf16 v[72:75], a[80:83], a[212:215], v[72:75]
  s_waitcnt vmcnt(48)
  v_mfma_f32_16x16x32_bf16 v[76:79], a[80:83], a[216:219], v[76:79]
  s_add_u32 s13, s81, 2228224
  buffer_load_dwordx4 a[188:191], v54, s[72:75], s13 offen offset:0 sc1
  v_mfma_f32_16x16x32_bf16 v[80:83], a[84:87], a[204:207], v[80:83]
  v_mfma_f32_16x16x32_bf16 v[84:87], a[84:87], a[208:211], v[84:87]
  s_add_u32 s7, s80, 737280
  buffer_load_dwordx4 a[80:83], v54, s[76:79], s7 offen offset:0 sc1
  v_mfma_f32_16x16x32_bf16 v[88:91], a[84:87], a[212:215], v[88:91]
  v_mfma_f32_16x16x32_bf16 v[92:95], a[84:87], a[216:219], v[92:95]
  buffer_load_dwordx4 a[192:195], v54, s[72:75], s13 offen offset:1024 sc1
  v_mfma_f32_16x16x32_bf16 v[96:99], a[88:91], a[204:207], v[96:99]
  v_mfma_f32_16x16x32_bf16 v[100:103], a[88:91], a[208:211], v[100:103]
  buffer_load_dwordx4 a[84:87], v54, s[76:79], s7 offen offset:1024 sc1
  v_mfma_f32_16x16x32_bf16 v[104:107], a[88:91], a[212:215], v[104:107]
  v_mfma_f32_16x16x32_bf16 v[108:111], a[88:91], a[216:219], v[108:111]
  buffer_load_dwordx4 a[196:199], v54, s[72:75], s13 offen offset:2048 sc1
  v_mfma_f32_16x16x32_bf16 v[112:115], a[92:95], a[204:207], v[112:115]
  v_mfma_f32_16x16x32_bf16 v[116:119], a[92:95], a[208:211], v[116:119]
  buffer_load_dwordx4 a[88:91], v54, s[76:79], s7 offen offset:2048 sc1
  v_mfma_f32_16x16x32_bf16 v[120:123], a[92:95], a[212:215], v[120:123]
  v_mfma_f32_16x16x32_bf16 v[124:127], a[92:95], a[216:219], v[124:127]
  buffer_load_dwordx4 a[200:203], v54, s[72:75], s13 offen offset:3072 sc1
  v_mfma_f32_16x16x32_bf16 v[128:131], a[96:99], a[204:207], v[128:131]
  v_mfma_f32_16x16x32_bf16 v[132:135], a[96:99], a[208:211], v[132:135]
  buffer_load_dwordx4 a[92:95], v54, s[76:79], s7 offen offset:3072 sc1
  v_mfma_f32_16x16x32_bf16 v[136:139], a[96:99], a[212:215], v[136:139]
  v_mfma_f32_16x16x32_bf16 v[140:143], a[96:99], a[216:219], v[140:143]
  s_waitcnt vmcnt(53)
  v_mfma_f32_16x16x32_bf16 v[64:67], a[100:103], a[220:223], v[64:67]
  s_waitcnt vmcnt(51)
  v_mfma_f32_16x16x32_bf16 v[68:71], a[100:103], a[224:227], v[68:71]
  buffer_load_dwordx4 a[96:99], v56, s[76:79], s7 offen sc1
  s_waitcnt vmcnt(50)
  v_mfma_f32_16x16x32_bf16 v[72:75], a[100:103], a[228:231], v[72:75]
  s_waitcnt vmcnt(48)
  v_mfma_f32_16x16x32_bf16 v[76:79], a[100:103], a[232:235], v[76:79]
  s_add_u32 s13, s81, 2359296
  buffer_load_dwordx4 a[204:207], v54, s[72:75], s13 offen offset:0 sc1
  v_mfma_f32_16x16x32_bf16 v[80:83], a[104:107], a[220:223], v[80:83]
  v_mfma_f32_16x16x32_bf16 v[84:87], a[104:107], a[224:227], v[84:87]
  s_add_u32 s7, s80, 778240
  buffer_load_dwordx4 a[100:103], v54, s[76:79], s7 offen offset:0 sc1
  v_mfma_f32_16x16x32_bf16 v[88:91], a[104:107], a[228:231], v[88:91]
  v_mfma_f32_16x16x32_bf16 v[92:95], a[104:107], a[232:235], v[92:95]
  buffer_load_dwordx4 a[208:211], v54, s[72:75], s13 offen offset:1024 sc1
  v_mfma_f32_16x16x32_bf16 v[96:99], a[108:111], a[220:223], v[96:99]
  v_mfma_f32_16x16x32_bf16 v[100:103], a[108:111], a[224:227], v[100:103]
  buffer_load_dwordx4 a[104:107], v54, s[76:79], s7 offen offset:1024 sc1
  v_mfma_f32_16x16x32_bf16 v[104:107], a[108:111], a[228:231], v[104:107]
  v_mfma_f32_16x16x32_bf16 v[108:111], a[108:111], a[232:235], v[108:111]
  buffer_load_dwordx4 a[212:215], v54, s[72:75], s13 offen offset:2048 sc1
  v_mfma_f32_16x16x32_bf16 v[112:115], a[112:115], a[220:223], v[112:115]
  v_mfma_f32_16x16x32_bf16 v[116:119], a[112:115], a[224:227], v[116:119]
  buffer_load_dwordx4 a[108:111], v54, s[76:79], s7 offen offset:2048 sc1
  v_mfma_f32_16x16x32_bf16 v[120:123], a[112:115], a[228:231], v[120:123]
  v_mfma_f32_16x16x32_bf16 v[124:127], a[112:115], a[232:235], v[124:127]
  buffer_load_dwordx4 a[216:219], v54, s[72:75], s13 offen offset:3072 sc1
  v_mfma_f32_16x16x32_bf16 v[128:131], a[116:119], a[220:223], v[128:131]
  v_mfma_f32_16x16x32_bf16 v[132:135], a[116:119], a[224:227], v[132:135]
  buffer_load_dwordx4 a[112:115], v54, s[76:79], s7 offen offset:3072 sc1
  v_mfma_f32_16x16x32_bf16 v[136:139], a[116:119], a[228:231], v[136:139]
  v_mfma_f32_16x16x32_bf16 v[140:143], a[116:119], a[232:235], v[140:143]
  s_waitcnt vmcnt(34)
  v_cmp_ne_u32 vcc, s6, v9
  s_nop 1
  s_andn2_b64 vcc, vcc, s[98:99]
  s_cmp_eq_u64 vcc, 0
  s_cbranch_scc0 L_slow_38
L_back_39:
  v_mfma_f32_16x16x32_bf16 v[64:67], a[120:123], a[236:239], v[64:67]
  v_mfma_f32_16x16x32_bf16 v[68:71], a[120:123], a[240:243], v[68:71]
  buffer_load_dwordx4 a[116:119], v56, s[76:79], s7 offen sc1
  v_mfma_f32_16x16x32_bf16 v[72:75], a[120:123], a[244:247], v[72:75]
  v_mfma_f32_16x16x32_bf16 v[76:79], a[120:123], a[248:251], v[76:79]
  s_add_u32 s13, s81, 2490368
  buffer_load_dwordx4 a[220:223], v54, s[72:75], s13 offen offset:0 sc1
  v_mfma_f32_16x16x32_bf16 v[80:83], a[124:127], a[236:239], v[80:83]
  v_mfma_f32_16x16x32_bf16 v[84:87], a[124:127], a[240:243], v[84:87]
  s_add_u32 s7, s91, 819200
  buffer_load_dwordx4 a[120:123], v54, s[76:79], s7 offen offset:0 sc1
  v_mfma_f32_16x16x32_bf16 v[88:91], a[124:127], a[244:247], v[88:91]
  v_mfma_f32_16x16x32_bf16 v[92:95], a[124:127], a[248:251], v[92:95]
  buffer_load_dwordx4 a[224:227], v54, s[72:75], s13 offen offset:1024 sc1
  v_mfma_f32_16x16x32_bf16 v[96:99], a[128:131], a[236:239], v[96:99]
  v_mfma_f32_16x16x32_bf16 v[100:103], a[128:131], a[240:243], v[100:103]
  buffer_load_dwordx4 a[124:127], v54, s[76:79], s7 offen offset:1024 sc1
  v_mfma_f32_16x16x32_bf16 v[104:107], a[128:131], a[244:247], v[104:107]
  v_mfma_f32_16x16x32_bf16 v[108:111], a[128:131], a[248:251], v[108:111]
  buffer_load_dwordx4 a[228:231], v54, s[72:75], s13 offen offset:2048 sc1
  v_mfma_f32_16x16x32_bf16 v[112:115], a[132:135], a[236:239], v[112:115]
  v_mfma_f32_16x16x32_bf16 v[116:119], a[132:135], a[240:243], v[116:119]
  buffer_load_dwordx4 a[128:131], v54, s[76:79], s7 offen offset:2048 sc1
  v_mfma_f32_16x16x32_bf16 v[120:123], a[132:135], a[244:247], v[120:123]
  v_mfma_f32_16x16x32_bf16 v[124:127], a[132:135], a[248:251], v[124:127]
  buffer_load_dwordx4 a[232:235], v54, s[72:75], s13 offen offset:3072 sc1
  v_mfma_f32_16x16x32_bf16 v[128:131], a[136:139], a[236:239], v[128:131]
  v_mfma_f32_16x16x32_bf16 v[132:135], a[136:139], a[240:243], v[132:135]
  buffer_load_dwordx4 a[132:135], v54, s[76:79], s7 offen offset:3072 sc1
  v_mfma_f32_16x16x32_bf16 v[136:139], a[136:139], a[244:247], v[136:139]
  v_mfma_f32_16x16x32_bf16 v[140:143], a[136:139], a[248:251], v[140:143]
  v_mfma_f32_16x16x32_bf16 v[64:67], a[0:3], a[140:143], v[64:67]
  v_mfma_f32_16x16x32_bf16 v[68:71], a[0:3], a[144:147], v[68:71]
  buffer_load_dwordx4 a[136:139], v56, s[76:79], s7 offen sc1
  v_mfma_f32_16x16x32_bf16 v[72:75], a[0:3], a[148:151], v[72:75]
  v_mfma_f32_16x16x32_bf16 v[76:79], a[0:3], a[152:155], v[76:79]
  s_add_u32 s13, s90, 2621440
  buffer_load_dwordx4 a[236:239], v54, s[72:75], s13 offen offset:0 sc1
  v_lshlrev_b32 v244, 16, v246
  v_and_b32 v245, 0xffff0000, v246
  v_rcp_f32 v245, v245
  v_mfma_f32_16x16x32_bf16 v[80:83], a[4:7], a[140:143], v[80:83]
  v_mfma_f32_16x16x32_bf16 v[84:87], a[4:7], a[144:147], v[84:87]
  s_add_u32 s7, s91, 860160
  buffer_load_dwordx4 a[0:3], v54, s[76:79], s7 offen offset:0 sc1
  v_mfma_f32_16x16x32_bf16 v[88:91], a[4:7], a[148:151], v[88:91]
  v_mfma_f32_16x16x32_bf16 v[92:95], a[4:7], a[152:155], v[92:95]
  buffer_load_dwordx4 a[240:243], v54, s[72:75], s13 offen offset:1024 sc1
  v_lshlrev_b32 v14, 16, v224
  v_and_b32 v15, 0xffff0000, v224
  v_lshlrev_b32 v16, 16, v225
  v_mfma_f32_16x16x32_bf16 v[96:99], a[8:11], a[140:143], v[96:99]
  v_mfma_f32_16x16x32_bf16 v[100:103], a[8:11], a[144:147], v[100:103]
  buffer_load_dwordx4 a[4:7], v54, s[76:79], s7 offen offset:1024 sc1
  v_mfma_f32_16x16x32_bf16 v[104:107], a[8:11], a[148:151], v[104:107]
  v_mfma_f32_16x16x32_bf16 v[108:111], a[8:11], a[152:155], v[108:111]
  buffer_load_dwordx4 a[244:247], v54, s[72:75], s13 offen offset:2048 sc1
  v_and_b32 v17, 0xffff0000, v225
  v_lshlrev_b32 v34, 16, v234
  v_and_b32 v35, 0xffff0000, v234
  v_lshlrev_b32 v36, 16, v235
  v_mfma_f32_16x16x32_bf16 v[112:115], a[12:15], a[140:143], v[112:115]
  v_mfma_f32_16x16x32_bf16 v[116:119], a[12:15], a[144:147], v[116:119]
  buffer_load_dwordx4 a[8:11], v54, s[76:79], s7 offen offset:2048 sc1
  v_mfma_f32_16x16x32_bf16 v[120:123], a[12:15], a[148:151], v[120:123]
  v_mfma_f32_16x16x32_bf16 v[124:127], a[12:15], a[152:155], v[124:127]
  buffer_load_dwordx4 a[248:251], v54, s[72:75], s13 offen offset:3072 sc1
  v_and_b32 v37, 0xffff0000, v235
  v_sub_f32 v248, v14, v244
  v_sub_f32 v249, v15, v244
  v_mfma_f32_16x16x32_bf16 v[128:131], a[16:19], a[140:143], v[128:131]
  v_mfma_f32_16x16x32_bf16 v[132:135], a[16:19], a[144:147], v[132:135]
  buffer_load_dwordx4 a[12:15], v54, s[76:79], s7 offen offset:3072 sc1
  v_mfma_f32_16x16x32_bf16 v[136:139], a[16:19], a[148:151], v[136:139]
  v_mfma_f32_16x16x32_bf16 v[140:143], a[16:19], a[152:155], v[140:143]
  v_sub_f32 v250, v16, v244
  v_sub_f32 v251, v17, v244
  v_mul_f32 v248, v248, v245
  v_mfma_f32_16x16x32_bf16 v[64:67], a[20:23], a[156:159], v[64:67]
  s_waitcnt vmcnt(50)
  v_mfma_f32_16x16x32_bf16 v[68:71], a[20:23], a[160:163], v[68:71]
  buffer_load_dwordx4 a[16:19], v56, s[76:79], s7 offen sc1
  s_waitcnt vmcnt(49)
  v_mfma_f32_16x16x32_bf16 v[72:75], a[20:23], a[164:167], v[72:75]
  s_waitcnt vmcnt(47)
  v_mfma_f32_16x16x32_bf16 v[76:79], a[20:23], a[168:171], v[76:79]
  s_add_u32 s13, s90, 2752512
  buffer_load_dwordx4 a[140:143], v54, s[72:75], s13 offen offset:0 sc1
  v_mul_f32 v249, v249, v245
  v_mul_f32 v250, v250, v245
  v_mul_f32 v251, v251, v245
  v_mul_f32 v34, v34, v248
  v_mfma_f32_16x16x32_bf16 v[80:83], a[24:27], a[156:159], v[80:83]
  v_mfma_f32_16x16x32_bf16 v[84:87], a[24:27], a[160:163], v[84:87]
  s_add_u32 s7, s91, 901120
  buffer_load_dwordx4 a[20:23], v54, s[76:79], s7 offen offset:0 sc1
  v_mfma_f32_16x16x32_bf16 v[88:91], a[24:27], a[164:167], v[88:91]
  v_mfma_f32_16x16x32_bf16 v[92:95], a[24:27], a[168:171], v[92:95]
  buffer_load_dwordx4 a[144:147], v54, s[72:75], s13 offen offset:1024 sc1
  v_mul_f32 v35, v35, v249
  v_mul_f32 v36, v36, v250
  v_mul_f32 v37, v37, v251
  v_mfma_f32_16x16x32_bf16 v[96:99], a[28:31], a[156:159], v[96:99]
  v_mfma_f32_16x16x32_bf16 v[100:103], a[28:31], a[160:163], v[100:103]
  buffer_load_dwordx4 a[24:27], v54, s[76:79], s7 offen offset:1024 sc1
  v_mfma_f32_16x16x32_bf16 v[104:107], a[28:31], a[164:167], v[104:107]
  v_mfma_f32_16x16x32_bf16 v[108:111], a[28:31], a[168:171], v[108:111]
  buffer_load_dwordx4 a[148:151], v54, s[72:75], s13 offen offset:2048 sc1
  v_lshlrev_b32 v18, 16, v226
  v_and_b32 v19, 0xffff0000, v226
  v_lshlrev_b32 v20, 16, v227
  v_and_b32 v21, 0xffff0000, v227
  v_mfma_f32_16x16x32_bf16 v[112:115], a[32:35], a[156:159], v[112:115]
  v_mfma_f32_16x16x32_bf16 v[116:119], a[32:35], a[160:163], v[116:119]
  buffer_load_dwordx4 a[28:31], v54, s[76:79], s7 offen offset:2048 sc1
  v_mfma_f32_16x16x32_bf16 v[120:123], a[32:35], a[164:167], v[120:123]
  v_mfma_f32_16x16x32_bf16 v[124:127], a[32:35], a[168:171], v[124:127]
  buffer_load_dwordx4 a[152:155], v54, s[72:75], s13 offen offset:3072 sc1
  v_lshlrev_b32 v38, 16, v236
  v_and_b32 v39, 0xffff0000, v236
  v_lshlrev_b32 v40, 16, v237
  v_mfma_f32_16x16x32_bf16 v[128:131], a[36:39], a[156:159], v[128:131]
  v_mfma_f32_16x16x32_bf16 v[132:135], a[36:39], a[160:163], v[132:135]
  buffer_load_dwordx4 a[32:35], v54, s[76:79], s7 offen offset:3072 sc1
  v_mfma_f32_16x16x32_bf16 v[136:139], a[36:39], a[164:167], v[136:139]
  v_mfma_f32_16x16x32_bf16 v[140:143], a[36:39], a[168:171], v[140:143]
  v_and_b32 v41, 0xffff0000, v237
  v_sub_f32 v248, v18, v244
  v_sub_f32 v249, v19, v244
  s_waitcnt vmcnt(52)
  v_mfma_f32_16x16x32_bf16 v[64:67], a[40:43], a[172:175], v[64:67]
  s_waitcnt vmcnt(50)
  v_mfma_f32_16x16x32_bf16 v[68:71], a[40:43], a[176:179], v[68:71]
  buffer_load_dwordx4 a[36:39], v56, s[76:79], s7 offen sc1
  s_waitcnt vmcnt(49)
  v_mfma_f32_16x16x32_bf16 v[72:75], a[40:43], a[180:183], v[72:75]
  s_waitcnt vmcnt(47)
  v_mfma_f32_16x16x32_bf16 v[76:79], a[40:43], a[184:187], v[76:79]
  s_add_u32 s13, s90, 2883584
  buffer_load_dwordx4 a[156:159], v54, s[72:75], s13 offen offset:0 sc1
  v_sub_f32 v250, v20, v244
  v_sub_f32 v251, v21, v244
  v_mul_f32 v248, v248, v245
  v_mul_f32 v249, v249, v245
  v_mfma_f32_16x16x32_bf16 v[80:83], a[44:47], a[172:175], v[80:83]
  v_mfma_f32_16x16x32_bf16 v[84:87], a[44:47], a[176:179], v[84:87]
  s_add_u32 s7, s91, 942080
  buffer_load_dwordx4 a[40:43], v54, s[76:79], s7 offen offset:0 sc1
  v_mfma_f32_16x16x32_bf16 v[88:91], a[44:47], a[180:183], v[88:91]
  v_mfma_f32_16x16x32_bf16 v[92:95], a[44:47], a[184:187], v[92:95]
  buffer_load_dwordx4 a[160:163], v54, s[72:75], s13 offen offset:1024 sc1
  v_mul_f32 v250, v250, v245
  v_mul_f32 v251, v251, v245
  v_mul_f32 v38, v38, v248
  v_mul_f32 v39, v39, v249
  v_mfma_f32_16x16x32_bf16 v[96:99], a[48:51], a[172:175], v[96:99]
  v_mfma_f32_16x16x32_bf16 v[100:103], a[48:51], a[176:179], v[100:103]
  buffer_load_dwordx4 a[44:47], v54, s[76:79], s7 offen offset:1024 sc1
  v_mfma_f32_16x16x32_bf16 v[104:107], a[48:51], a[180:183], v[104:107]
  v_mfma_f32_16x16x32_bf16 v[108:111], a[48:51], a[184:187], v[108:111]
  buffer_load_dwordx4 a[164:167], v54, s[72:75], s13 offen offset:2048 sc1
  v_mul_f32 v40, v40, v250
  v_mul_f32 v41, v41, v251
  v_lshlrev_b32 v22, 16, v228
  v_mfma_f32_16x16x32_bf16 v[112:115], a[52:55], a[172:175], v[112:115]
  v_mfma_f32_16x16x32_bf16 v[116:119], a[52:55], a[176:179], v[116:119]
  buffer_load_dwordx4 a[48:51], v54, s[76:79], s7 offen offset:2048 sc1
  v_mfma_f32_16x16x32_bf16 v[120:123], a[52:55], a[180:183], v[120:123]
  v_mfma_f32_16x16x32_bf16 v[124:127], a[52:55], a[184:187], v[124:127]
  buffer_load_dwordx4 a[168:171], v54, s[72:75], s13 offen offset:3072 sc1
  v_and_b32 v23, 0xffff0000, v228
  v_lshlrev_b32 v24, 16, v229
  v_and_b32 v25, 0xffff0000, v229
  v_lshlrev_b32 v42, 16, v238
  v_mfma_f32_16x16x32_bf16 v[128:131], a[56:59], a[172:175], v[128:131]
  v_mfma_f32_16x16x32_bf16 v[132:135], a[56:59], a[176:179], v[132:135]
  buffer_load_dwordx4 a[52:55], v54, s[76:79], s7 offen offset:3072 sc1
  v_mfma_f32_16x16x32_bf16 v[136:139], a[56:59], a[180:183], v[136:139]
  v_mfma_f32_16x16x32_bf16 v[140:143], a[56:59], a[184:187], v[140:143]
  v_and_b32 v43, 0xffff0000, v238
  v_lshlrev_b32 v44, 16, v239
  v_and_b32 v45, 0xffff0000, v239
  s_waitcnt vmcnt(52)
  v_mfma_f32_16x16x32_bf16 v[64:67], a[60:63], a[188:191], v[64:67]
  s_waitcnt vmcnt(50)
  v_mfma_f32_16x16x32_bf16 v[68:71], a[60:63], a[192:195], v[68:71]
  buffer_load_dwordx4 a[56:59], v56, s[76:79], s7 offen sc1
  s_waitcnt vmcnt(49)
  v_mfma_f32_16x16x32_bf16 v[72:75], a[60:63], a[196:199], v[72:75]
  s_waitcnt vmcnt(47)
  v_mfma_f32_16x16x32_bf16 v[76:79], a[60:63], a[200:203], v[76:79]
  s_add_u32 s13, s90, 3014656
  buffer_load_dwordx4 a[172:175], v54, s[72:75], s13 offen offset:0 sc1
  v_sub_f32 v248, v22, v244
  v_sub_f32 v249, v23, v244
  v_sub_f32 v250, v24, v244
  v_sub_f32 v251, v25, v244
  v_mfma_f32_16x16x32_bf16 v[80:83], a[64:67], a[188:191], v[80:83]
  v_mfma_f32_16x16x32_bf16 v[84:87], a[64:67], a[192:195], v[84:87]
  v_mfma_f32_16x16x32_bf16 v[88:91], a[64:67], a[196:199], v[88:91]
  v_mfma_f32_16x16x32_bf16 v[92:95], a[64:67], a[200:203], v[92:95]
  buffer_load_dwordx4 a[176:179], v54, s[72:75], s13 offen offset:1024 sc1
  v_mul_f32 v248, v248, v245
  v_mul_f32 v249, v249, v245
  v_mul_f32 v250, v250, v245
  v_mfma_f32_16x16x32_bf16 v[96:99], a[68:71], a[188:191], v[96:99]
  v_mfma_f32_16x16x32_bf16 v[100:103], a[68:71], a[192:195], v[100:103]
  v_mfma_f32_16x16x32_bf16 v[104:107], a[68:71], a[196:199], v[104:107]
  v_mfma_f32_16x16x32_bf16 v[108:111], a[68:71], a[200:203], v[108:111]
  buffer_load_dwordx4 a[180:183], v54, s[72:75], s13 offen offset:2048 sc1
  v_mul_f32 v251, v251, v245
  v_mul_f32 v42, v42, v248
  v_mul_f32 v43, v43, v249
  v_mul_f32 v44, v44, v250
  v_mfma_f32_16x16x32_bf16 v[112:115], a[72:75], a[188:191], v[112:115]
  v_mfma_f32_16x16x32_bf16 v[116:119], a[72:75], a[192:195], v[116:119]
  v_mfma_f32_16x16x32_bf16 v[120:123], a[72:75], a[196:199], v[120:123]
  v_mfma_f32_16x16x32_bf16 v[124:127], a[72:75], a[200:203], v[124:127]
  buffer_load_dwordx4 a[184:187], v54, s[72:75], s13 offen offset:3072 sc1
  v_mul_f32 v45, v45, v251
  v_lshlrev_b32 v26, 16, v230
  v_and_b32 v27, 0xffff0000, v230
  v_mfma_f32_16x16x32_bf16 v[128:131], a[76:79], a[188:191], v[128:131]
  v_mfma_f32_16x16x32_bf16 v[132:135], a[76:79], a[192:195], v[132:135]
  v_mfma_f32_16x16x32_bf16 v[136:139], a[76:79], a[196:199], v[136:139]
  v_mfma_f32_16x16x32_bf16 v[140:143], a[76:79], a[200:203], v[140:143]
  v_lshlrev_b32 v28, 16, v231
  v_and_b32 v29, 0xffff0000, v231
  v_lshlrev_b32 v46, 16, v240
  s_waitcnt vmcnt(48)
  v_mfma_f32_16x16x32_bf16 v[64:67], a[80:83], a[204:207], v[64:67]
  s_waitcnt vmcnt(46)
  v_mfma_f32_16x16x32_bf16 v[68:71], a[80:83], a[208:211], v[68:71]
  s_waitcnt vmcnt(44)
  v_mfma_f32_16x16x32_bf16 v[72:75], a[80:83], a[212:215], v[72:75]
  s_waitcnt vmcnt(42)
  v_mfma_f32_16x16x32_bf16 v[76:79], a[80:83], a[216:219], v[76:79]
  v_and_b32 v47, 0xffff0000, v240
  v_lshlrev_b32 v48, 16, v241
  v_and_b32 v49, 0xffff0000, v241
  v_sub_f32 v248, v26, v244
  v_mfma_f32_16x16x32_bf16 v[80:83], a[84:87], a[204:207], v[80:83]
  v_mfma_f32_16x16x32_bf16 v[84:87], a[84:87], a[208:211], v[84:87]
  v_mfma_f32_16x16x32_bf16 v[88:91], a[84:87], a[212:215], v[88:91]
  v_mfma_f32_16x16x32_bf16 v[92:95], a[84:87], a[216:219], v[92:95]
  v_sub_f32 v249, v27, v244
  v_sub_f32 v250, v28, v244
  v_sub_f32 v251, v29, v244
  v_mfma_f32_16x16x32_bf16 v[96:99], a[88:91], a[204:207], v[96:99]
  v_mfma_f32_16x16x32_bf16 v[100:103], a[88:91], a[208:211], v[100:103]
  v_mfma_f32_16x16x32_bf16 v[104:107], a[88:91], a[212:215], v[104:107]
  v_mfma_f32_16x16x32_bf16 v[108:111], a[88:91], a[216:219], v[108:111]
  v_mul_f32 v248, v248, v245
  v_mul_f32 v249, v249, v245
  v_mul_f32 v250, v250, v245
  v_mul_f32 v251, v251, v245
  v_mfma_f32_16x16x32_bf16 v[112:115], a[92:95], a[204:207], v[112:115]
  v_mfma_f32_16x16x32_bf16 v[116:119], a[92:95], a[208:211], v[116:119]
  v_mfma_f32_16x16x32_bf16 v[120:123], a[92:95], a[212:215], v[120:123]
  v_mfma_f32_16x16x32_bf16 v[124:127], a[92:95], a[216:219], v[124:127]
  v_mul_f32 v46, v46, v248
  v_mul_f32 v47, v47, v249
  v_mul_f32 v48, v48, v250
  v_mfma_f32_16x16x32_bf16 v[128:131], a[96:99], a[204:207], v[128:131]
  v_mfma_f32_16x16x32_bf16 v[132:135], a[96:99], a[208:211], v[132:135]
  v_mfma_f32_16x16x32_bf16 v[136:139], a[96:99], a[212:215], v[136:139]
  v_mfma_f32_16x16x32_bf16 v[140:143], a[96:99], a[216:219], v[140:143]
  v_mul_f32 v49, v49, v251
  v_lshlrev_b32 v30, 16, v232
  v_and_b32 v31, 0xffff0000, v232
  s_waitcnt vmcnt(39)
  v_mfma_f32_16x16x32_bf16 v[64:67], a[100:103], a[220:223], v[64:67]
  s_waitcnt vmcnt(37)
  v_mfma_f32_16x16x32_bf16 v[68:71], a[100:103], a[224:227], v[68:71]
  s_waitcnt vmcnt(35)
  v_mfma_f32_16x16x32_bf16 v[72:75], a[100:103], a[228:231], v[72:75]
  s_waitcnt vmcnt(33)
  v_mfma_f32_16x16x32_bf16 v[76:79], a[100:103], a[232:235], v[76:79]
  v_lshlrev_b32 v32, 16, v233
  v_and_b32 v33, 0xffff0000, v233
  v_lshlrev_b32 v50, 16, v242
  v_and_b32 v51, 0xffff0000, v242
  v_mfma_f32_16x16x32_bf16 v[80:83], a[104:107], a[220:223], v[80:83]
  v_mfma_f32_16x16x32_bf16 v[84:87], a[104:107], a[224:227], v[84:87]
  v_mfma_f32_16x16x32_bf16 v[88:91], a[104:107], a[228:231], v[88:91]
  v_mfma_f32_16x16x32_bf16 v[92:95], a[104:107], a[232:235], v[92:95]
  v_lshlrev_b32 v52, 16, v243
  v_and_b32 v53, 0xffff0000, v243
  v_sub_f32 v248, v30, v244
  v_sub_f32 v249, v31, v244
  v_mfma_f32_16x16x32_bf16 v[96:99], a[108:111], a[220:223], v[96:99]
  v_mfma_f32_16x16x32_bf16 v[100:103], a[108:111], a[224:227], v[100:103]
  v_mfma_f32_16x16x32_bf16 v[104:107], a[108:111], a[228:231], v[104:107]
  v_mfma_f32_16x16x32_bf16 v[108:111], a[108:111], a[232:235], v[108:111]
  v_sub_f32 v250, v32, v244
  v_sub_f32 v251, v33, v244
  v_mul_f32 v248, v248, v245
  v_mfma_f32_16x16x32_bf16 v[112:115], a[112:115], a[220:223], v[112:115]
  v_mfma_f32_16x16x32_bf16 v[116:119], a[112:115], a[224:227], v[116:119]
  v_mfma_f32_16x16x32_bf16 v[120:123], a[112:115], a[228:231], v[120:123]
  v_mfma_f32_16x16x32_bf16 v[124:127], a[112:115], a[232:235], v[124:127]
  v_mul_f32 v249, v249, v245
  v_mul_f32 v250, v250, v245
  v_mul_f32 v251, v251, v245
  v_mul_f32 v50, v50, v248
  v_mfma_f32_16x16x32_bf16 v[128:131], a[116:119], a[220:223], v[128:131]
  v_mfma_f32_16x16x32_bf16 v[132:135], a[116:119], a[224:227], v[132:135]
  v_mfma_f32_16x16x32_bf16 v[136:139], a[116:119], a[228:231], v[136:139]
  v_mfma_f32_16x16x32_bf16 v[140:143], a[116:119], a[232:235], v[140:143]
  v_mul_f32 v51, v51, v249
  v_mul_f32 v52, v52, v250
  v_mul_f32 v53, v53, v251
  s_waitcnt vmcnt(30)
  v_mfma_f32_16x16x32_bf16 v[144:147], a[120:123], a[236:239], 0
  s_waitcnt vmcnt(28)
  v_mfma_f32_16x16x32_bf16 v[148:151], a[120:123], a[240:243], 0
  s_waitcnt vmcnt(26)
  v_mfma_f32_16x16x32_bf16 v[152:155], a[120:123], a[244:247], 0
  s_waitcnt vmcnt(24)
  v_mfma_f32_16x16x32_bf16 v[156:159], a[120:123], a[248:251], 0
  v_mfma_f32_16x16x32_bf16 v[160:163], a[124:127], a[236:239], 0
  v_mfma_f32_16x16x32_bf16 v[164:167], a[124:127], a[240:243], 0
  v_mfma_f32_16x16x32_bf16 v[168:171], a[124:127], a[244:247], 0
  v_mfma_f32_16x16x32_bf16 v[172:175], a[124:127], a[248:251], 0
  v_mfma_f32_16x16x32_bf16 v[176:179], a[128:131], a[236:239], 0
  v_mfma_f32_16x16x32_bf16 v[180:183], a[128:131], a[240:243], 0
  v_mfma_f32_16x16x32_bf16 v[184:187], a[128:131], a[244:247], 0
  v_mfma_f32_16x16x32_bf16 v[188:191], a[128:131], a[248:251], 0
  v_mfma_f32_16x16x32_bf16 v[192:195], a[132:135], a[236:239], 0
  v_mfma_f32_16x16x32_bf16 v[196:199], a[132:135], a[240:243], 0
  v_mfma_f32_16x16x32_bf16 v[200:203], a[132:135], a[244:247], 0
  v_mfma_f32_16x16x32_bf16 v[204:207], a[132:135], a[248:251], 0
  v_mfma_f32_16x16x32_bf16 v[208:211], a[136:139], a[236:239], 0
  v_mfma_f32_16x16x32_bf16 v[212:215], a[136:139], a[240:243], 0
  v_mfma_f32_16x16x32_bf16 v[216:219], a[136:139], a[244:247], 0
  v_mfma_f32_16x16x32_bf16 v[220:223], a[136:139], a[248:251], 0
  s_waitcnt vmcnt(21)
  v_mfma_f32_16x16x32_bf16 v[144:147], a[0:3], a[140:143], v[144:147]
  s_waitcnt vmcnt(19)
  v_mfma_f32_16x16x32_bf16 v[148:151], a[0:3], a[144:147], v[148:151]
  s_waitcnt vmcnt(17)
  v_mfma_f32_16x16x32_bf16 v[152:155], a[0:3], a[148:151], v[152:155]
  s_waitcnt vmcnt(15)
  v_mfma_f32_16x16x32_bf16 v[156:159], a[0:3], a[152:155], v[156:159]
  v_mfma_f32_16x16x32_bf16 v[160:163], a[4:7], a[140:143], v[160:163]
  v_mfma_f32_16x16x32_bf16 v[164:167], a[4:7], a[144:147], v[164:167]
  v_mfma_f32_16x16x32_bf16 v[168:171], a[4:7], a[148:151], v[168:171]
  v_mfma_f32_16x16x32_bf16 v[172:175], a[4:7], a[152:155], v[172:175]
  v_mfma_f32_16x16x32_bf16 v[176:179], a[8:11], a[140:143], v[176:179]
  v_mfma_f32_16x16x32_bf16 v[180:183], a[8:11], a[144:147], v[180:183]
  v_mfma_f32_16x16x32_bf16 v[184:187], a[8:11], a[148:151], v[184:187]
  v_mfma_f32_16x16x32_bf16 v[188:191], a[8:11], a[152:155], v[188:191]
  v_mfma_f32_16x16x32_bf16 v[192:195], a[12:15], a[140:143], v[192:195]
  v_mfma_f32_16x16x32_bf16 v[196:199], a[12:15], a[144:147], v[196:199]
  v_mfma_f32_16x16x32_bf16 v[200:203], a[12:15], a[148:151], v[200:203]
  v_mfma_f32_16x16x32_bf16 v[204:207], a[12:15], a[152:155], v[204:207]
  v_mfma_f32_16x16x32_bf16 v[208:211], a[16:19], a[140:143], v[208:211]
  v_mfma_f32_16x16x32_bf16 v[212:215], a[16:19], a[144:147], v[212:215]
  v_mfma_f32_16x16x32_bf16 v[216:219], a[16:19], a[148:151], v[216:219]
  v_mfma_f32_16x16x32_bf16 v[220:223], a[16:19], a[152:155], v[220:223]
  s_waitcnt vmcnt(12)
  v_mfma_f32_16x16x32_bf16 v[144:147], a[20:23], a[156:159], v[144:147]
  s_waitcnt vmcnt(10)
  v_mfma_f32_16x16x32_bf16 v[148:151], a[20:23], a[160:163], v[148:151]
  s_waitcnt vmcnt(8)
  v_mfma_f32_16x16x32_bf16 v[152:155], a[20:23], a[164:167], v[152:155]
  s_waitcnt vmcnt(6)
  v_mfma_f32_16x16x32_bf16 v[156:159], a[20:23], a[168:171], v[156:159]
  v_mfma_f32_16x16x32_bf16 v[160:163], a[24:27], a[156:159], v[160:163]
  v_mfma_f32_16x16x32_bf16 v[164:167], a[24:27], a[160:163], v[164:167]
  v_mfma_f32_16x16x32_bf16 v[168:171], a[24:27], a[164:167], v[168:171]
  v_mfma_f32_16x16x32_bf16 v[172:175], a[24:27], a[168:171], v[172:175]
  v_mfma_f32_16x16x32_bf16 v[176:179], a[28:31], a[156:159], v[176:179]
  v_mfma_f32_16x16x32_bf16 v[180:183], a[28:31], a[160:163], v[180:183]
  v_mfma_f32_16x16x32_bf16 v[184:187], a[28:31], a[164:167], v[184:187]
  v_mfma_f32_16x16x32_bf16 v[188:191], a[28:31], a[168:171], v[188:191]
  v_mfma_f32_16x16x32_bf16 v[192:195], a[32:35], a[156:159], v[192:195]
  v_mfma_f32_16x16x32_bf16 v[196:199], a[32:35], a[160:163], v[196:199]
  v_mfma_f32_16x16x32_bf16 v[200:203], a[32:35], a[164:167], v[200:203]
  v_mfma_f32_16x16x32_bf16 v[204:207], a[32:35], a[168:171], v[204:207]
  v_mfma_f32_16x16x32_bf16 v[208:211], a[36:39], a[156:159], v[208:211]
  v_mfma_f32_16x16x32_bf16 v[212:215], a[36:39], a[160:163], v[212:215]
  v_mfma_f32_16x16x32_bf16 v[216:219], a[36:39], a[164:167], v[216:219]
  v_mfma_f32_16x16x32_bf16 v[220:223], a[36:39], a[168:171], v[220:223]
  s_waitcnt vmcnt(3)
  v_mfma_f32_16x16x32_bf16 v[144:147], a[40:43], a[172:175], v[144:147]
  s_waitcnt vmcnt(2)
  v_mfma_f32_16x16x32_bf16 v[148:151], a[40:43], a[176:179], v[148:151]
  s_waitcnt vmcnt(1)
  v_mfma_f32_16x16x32_bf16 v[152:155], a[40:43], a[180:183], v[152:155]
  s_waitcnt vmcnt(0)
  v_mfma_f32_16x16x32_bf16 v[156:159], a[40:43], a[184:187], v[156:159]
  v_mfma_f32_16x16x32_bf16 v[160:163], a[44:47], a[172:175], v[160:163]
  v_mfma_f32_16x16x32_bf16 v[164:167], a[44:47], a[176:179], v[164:167]
  v_mfma_f32_16x16x32_bf16 v[168:171], a[44:47], a[180:183], v[168:171]
  v_mfma_f32_16x16x32_bf16 v[172:175], a[44:47], a[184:187], v[172:175]
  v_mfma_f32_16x16x32_bf16 v[176:179], a[48:51], a[172:175], v[176:179]
  v_mfma_f32_16x16x32_bf16 v[180:183], a[48:51], a[176:179], v[180:183]
  v_mfma_f32_16x16x32_bf16 v[184:187], a[48:51], a[180:183], v[184:187]
  v_mfma_f32_16x16x32_bf16 v[188:191], a[48:51], a[184:187], v[188:191]
  v_mfma_f32_16x16x32_bf16 v[192:195], a[52:55], a[172:175], v[192:195]
  v_mfma_f32_16x16x32_bf16 v[196:199], a[52:55], a[176:179], v[196:199]
  v_mfma_f32_16x16x32_bf16 v[200:203], a[52:55], a[180:183], v[200:203]
  v_mfma_f32_16x16x32_bf16 v[204:207], a[52:55], a[184:187], v[204:207]
  v_mfma_f32_16x16x32_bf16 v[208:211], a[56:59], a[172:175], v[208:211]
  v_mfma_f32_16x16x32_bf16 v[212:215], a[56:59], a[176:179], v[212:215]
  v_mfma_f32_16x16x32_bf16 v[216:219], a[56:59], a[180:183], v[216:219]
  v_mfma_f32_16x16x32_bf16 v[220:223], a[56:59], a[184:187], v[220:223]
  s_waitcnt vmcnt(0)
  s_mul_i32 s8, s3, 20480
  s_add_u32 s8, s8, 81920
  v_add_u32 v12, s8, v13
  ds_write_b128 v12, v[64:67] offset:0
  ds_write_b128 v12, v[80:83] offset:1024
  ds_write_b128 v12, v[96:99] offset:2048
  ds_write_b128 v12, v[112:115] offset:3072
  ds_write_b128 v12, v[128:131] offset:4096
  ds_write_b128 v12, v[68:71] offset:5120
  ds_write_b128 v12, v[84:87] offset:6144
  ds_write_b128 v12, v[100:103] offset:7168
  ds_write_b128 v12, v[116:119] offset:8192
  ds_write_b128 v12, v[132:135] offset:9216
  ds_write_b128 v12, v[72:75] offset:10240
  ds_write_b128 v12, v[88:91] offset:11264
  ds_write_b128 v12, v[104:107] offset:12288
  ds_write_b128 v12, v[120:123] offset:13312
  ds_write_b128 v12, v[136:139] offset:14336
  ds_write_b128 v12, v[76:79] offset:15360
  ds_write_b128 v12, v[92:95] offset:16384
  ds_write_b128 v12, v[108:111] offset:17408
  ds_write_b128 v12, v[124:127] offset:18432
  ds_write_b128 v12, v[140:143] offset:19456
  s_branch L_P2_done
L_P2_D:
  s_waitcnt vmcnt(23)
  v_mfma_f32_16x16x32_bf16 v[144:147], a[0:3], a[140:143], 0
  s_waitcnt vmcnt(22)
  v_mfma_f32_16x16x32_bf16 v[148:151], a[0:3], a[144:147], 0
  s_waitcnt vmcnt(21)
  v_mfma_f32_16x16x32_bf16 v[152:155], a[0:3], a[148:151], 0
  s_waitcnt vmcnt(20)
  v_mfma_f32_16x16x32_bf16 v[156:159], a[0:3], a[152:155], 0
  s_add_u32 s13, s81, 786432
  buffer_load_dwordx4 a[236:239], v54, s[72:75], s13 offen offset:0 sc1
  v_mfma_f32_16x16x32_bf16 v[160:163], a[4:7], a[140:143], 0
  v_mfma_f32_16x16x32_bf16 v[164:167], a[4:7], a[144:147], 0
  s_add_u32 s7, s80, 286720
  buffer_load_dwordx4 a[0:3], v54, s[76:79], s7 offen offset:0 sc1
  v_mfma_f32_16x16x32_bf16 v[168:171], a[4:7], a[148:151], 0
  v_mfma_f32_16x16x32_bf16 v[172:175], a[4:7], a[152:155], 0
  buffer_load_dwordx4 a[240:243], v54, s[72:75], s13 offen offset:1024 sc1
  v_mfma_f32_16x16x32_bf16 v[176:179], a[8:11], a[140:143], 0
  v_mfma_f32_16x16x32_bf16 v[180:183], a[8:11], a[144:147], 0
  buffer_load_dwordx4 a[4:7], v54, s[76:79], s7 offen offset:1024 sc1
  v_mfma_f32_16x16x32_bf16 v[184:187], a[8:11], a[148:151], 0
  v_mfma_f32_16x16x32_bf16 v[188:191], a[8:11], a[152:155], 0
  buffer_load_dwordx4 a[244:247], v54, s[72:75], s13 offen offset:2048 sc1
  v_mfma_f32_16x16x32_bf16 v[192:195], a[12:15], a[140:143], 0
  v_mfma_f32_16x16x32_bf16 v[196:199], a[12:15], a[144:147], 0
  buffer_load_dwordx4 a[8:11], v54, s[76:79], s7 offen offset:2048 sc1
  v_mfma_f32_16x16x32_bf16 v[200:203], a[12:15], a[148:151], 0
  v_mfma_f32_16x16x32_bf16 v[204:207], a[12:15], a[152:155], 0
  buffer_load_dwordx4 a[248:251], v54, s[72:75], s13 offen offset:3072 sc1
  v_mfma_f32_16x16x32_bf16 v[208:211], a[16:19], a[140:143], 0
  v_mfma_f32_16x16x32_bf16 v[212:215], a[16:19], a[144:147], 0
  buffer_load_dwordx4 a[12:15], v54, s[76:79], s7 offen offset:3072 sc1
  v_mfma_f32_16x16x32_bf16 v[216:219], a[16:19], a[148:151], 0
  v_mfma_f32_16x16x32_bf16 v[220:223], a[16:19], a[152:155], 0
  s_waitcnt vmcnt(27)
  v_mfma_f32_16x16x32_bf16 v[144:147], a[20:23], a[156:159], v[144:147]
  s_waitcnt vmcnt(26)
  v_mfma_f32_16x16x32_bf16 v[148:151], a[20:23], a[160:163], v[148:151]
  buffer_load_dwordx4 a[16:19], v56, s[76:79], s7 offen sc1
  s_waitcnt vmcnt(26)
  v_mfma_f32_16x16x32_bf16 v[152:155], a[20:23], a[164:167], v[152:155]
  s_waitcnt vmcnt(25)
  v_mfma_f32_16x16x32_bf16 v[156:159], a[20:23], a[168:171], v[156:159]
  s_add_u32 s13, s81, 917504
  buffer_load_dwordx4 a[140:143], v54, s[72:75], s13 offen offset:0 sc1
  buffer_load_dwordx2 v[224:225], v5, s[60:63], s88 offen offset:0
  buffer_load_dwordx2 v[234:235], v6, s[64:67], s87 offen offset:0
  buffer_load_dwordx2 v[226:227], v5, s[60:63], s88 offen offset:32
  v_mfma_f32_16x16x32_bf16 v[160:163], a[24:27], a[156:159], v[160:163]
  v_mfma_f32_16x16x32_bf16 v[164:167], a[24:27], a[160:163], v[164:167]
  s_add_u32 s7, s80, 327680
  buffer_load_dwordx4 a[20:23], v54, s[76:79], s7 offen offset:0 sc1
  v_mfma_f32_16x16x32_bf16 v[168:171], a[24:27], a[164:167], v[168:171]
  v_mfma_f32_16x16x32_bf16 v[172:175], a[24:27], a[168:171], v[172:175]
  buffer_load_dwordx4 a[144:147], v54, s[72:75], s13 offen offset:1024 sc1
  buffer_load_dwordx2 v[236:237], v6, s[64:67], s87 offen offset:32
  buffer_load_dwordx2 v[228:229], v5, s[60:63], s88 offen offset:64
  v_mfma_f32_16x16x32_bf16 v[176:179], a[28:31], a[156:159], v[176:179]
  v_mfma_f32_16x16x32_bf16 v[180:183], a[28:31], a[160:163], v[180:183]
  buffer_load_dwordx4 a[24:27], v54, s[76:79], s7 offen offset:1024 sc1
  v_mfma_f32_16x16x32_bf16 v[184:187], a[28:31], a[164:167], v[184:187]
  v_mfma_f32_16x16x32_bf16 v[188:191], a[28:31], a[168:171], v[188:191]
  buffer_load_dwordx4 a[148:151], v54, s[72:75], s13 offen offset:2048 sc1
  buffer_load_dwordx2 v[238:239], v6, s[64:67], s87 offen offset:64
  buffer_load_dwordx2 v[230:231], v5, s[60:63], s88 offen offset:96
  v_mfma_f32_16x16x32_bf16 v[192:195], a[32:35], a[156:159], v[192:195]
  v_mfma_f32_16x16x32_bf16 v[196:199], a[32:35], a[160:163], v[196:199]
  buffer_load_dwordx4 a[28:31], v54, s[76:79], s7 offen offset:2048 sc1
  v_mfma_f32_16x16x32_bf16 v[200:203], a[32:35], a[164:167], v[200:203]
  v_mfma_f32_16x16x32_bf16 v[204:207], a[32:35], a[168:171], v[204:207]
  buffer_load_dwordx4 a[152:155], v54, s[72:75], s13 offen offset:3072 sc1
  buffer_load_dwordx2 v[240:241], v6, s[64:67], s87 offen offset:96
  buffer_load_dwordx2 v[232:233], v5, s[60:63], s88 offen offset:128
  v_mfma_f32_16x16x32_bf16 v[208:211], a[36:39], a[156:159], v[208:211]
  v_mfma_f32_16x16x32_bf16 v[212:215], a[36:39], a[160:163], v[212:215]
  buffer_load_dwordx4 a[32:35], v54, s[76:79], s7 offen offset:3072 sc1
  v_mfma_f32_16x16x32_bf16 v[216:219], a[36:39], a[164:167], v[216:219]
  v_mfma_f32_16x16x32_bf16 v[220:223], a[36:39], a[168:171], v[220:223]
  buffer_load_dwordx2 v[242:243], v6, s[64:67], s87 offen offset:128
  s_lshl_b32 s8, s86, 3
  s_add_u32 s8, s8, 0x1000000
  buffer_load_dword v246, v7, s[56:59], s8 offen sc1
  s_waitcnt vmcnt(43)
  v_mfma_f32_16x16x32_bf16 v[144:147], a[40:43], a[172:175], v[144:147]
  s_waitcnt vmcnt(42)
  v_mfma_f32_16x16x32_bf16 v[148:151], a[40:43], a[176:179], v[148:151]
  buffer_load_dwordx4 a[36:39], v56, s[76:79], s7 offen sc1
  s_waitcnt vmcnt(42)
  v_mfma_f32_16x16x32_bf16 v[152:155], a[40:43], a[180:183], v[152:155]
  s_waitcnt vmcnt(41)
  v_mfma_f32_16x16x32_bf16 v[156:159], a[40:43], a[184:187], v[156:159]
  s_add_u32 s13, s81, 1048576
  buffer_load_dwordx4 a[156:159], v54, s[72:75], s13 offen offset:0 sc1
  v_mfma_f32_16x16x32_bf16 v[160:163], a[44:47], a[172:175], v[160:163]
  v_mfma_f32_16x16x32_bf16 v[164:167], a[44:47], a[176:179], v[164:167]
  s_add_u32 s7, s80, 368640
  buffer_load_dwordx4 a[40:43], v54, s[76:79], s7 offen offset:0 sc1
  v_mfma_f32_16x16x32_bf16 v[168:171], a[44:47], a[180:183], v[168:171]
  v_mfma_f32_16x16x32_bf16 v[172:175], a[44:47], a[184:187], v[172:175]
  buffer_load_dwordx4 a[160:163], v54, s[72:75], s13 offen offset:1024 sc1
  v_mfma_f32_16x16x32_bf16 v[176:179], a[48:51], a[172:175], v[176:179]
  v_mfma_f32_16x16x32_bf16 v[180:183], a[48:51], a[176:179], v[180:183]
  buffer_load_dwordx4 a[44:47], v54, s[76:79], s7 offen offset:1024 sc1
  v_mfma_f32_16x16x32_bf16 v[184:187], a[48:51], a[180:183], v[184:187]
  v_mfma_f32_16x16x32_bf16 v[188:191], a[48:51], a[184:187], v[188:191]
  buffer_load_dwordx4 a[164:167], v54, s[72:75], s13 offen offset:2048 sc1
  v_mfma_f32_16x16x32_bf16 v[192:195], a[52:55], a[172:175], v[192:195]
  v_mfma_f32_16x16x32_bf16 v[196:199], a[52:55], a[176:179], v[196:199]
  buffer_load_dwordx4 a[48:51], v54, s[76:79], s7 offen offset:2048 sc1
  v_mfma_f32_16x16x32_bf16 v[200:203], a[52:55], a[180:183], v[200:203]
  v_mfma_f32_16x16x32_bf16 v[204:207], a[52:55], a[184:187], v[204:207]
  buffer_load_dwordx4 a[168:171], v54, s[72:75], s13 offen offset:3072 sc1
  v_mfma_f32_16x16x32_bf16 v[208:211], a[56:59], a[172:175], v[208:211]
  v_mfma_f32_16x16x32_bf16 v[212:215], a[56:59], a[176:179], v[212:215]
  buffer_load_dwordx4 a[52:55], v54, s[76:79], s7 offen offset:3072 sc1
  v_mfma_f32_16x16x32_bf16 v[216:219], a[56:59], a[180:183], v[216:219]
  v_mfma_f32_16x16x32_bf16 v[220:223], a[56:59], a[184:187], v[220:223]
  s_waitcnt vmcnt(48)
  v_mfma_f32_16x16x32_bf16 v[144:147], a[60:63], a[188:191], v[144:147]
  s_waitcnt vmcnt(47)
  v_mfma_f32_16x16x32_bf16 v[148:151], a[60:63], a[192:195], v[148:151]
  buffer_load_dwordx4 a[56:59], v56, s[76:79], s7 offen sc1
  s_waitcnt vmcnt(47)
  v_mfma_f32_16x16x32_bf16 v[152:155], a[60:63], a[196:199], v[152:155]
  s_waitcnt vmcnt(46)
  v_mfma_f32_16x16x32_bf16 v[156:159], a[60:63], a[200:203], v[156:159]
  s_add_u32 s13, s81, 1179648
  buffer_load_dwordx4 a[172:175], v54, s[72:75], s13 offen offset:0 sc1
  v_mfma_f32_16x16x32_bf16 v[160:163], a[64:67], a[188:191], v[160:163]
  v_mfma_f32_16x16x32_bf16 v[164:167], a[64:67], a[192:195], v[164:167]
  s_add_u32 s7, s80, 409600
  buffer_load_dwordx4 a[60:63], v54, s[76:79], s7 offen offset:0 sc1
  v_mfma_f32_16x16x32_bf16 v[168:171], a[64:67], a[196:199], v[168:171]
  v_mfma_f32_16x16x32_bf16 v[172:175], a[64:67], a[200:203], v[172:175]
  buffer_load_dwordx4 a[176:179], v54, s[72:75], s13 offen offset:1024 sc1
  v_mfma_f32_16x16x32_bf16 v[176:179], a[68:71], a[188:191], v[176:179]
  v_mfma_f32_16x16x32_bf16 v[180:183], a[68:71], a[192:195], v[180:183]
  buffer_load_dwordx4 a[64:67], v54, s[76:79], s7 offen offset:1024 sc1
  v_mfma_f32_16x16x32_bf16 v[184:187], a[68:71], a[196:199], v[184:187]
  v_mfma_f32_16x16x32_bf16 v[188:191], a[68:71], a[200:203], v[188:191]
  buffer_load_dwordx4 a[180:183], v54, s[72:75], s13 offen offset:2048 sc1
  v_mfma_f32_16x16x32_bf16 v[192:195], a[72:75], a[188:191], v[192:195]
  v_mfma_f32_16x16x32_bf16 v[196:199], a[72:75], a[192:195], v[196:199]
  buffer_load_dwordx4 a[68:71], v54, s[76:79], s7 offen offset:2048 sc1
  v_mfma_f32_16x16x32_bf16 v[200:203], a[72:75], a[196:199], v[200:203]
  v_mfma_f32_16x16x32_bf16 v[204:207], a[72:75], a[200:203], v[204:207]
  buffer_load_dwordx4 a[184:187], v54, s[72:75], s13 offen offset:3072 sc1
  v_mfma_f32_16x16x32_bf16 v[208:211], a[76:79], a[188:191], v[208:211]
  v_mfma_f32_16x16x32_bf16 v[212:215], a[76:79], a[192:195], v[212:215]
  buffer_load_dwordx4 a[72:75], v54, s[76:79], s7 offen offset:3072 sc1
  v_mfma_f32_16x16x32_bf16 v[216:219], a[76:79], a[196:199], v[216:219]
  v_mfma_f32_16x16x32_bf16 v[220:223], a[76:79], a[200:203], v[220:223]
  s_waitcnt vmcnt(53)
  v_mfma_f32_16x16x32_bf16 v[144:147], a[80:83], a[204:207], v[144:147]
  s_waitcnt vmcnt(52)
  v_mfma_f32_16x16x32_bf16 v[148:151], a[80:83], a[208:211], v[148:151]
  buffer_load_dwordx4 a[76:79], v56, s[76:79], s7 offen sc1
  s_waitcnt vmcnt(52)
  v_mfma_f32_16x16x32_bf16 v[152:155], a[80:83], a[212:215], v[152:155]
  s_waitcnt vmcnt(51)
  v_mfma_f32_16x16x32_bf16 v[156:159], a[80:83], a[216:219], v[156:159]
  s_add_u32 s13, s81, 1310720
  buffer_load_dwordx4 a[188:191], v54, s[72:75], s13 offen offset:0 sc1
  v_mfma_f32_16x16x32_bf16 v[160:163], a[84:87], a[204:207], v[160:163]
  v_mfma_f32_16x16x32_bf16 v[164:167], a[84:87], a[208:211], v[164:167]
  s_add_u32 s7, s80, 450560
  buffer_load_dwordx4 a[80:83], v54, s[76:79], s7 offen offset:0 sc1
  v_mfma_f32_16x16x32_bf16 v[168:171], a[84:87], a[212:215], v[168:171]
  v_mfma_f32_16x16x32_bf16 v[172:175], a[84:87], a[216:219], v[172:175]
  buffer_load_dwordx4 a[192:195], v54, s[72:75], s13 offen offset:1024 sc1
  v_mfma_f32_16x16x32_bf16 v[176:179], a[88:91], a[204:207], v[176:179]
  v_mfma_f32_16x16x32_bf16 v[180:183], a[88:91], a[208:211], v[180:183]
  buffer_load_dwordx4 a[84:87], v54, s[76:79], s7 offen offset:1024 sc1
  v_mfma_f32_16x16x32_bf16 v[184:187], a[88:91], a[212:215], v[184:187]
  v_mfma_f32_16x16x32_bf16 v[188:191], a[88:91], a[216:219], v[188:191]
  buffer_load_dwordx4 a[196:199], v54, s[72:75], s13 offen offset:2048 sc1
  v_mfma_f32_16x16x32_bf16 v[192:195], a[92:95], a[204:207], v[192:195]
  v_mfma_f32_16x16x32_bf16 v[196:199], a[92:95], a[208:211], v[196:199]
  buffer_load_dwordx4 a[88:91], v54, s[76:79], s7 offen offset:2048 sc1
  v_mfma_f32_16x16x32_bf16 v[200:203], a[92:95], a[212:215], v[200:203]
  v_mfma_f32_16x16x32_bf16 v[204:207], a[92:95], a[216:219], v[204:207]
  buffer_load_dwordx4 a[200:203], v54, s[72:75], s13 offen offset:3072 sc1
  v_mfma_f32_16x16x32_bf16 v[208:211], a[96:99], a[204:207], v[208:211]
  v_mfma_f32_16x16x32_bf16 v[212:215], a[96:99], a[208:211], v[212:215]
  buffer_load_dwordx4 a[92:95], v54, s[76:79], s7 offen offset:3072 sc1
  v_mfma_f32_16x16x32_bf16 v[216:219], a[96:99], a[212:215], v[216:219]
  v_mfma_f32_16x16x32_bf16 v[220:223], a[96:99], a[216:219], v[220:223]
  s_waitcnt vmcnt(58)
  v_mfma_f32_16x16x32_bf16 v[144:147], a[100:103], a[220:223], v[144:147]
  s_waitcnt vmcnt(57)
  v_mfma_f32_16x16x32_bf16 v[148:151], a[100:103], a[224:227], v[148:151]
  buffer_load_dwordx4 a[96:99], v56, s[76:79], s7 offen sc1
  s_waitcnt vmcnt(57)
  v_mfma_f32_16x16x32_bf16 v[152:155], a[100:103], a[228:231], v[152:155]
  s_waitcnt vmcnt(56)
  v_mfma_f32_16x16x32_bf16 v[156:159], a[100:103], a[232:235], v[156:159]
  s_add_u32 s13, s81, 1441792
  buffer_load_dwordx4 a[204:207], v54, s[72:75], s13 offen offset:0 sc1
  v_mfma_f32_16x16x32_bf16 v[160:163], a[104:107], a[220:223], v[160:163]
  v_mfma_f32_16x16x32_bf16 v[164:167], a[104:107], a[224:227], v[164:167]
  s_add_u32 s7, s80, 491520
  buffer_load_dwordx4 a[100:103], v54, s[76:79], s7 offen offset:0 sc1
  v_mfma_f32_16x16x32_bf16 v[168:171], a[104:107], a[228:231], v[168:171]
  v_mfma_f32_16x16x32_bf16 v[172:175], a[104:107], a[232:235], v[172:175]
  buffer_load_dwordx4 a[208:211], v54, s[72:75], s13 offen offset:1024 sc1
  v_mfma_f32_16x16x32_bf16 v[176:179], a[108:111], a[220:223], v[176:179]
  v_mfma_f32_16x16x32_bf16 v[180:183], a[108:111], a[224:227], v[180:183]
  buffer_load_dwordx4 a[104:107], v54, s[76:79], s7 offen offset:1024 sc1
  v_mfma_f32_16x16x32_bf16 v[184:187], a[108:111], a[228:231], v[184:187]
  v_mfma_f32_16x16x32_bf16 v[188:191], a[108:111], a[232:235], v[188:191]
  buffer_load_dwordx4 a[212:215], v54, s[72:75], s13 offen offset:2048 sc1
  v_mfma_f32_16x16x32_bf16 v[192:195], a[112:115], a[220:223], v[192:195]
  v_mfma_f32_16x16x32_bf16 v[196:199], a[112:115], a[224:227], v[196:199]
  buffer_load_dwordx4 a[108:111], v54, s[76:79], s7 offen offset:2048 sc1
  v_mfma_f32_16x16x32_bf16 v[200:203], a[112:115], a[228:231], v[200:203]
  v_mfma_f32_16x16x32_bf16 v[204:207], a[112:115], a[232:235], v[204:207]
  buffer_load_dwordx4 a[216:219], v54, s[72:75], s13 offen offset:3072 sc1
  v_mfma_f32_16x16x32_bf16 v[208:211], a[116:119], a[220:223], v[208:211]
  v_mfma_f32_16x16x32_bf16 v[212:215], a[116:119], a[224:227], v[212:215]
  buffer_load_dwordx4 a[112:115], v54, s[76:79], s7 offen offset:3072 sc1
  v_mfma_f32_16x16x32_bf16 v[216:219], a[116:119], a[228:231], v[216:219]
  v_mfma_f32_16x16x32_bf16 v[220:223], a[116:119], a[232:235], v[220:223]
  s_waitcnt vmcnt(63)
  v_mfma_f32_16x16x32_bf16 v[144:147], a[120:123], a[236:239], v[144:147]
  s_waitcnt vmcnt(61)
  v_mfma_f32_16x16x32_bf16 v[148:151], a[120:123], a[240:243], v[148:151]
  buffer_load_dwordx4 a[116:119], v56, s[76:79], s7 offen sc1
  s_waitcnt vmcnt(60)
  v_mfma_f32_16x16x32_bf16 v[152:155], a[120:123], a[244:247], v[152:155]
  s_waitcnt vmcnt(58)
  v_mfma_f32_16x16x32_bf16 v[156:159], a[120:123], a[248:251], v[156:159]
  s_add_u32 s13, s81, 1572864
  buffer_load_dwordx4 a[220:223], v54, s[72:75], s13 offen offset:0 sc1
  v_mfma_f32_16x16x32_bf16 v[160:163], a[124:127], a[236:239], v[160:163]
  v_mfma_f32_16x16x32_bf16 v[164:167], a[124:127], a[240:243], v[164:167]
  s_add_u32 s7, s80, 532480
  buffer_load_dwordx4 a[120:123], v54, s[76:79], s7 offen offset:0 sc1
  v_mfma_f32_16x16x32_bf16 v[168:171], a[124:127], a[244:247], v[168:171]
  v_mfma_f32_16x16x32_bf16 v[172:175], a[124:127], a[248:251], v[172:175]
  buffer_load_dwordx4 a[224:227], v54, s[72:75], s13 offen offset:1024 sc1
  v_mfma_f32_16x16x32_bf16 v[176:179], a[128:131], a[236:239], v[176:179]
  v_mfma_f32_16x16x32_bf16 v[180:183], a[128:131], a[240:243], v[180:183]
  buffer_load_dwordx4 a[124:127], v54, s[76:79], s7 offen offset:1024 sc1
  v_mfma_f32_16x16x32_bf16 v[184:187], a[128:131], a[244:247], v[184:187]
  v_mfma_f32_16x16x32_bf16 v[188:191], a[128:131], a[248:251], v[188:191]
  buffer_load_dwordx4 a[228:231], v54, s[72:75], s13 offen offset:2048 sc1
  v_mfma_f32_16x16x32_bf16 v[192:195], a[132:135], a[236:239], v[192:195]
  v_mfma_f32_16x16x32_bf16 v[196:199], a[132:135], a[240:243], v[196:199]
  buffer_load_dwordx4 a[128:131], v54, s[76:79], s7 offen offset:2048 sc1
  v_mfma_f32_16x16x32_bf16 v[200:203], a[132:135], a[244:247], v[200:203]
  v_mfma_f32_16x16x32_bf16 v[204:207], a[132:135], a[248:251], v[204:207]
  buffer_load_dwordx4 a[232:235], v54, s[72:75], s13 offen offset:3072 sc1
  v_mfma_f32_16x16x32_bf16 v[208:211], a[136:139], a[236:239], v[208:211]
  v_mfma_f32_16x16x32_bf16 v[212:215], a[136:139], a[240:243], v[212:215]
  buffer_load_dwordx4 a[132:135], v54, s[76:79], s7 offen offset:3072 sc1
  v_mfma_f32_16x16x32_bf16 v[216:219], a[136:139], a[244:247], v[216:219]
  v_mfma_f32_16x16x32_bf16 v[220:223], a[136:139], a[248:251], v[220:223]
  s_waitcnt vmcnt(63)
  v_mfma_f32_16x16x32_bf16 v[144:147], a[0:3], a[140:143], v[144:147]
  s_waitcnt vmcnt(58)
  v_mfma_f32_16x16x32_bf16 v[148:151], a[0:3], a[144:147], v[148:151]
  buffer_load_dwordx4 a[136:139], v56, s[76:79], s7 offen sc1
  s_waitcnt vmcnt(55)
  v_mfma_f32_16x16x32_bf16 v[152:155], a[0:3], a[148:151], v[152:155]
  s_waitcnt vmcnt(51)
  v_mfma_f32_16x16x32_bf16 v[156:159], a[0:3], a[152:155], v[156:159]
  s_add_u32 s13, s81, 1703936
  buffer_load_dwordx4 a[236:239], v54, s[72:75], s13 offen offset:0 sc1
  buffer_load_dword v9, v4, s[56:59], s89 offen sc1
  v_mfma_f32_16x16x32_bf16 v[160:163], a[4:7], a[140:143], v[160:163]
  v_mfma_f32_16x16x32_bf16 v[164:167], a[4:7], a[144:147], v[164:167]
  s_add_u32 s7, s80, 573440
  buffer_load_dwordx4 a[0:3], v54, s[76:79], s7 offen offset:0 sc1
  v_mfma_f32_16x16x32_bf16 v[168:171], a[4:7], a[148:151], v[168:171]
  v_mfma_f32_16x16x32_bf16 v[172:175], a[4:7], a[152:155], v[172:175]
  buffer_load_dwordx4 a[240:243], v54, s[72:75], s13 offen offset:1024 sc1
  v_mfma_f32_16x16x32_bf16 v[176:179], a[8:11], a[140:143], v[176:179]
  v_mfma_f32_16x16x32_bf16 v[180:183], a[8:11], a[144:147], v[180:183]
  buffer_load_dwordx4 a[4:7], v54, s[76:79], s7 offen offset:1024 sc1
  v_mfma_f32_16x16x32_bf16 v[184:187], a[8:11], a[148:151], v[184:187]
  v_mfma_f32_16x16x32_bf16 v[188:191], a[8:11], a[152:155], v[188:191]
  buffer_load_dwordx4 a[244:247], v54, s[72:75], s13 offen offset:2048 sc1
  v_mfma_f32_16x16x32_bf16 v[192:195], a[12:15], a[140:143], v[192:195]
  v_mfma_f32_16x16x32_bf16 v[196:199], a[12:15], a[144:147], v[196:199]
  buffer_load_dwordx4 a[8:11], v54, s[76:79], s7 offen offset:2048 sc1
  v_mfma_f32_16x16x32_bf16 v[200:203], a[12:15], a[148:151], v[200:203]
  v_mfma_f32_16x16x32_bf16 v[204:207], a[12:15], a[152:155], v[204:207]
  buffer_load_dwordx4 a[248:251], v54, s[72:75], s13 offen offset:3072 sc1
  v_mfma_f32_16x16x32_bf16 v[208:211], a[16:19], a[140:143], v[208:211]
  v_mfma_f32_16x16x32_bf16 v[212:215], a[16:19], a[144:147], v[212:215]
  buffer_load_dwordx4 a[12:15], v54, s[76:79], s7 offen offset:3072 sc1
  v_mfma_f32_16x16x32_bf16 v[216:219], a[16:19], a[148:151], v[216:219]
  v_mfma_f32_16x16x32_bf16 v[220:223], a[16:19], a[152:155], v[220:223]
  s_waitcnt vmcnt(53)
  v_mfma_f32_16x16x32_bf16 v[144:147], a[20:23], a[156:159], v[144:147]
  s_waitcnt vmcnt(51)
  v_mfma_f32_16x16x32_bf16 v[148:151], a[20:23], a[160:163], v[148:151]
  buffer_load_dwordx4 a[16:19], v56, s[76:79], s7 offen sc1
  s_waitcnt vmcnt(50)
  v_mfma_f32_16x16x32_bf16 v[152:155], a[20:23], a[164:167], v[152:155]
  s_waitcnt vmcnt(48)
  v_mfma_f32_16x16x32_bf16 v[156:159], a[20:23], a[168:171], v[156:159]
  s_add_u32 s13, s81, 1835008
  buffer_load_dwordx4 a[140:143], v54, s[72:75], s13 offen offset:0 sc1
  v_mfma_f32_16x16x32_bf16 v[160:163], a[24:27], a[156:159], v[160:163]
  v_mfma_f32_16x16x32_bf16 v[164:167], a[24:27], a[160:163], v[164:167]
  s_add_u32 s7, s80, 614400
  buffer_load_dwordx4 a[20:23], v54, s[76:79], s7 offen offset:0 sc1
  v_mfma_f32_16x16x32_bf16 v[168:171], a[24:27], a[164:167], v[168:171]
  v_mfma_f32_16x16x32_bf16 v[172:175], a[24:27], a[168:171], v[172:175]
  buffer_load_dwordx4 a[144:147], v54, s[72:75], s13 offen offset:1024 sc1
  v_mfma_f32_16x16x32_bf16 v[176:179], a[28:31], a[156:159], v[176:179]
  v_mfma_f32_16x16x32_bf16 v[180:183], a[28:31], a[160:163], v[180:183]
  buffer_load_dwordx4 a[24:27], v54, s[76:79], s7 offen offset:1024 sc1
  v_mfma_f32_16x16x32_bf16 v[184:187], a[28:31], a[164:167], v[184:187]
  v_mfma_f32_16x16x32_bf16 v[188:191], a[28:31], a[168:171], v[188:191]
  buffer_load_dwordx4 a[148:151], v54, s[72:75], s13 offen offset:2048 sc1
  v_mfma_f32_16x16x32_bf16 v[192:195], a[32:35], a[156:159], v[192:195]
  v_mfma_f32_16x16x32_bf16 v[196:199], a[32:35], a[160:163], v[196:199]
  buffer_load_dwordx4 a[28:31], v54, s[76:79], s7 offen offset:2048 sc1
  v_mfma_f32_16x16x32_bf16 v[200:203], a[32:35], a[164:167], v[200:203]
  v_mfma_f32_16x16x32_bf16 v[204:207], a[32:35], a[168:171], v[204:207]
  buffer_load_dwordx4 a[152:155], v54, s[72:75], s13 offen offset:3072 sc1
  v_mfma_f32_16x16x32_bf16 v[208:211], a[36:39], a[156:159], v[208:211]
  v_mfma_f32_16x16x32_bf16 v[212:215], a[36:39], a[160:163], v[212:215]
  buffer_load_dwordx4 a[32:35], v54, s[76:79], s7 offen offset:3072 sc1
  v_mfma_f32_16x16x32_bf16 v[216:219], a[36:39], a[164:167], v[216:219]
  v_mfma_f32_16x16x32_bf16 v[220:223], a[36:39], a[168:171], v[220:223]
  s_waitcnt vmcnt(53)
  v_mfma_f32_16x16x32_bf16 v[144:147], a[40:43], a[172:175], v[144:147]
  s_waitcnt vmcnt(51)
  v_mfma_f32_16x16x32_bf16 v[148:151], a[40:43], a[176:179], v[148:151]
  buffer_load_dwordx4 a[36:39], v56, s[76:79], s7 offen sc1
  s_waitcnt vmcnt(50)
  v_mfma_f32_16x16x32_bf16 v[152:155], a[40:43], a[180:183], v[152:155]
  s_waitcnt vmcnt(48)
  v_mfma_f32_16x16x32_bf16 v[156:159], a[40:43], a[184:187], v[156:159]
  s_add_u32 s13, s81, 1966080
  buffer_load_dwordx4 a[156:159], v54, s[72:75], s13 offen offset:0 sc1
  v_mfma_f32_16x16x32_bf16 v[160:163], a[44:47], a[172:175], v[160:163]
  v_mfma_f32_16x16x32_bf16 v[164:167], a[44:47], a[176:179], v[164:167]
  s_add_u32 s7, s80, 655360
  buffer_load_dwordx4 a[40:43], v54, s[76:79], s7 offen offset:0 sc1
  v_mfma_f32_16x16x32_bf16 v[168:171], a[44:47], a[180:183], v[168:171]
  v_mfma_f32_16x16x32_bf16 v[172:175], a[44:47], a[184:187], v[172:175]
  buffer_load_dwordx4 a[160:163], v54, s[72:75], s13 offen offset:1024 sc1
  v_mfma_f32_16x16x32_bf16 v[176:179], a[48:51], a[172:175], v[176:179]
  v_mfma_f32_16x16x32_bf16 v[180:183], a[48:51], a[176:179], v[180:183]
  buffer_load_dwordx4 a[44:47], v54, s[76:79], s7 offen offset:1024 sc1
  v_mfma_f32_16x16x32_bf16 v[184:187], a[48:51], a[180:183], v[184:187]
  v_mfma_f32_16x16x32_bf16 v[188:191], a[48:51], a[184:187], v[188:191]
  buffer_load_dwordx4 a[164:167], v54, s[72:75], s13 offen offset:2048 sc1
  v_mfma_f32_16x16x32_bf16 v[192:195], a[52:55], a[172:175], v[192:195]
  v_mfma_f32_16x16x32_bf16 v[196:199], a[52:55], a[176:179], v[196:199]
  buffer_load_dwordx4 a[48:51], v54, s[76:79], s7 offen offset:2048 sc1
  v_mfma_f32_16x16x32_bf16 v[200:203], a[52:55], a[180:183], v[200:203]
  v_mfma_f32_16x16x32_bf16 v[204:207], a[52:55], a[184:187], v[204:207]
  buffer_load_dwordx4 a[168:171], v54, s[72:75], s13 offen offset:3072 sc1
  v_mfma_f32_16x16x32_bf16 v[208:211], a[56:59], a[172:175], v[208:211]
  v_mfma_f32_16x16x32_bf16 v[212:215], a[56:59], a[176:179], v[212:215]
  buffer_load_dwordx4 a[52:55], v54, s[76:79], s7 offen offset:3072 sc1
  v_mfma_f32_16x16x32_bf16 v[216:219], a[56:59], a[180:183], v[216:219]
  v_mfma_f32_16x16x32_bf16 v[220:223], a[56:59], a[184:187], v[220:223]
  s_waitcnt vmcnt(53)
  v_mfma_f32_16x16x32_bf16 v[144:147], a[60:63], a[188:191], v[144:147]
  s_waitcnt vmcnt(51)
  v_mfma_f32_16x16x32_bf16 v[148:151], a[60:63], a[192:195], v[148:151]
  buffer_load_dwordx4 a[56:59], v56, s[76:79], s7 offen sc1
  s_waitcnt vmcnt(50)
  v_mfma_f32_16x16x32_bf16 v[152:155], a[60:63], a[196:199], v[152:155]
  s_waitcnt vmcnt(48)
  v_mfma_f32_16x16x32_bf16 v[156:159], a[60:63], a[200:203], v[156:159]
  s_add_u32 s13, s81, 2097152
  buffer_load_dwordx4 a[172:175], v54, s[72:75], s13 offen offset:0 sc1
  v_mfma_f32_16x16x32_bf16 v[160:163], a[64:67], a[188:191], v[160:163]
  v_mfma_f32_16x16x32_bf16 v[164:167], a[64:67], a[192:195], v[164:167]
  s_add_u32 s7, s80, 696320
  buffer_load_dwordx4 a[60:63], v54, s[76:79], s7 offen offset:0 sc1
  v_mfma_f32_16x16x32_bf16 v[168:171], a[64:67], a[196:199], v[168:171]
  v_mfma_f32_16x16x32_bf16 v[172:175], a[64:67], a[200:203], v[172:175]
  buffer_load_dwordx4 a[176:179], v54, s[72:75], s13 offen offset:1024 sc1
  v_mfma_f32_16x16x32_bf16 v[176:179], a[68:71], a[188:191], v[176:179]
  v_mfma_f32_16x16x32_bf16 v[180:183], a[68:71], a[192:195], v[180:183]
  buffer_load_dwordx4 a[64:67], v54, s[76:79], s7 offen offset:1024 sc1
  v_mfma_f32_16x16x32_bf16 v[184:187], a[68:71], a[196:199], v[184:187]
  v_mfma_f32_16x16x32_bf16 v[188:191], a[68:71], a[200:203], v[188:191]
  buffer_load_dwordx4 a[180:183], v54, s[72:75], s13 offen offset:2048 sc1
  v_mfma_f32_16x16x32_bf16 v[192:195], a[72:75], a[188:191], v[192:195]
  v_mfma_f32_16x16x32_bf16 v[196:199], a[72:75], a[192:195], v[196:199]
  buffer_load_dwordx4 a[68:71], v54, s[76:79], s7 offen offset:2048 sc1
  v_mfma_f32_16x16x32_bf16 v[200:203], a[72:75], a[196:199], v[200:203]
  v_mfma_f32_16x16x32_bf16 v[204:207], a[72:75], a[200:203], v[204:207]
  buffer_load_dwordx4 a[184:187], v54, s[72:75], s13 offen offset:3072 sc1
  v_mfma_f32_16x16x32_bf16 v[208:211], a[76:79], a[188:191], v[208:211]
  v_mfma_f32_16x16x32_bf16 v[212:215], a[76:79], a[192:195], v[212:215]
  buffer_load_dwordx4 a[72:75], v54, s[76:79], s7 offen offset:3072 sc1
  v_mfma_f32_16x16x32_bf16 v[216:219], a[76:79], a[196:199], v[216:219]
  v_mfma_f32_16x16x32_bf16 v[220:223], a[76:79], a[200:203], v[220:223]
  s_waitcnt vmcnt(34)
  v_cmp_ne_u32 vcc, s6, v9
  s_nop 1
  s_and_b64 vcc, vcc, s[98:99]
  s_cmp_eq_u64 vcc, 0
  s_cbranch_scc0 L_slow_41
L_back_42:
  v_mfma_f32_16x16x32_bf16 v[144:147], a[80:83], a[204:207], v[144:147]
  v_mfma_f32_16x16x32_bf16 v[148:151], a[80:83], a[208:211], v[148:151]
  buffer_load_dwordx4 a[76:79], v56, s[76:79], s7 offen sc1
  v_mfma_f32_16x16x32_bf16 v[152:155], a[80:83], a[212:215], v[152:155]
  v_mfma_f32_16x16x32_bf16 v[156:159], a[80:83], a[216:219], v[156:159]
  s_add_u32 s13, s81, 2228224
  buffer_load_dwordx4 a[188:191], v54, s[72:75], s13 offen offset:0 sc1
  v_mfma_f32_16x16x32_bf16 v[160:163], a[84:87], a[204:207], v[160:163]
  v_mfma_f32_16x16x32_bf16 v[164:167], a[84:87], a[208:211], v[164:167]
  s_add_u32 s7, s80, 737280
  buffer_load_dwordx4 a[80:83], v54, s[76:79], s7 offen offset:0 sc1
  v_mfma_f32_16x16x32_bf16 v[168:171], a[84:87], a[212:215], v[168:171]
  v_mfma_f32_16x16x32_bf16 v[172:175], a[84:87], a[216:219], v[172:175]
  buffer_load_dwordx4 a[192:195], v54, s[72:75], s13 offen offset:1024 sc1
  v_mfma_f32_16x16x32_bf16 v[176:179], a[88:91], a[204:207], v[176:179]
  v_mfma_f32_16x16x32_bf16 v[180:183], a[88:91], a[208:211], v[180:183]
  buffer_load_dwordx4 a[84:87], v54, s[76:79], s7 offen offset:1024 sc1
  v_mfma_f32_16x16x32_bf16 v[184:187], a[88:91], a[212:215], v[184:187]
  v_mfma_f32_16x16x32_bf16 v[188:191], a[88:91], a[216:219], v[188:191]
  buffer_load_dwordx4 a[196:199], v54, s[72:75], s13 offen offset:2048 sc1
  v_mfma_f32_16x16x32_bf16 v[192:195], a[92:95], a[204:207], v[192:195]
  v_mfma_f32_16x16x32_bf16 v[196:199], a[92:95], a[208:211], v[196:199]
  buffer_load_dwordx4 a[88:91], v54, s[76:79], s7 offen offset:2048 sc1
  v_mfma_f32_16x16x32_bf16 v[200:203], a[92:95], a[212:215], v[200:203]
  v_mfma_f32_16x16x32_bf16 v[204:207], a[92:95], a[216:219], v[204:207]
  buffer_load_dwordx4 a[200:203], v54, s[72:75], s13 offen offset:3072 sc1
  v_mfma_f32_16x16x32_bf16 v[208:211], a[96:99], a[204:207], v[208:211]
  v_mfma_f32_16x16x32_bf16 v[212:215], a[96:99], a[208:211], v[212:215]
  buffer_load_dwordx4 a[92:95], v54, s[76:79], s7 offen offset:3072 sc1
  v_mfma_f32_16x16x32_bf16 v[216:219], a[96:99], a[212:215], v[216:219]
  v_mfma_f32_16x16x32_bf16 v[220:223], a[96:99], a[216:219], v[220:223]
  v_mfma_f32_16x16x32_bf16 v[144:147], a[100:103], a[220:223], v[144:147]
  v_mfma_f32_16x16x32_bf16 v[148:151], a[100:103], a[224:227], v[148:151]
  buffer_load_dwordx4 a[96:99], v56, s[76:79], s7 offen sc1
  v_mfma_f32_16x16x32_bf16 v[152:155], a[100:103], a[228:231], v[152:155]
  v_mfma_f32_16x16x32_bf16 v[156:159], a[100:103], a[232:235], v[156:159]
  s_add_u32 s13, s81, 2359296
  buffer_load_dwordx4 a[204:207], v54, s[72:75], s13 offen offset:0 sc1
  v_lshlrev_b32 v244, 16, v246
  v_and_b32 v245, 0xffff0000, v246
  v_mfma_f32_16x16x32_bf16 v[160:163], a[104:107], a[220:223], v[160:163]
  v_mfma_f32_16x16x32_bf16 v[164:167], a[104:107], a[224:227], v[164:167]
  s_add_u32 s7, s80, 778240
  buffer_load_dwordx4 a[100:103], v54, s[76:79], s7 offen offset:0 sc1
  v_mfma_f32_16x16x32_bf16 v[168:171], a[104:107], a[228:231], v[168:171]
  v_mfma_f32_16x16x32_bf16 v[172:175], a[104:107], a[232:235], v[172:175]
  buffer_load_dwordx4 a[208:211], v54, s[72:75], s13 offen offset:1024 sc1
  v_rcp_f32 v245, v245
  v_lshlrev_b32 v14, 16, v224
  v_and_b32 v15, 0xffff0000, v224
  v_mfma_f32_16x16x32_bf16 v[176:179], a[108:111], a[220:223], v[176:179]
  v_mfma_f32_16x16x32_bf16 v[180:183], a[108:111], a[224:227], v[180:183]
  buffer_load_dwordx4 a[104:107], v54, s[76:79], s7 offen offset:1024 sc1
  v_mfma_f32_16x16x32_bf16 v[184:187], a[108:111], a[228:231], v[184:187]
  v_mfma_f32_16x16x32_bf16 v[188:191], a[108:111], a[232:235], v[188:191]
  buffer_load_dwordx4 a[212:215], v54, s[72:75], s13 offen offset:2048 sc1
  v_lshlrev_b32 v16, 16, v225
  v_and_b32 v17, 0xffff0000, v225
  v_mfma_f32_16x16x32_bf16 v[192:195], a[112:115], a[220:223], v[192:195]
  v_mfma_f32_16x16x32_bf16 v[196:199], a[112:115], a[224:227], v[196:199]
  buffer_load_dwordx4 a[108:111], v54, s[76:79], s7 offen offset:2048 sc1
  v_mfma_f32_16x16x32_bf16 v[200:203], a[112:115], a[228:231], v[200:203]
  v_mfma_f32_16x16x32_bf16 v[204:207], a[112:115], a[232:235], v[204:207]
  buffer_load_dwordx4 a[216:219], v54, s[72:75], s13 offen offset:3072 sc1
  v_lshlrev_b32 v34, 16, v234
  v_and_b32 v35, 0xffff0000, v234
  v_lshlrev_b32 v36, 16, v235
  v_mfma_f32_16x16x32_bf16 v[208:211], a[116:119], a[220:223], v[208:211]
  v_mfma_f32_16x16x32_bf16 v[212:215], a[116:119], a[224:227], v[212:215]
  buffer_load_dwordx4 a[112:115], v54, s[76:79], s7 offen offset:3072 sc1
  v_mfma_f32_16x16x32_bf16 v[216:219], a[116:119], a[228:231], v[216:219]
  v_mfma_f32_16x16x32_bf16 v[220:223], a[116:119], a[232:235], v[220:223]
  v_and_b32 v37, 0xffff0000, v235
  v_sub_f32 v248, v14, v244
  v_mfma_f32_16x16x32_bf16 v[144:147], a[120:123], a[236:239], v[144:147]
  s_waitcnt vmcnt(50)
  v_mfma_f32_16x16x32_bf16 v[148:151], a[120:123], a[240:243], v[148:151]
  buffer_load_dwordx4 a[116:119], v56, s[76:79], s7 offen sc1
  s_waitcnt vmcnt(49)
  v_mfma_f32_16x16x32_bf16 v[152:155], a[120:123], a[244:247], v[152:155]
  s_waitcnt vmcnt(47)
  v_mfma_f32_16x16x32_bf16 v[156:159], a[120:123], a[248:251], v[156:159]
  s_add_u32 s13, s81, 2490368
  buffer_load_dwordx4 a[220:223], v54, s[72:75], s13 offen offset:0 sc1
  v_sub_f32 v249, v15, v244
  v_sub_f32 v250, v16, v244
  v_sub_f32 v251, v17, v244
  v_mfma_f32_16x16x32_bf16 v[160:163], a[124:127], a[236:239], v[160:163]
  v_mfma_f32_16x16x32_bf16 v[164:167], a[124:127], a[240:243], v[164:167]
  s_add_u32 s7, s80, 819200
  buffer_load_dwordx4 a[120:123], v54, s[76:79], s7 offen offset:0 sc1
  v_mfma_f32_16x16x32_bf16 v[168:171], a[124:127], a[244:247], v[168:171]
  v_mfma_f32_16x16x32_bf16 v[172:175], a[124:127], a[248:251], v[172:175]
  buffer_load_dwordx4 a[224:227], v54, s[72:75], s13 offen offset:1024 sc1
  v_mul_f32 v248, v248, v245
  v_mul_f32 v249, v249, v245
  v_mul_f32 v250, v250, v245
  v_mfma_f32_16x16x32_bf16 v[176:179], a[128:131], a[236:239], v[176:179]
  v_mfma_f32_16x16x32_bf16 v[180:183], a[128:131], a[240:243], v[180:183]
  buffer_load_dwordx4 a[124:127], v54, s[76:79], s7 offen offset:1024 sc1
  v_mfma_f32_16x16x32_bf16 v[184:187], a[128:131], a[244:247], v[184:187]
  v_mfma_f32_16x16x32_bf16 v[188:191], a[128:131], a[248:251], v[188:191]
  buffer_load_dwordx4 a[228:231], v54, s[72:75], s13 offen offset:2048 sc1
  v_mul_f32 v251, v251, v245
  v_mul_f32 v34, v34, v248
  v_mfma_f32_16x16x32_bf16 v[192:195], a[132:135], a[236:239], v[192:195]
  v_mfma_f32_16x16x32_bf16 v[196:199], a[132:135], a[240:243], v[196:199]
  buffer_load_dwordx4 a[128:131], v54, s[76:79], s7 offen offset:2048 sc1
  v_mfma_f32_16x16x32_bf16 v[200:203], a[132:135], a[244:247], v[200:203]
  v_mfma_f32_16x16x32_bf16 v[204:207], a[132:135], a[248:251], v[204:207]
  buffer_load_dwordx4 a[232:235], v54, s[72:75], s13 offen offset:3072 sc1
  v_mul_f32 v35, v35, v249
  v_mul_f32 v36, v36, v250
  v_mul_f32 v37, v37, v251
  v_mfma_f32_16x16x32_bf16 v[208:211], a[136:139], a[236:239], v[208:211]
  v_mfma_f32_16x16x32_bf16 v[212:215], a[136:139], a[240:243], v[212:215]
  buffer_load_dwordx4 a[132:135], v54, s[76:79], s7 offen offset:3072 sc1
  v_mfma_f32_16x16x32_bf16 v[216:219], a[136:139], a[244:247], v[216:219]
  v_mfma_f32_16x16x32_bf16 v[220:223], a[136:139], a[248:251], v[220:223]
  v_lshlrev_b32 v18, 16, v226
  v_and_b32 v19, 0xffff0000, v226
  s_waitcnt vmcnt(52)
  v_mfma_f32_16x16x32_bf16 v[144:147], a[0:3], a[140:143], v[144:147]
  s_waitcnt vmcnt(50)
  v_mfma_f32_16x16x32_bf16 v[148:151], a[0:3], a[144:147], v[148:151]
  buffer_load_dwordx4 a[136:139], v56, s[76:79], s7 offen sc1
  s_waitcnt vmcnt(49)
  v_mfma_f32_16x16x32_bf16 v[152:155], a[0:3], a[148:151], v[152:155]
  s_waitcnt vmcnt(47)
  v_mfma_f32_16x16x32_bf16 v[156:159], a[0:3], a[152:155], v[156:159]
  s_add_u32 s13, s81, 2621440
  buffer_load_dwordx4 a[236:239], v54, s[72:75], s13 offen offset:0 sc1
  v_lshlrev_b32 v20, 16, v227
  v_and_b32 v21, 0xffff0000, v227
  v_lshlrev_b32 v38, 16, v236
  v_mfma_f32_16x16x32_bf16 v[160:163], a[4:7], a[140:143], v[160:163]
  v_mfma_f32_16x16x32_bf16 v[164:167], a[4:7], a[144:147], v[164:167]
  s_add_u32 s7, s80, 860160
  buffer_load_dwordx4 a[0:3], v54, s[76:79], s7 offen offset:0 sc1
  v_mfma_f32_16x16x32_bf16 v[168:171], a[4:7], a[148:151], v[168:171]
  v_mfma_f32_16x16x32_bf16 v[172:175], a[4:7], a[152:155], v[172:175]
  buffer_load_dwordx4 a[240:243], v54, s[72:75], s13 offen offset:1024 sc1
  v_and_b32 v39, 0xffff0000, v236
  v_lshlrev_b32 v40, 16, v237
  v_and_b32 v41, 0xffff0000, v237
  v_mfma_f32_16x16x32_bf16 v[176:179], a[8:11], a[140:143], v[176:179]
  v_mfma_f32_16x16x32_bf16 v[180:183], a[8:11], a[144:147], v[180:183]
  buffer_load_dwordx4 a[4:7], v54, s[76:79], s7 offen offset:1024 sc1
  v_mfma_f32_16x16x32_bf16 v[184:187], a[8:11], a[148:151], v[184:187]
  v_mfma_f32_16x16x32_bf16 v[188:191], a[8:11], a[152:155], v[188:191]
  buffer_load_dwordx4 a[244:247], v54, s[72:75], s13 offen offset:2048 sc1
  v_sub_f32 v248, v18, v244
  v_sub_f32 v249, v19, v244
  v_mfma_f32_16x16x32_bf16 v[192:195], a[12:15], a[140:143], v[192:195]
  v_mfma_f32_16x16x32_bf16 v[196:199], a[12:15], a[144:147], v[196:199]
  buffer_load_dwordx4 a[8:11], v54, s[76:79], s7 offen offset:2048 sc1
  v_mfma_f32_16x16x32_bf16 v[200:203], a[12:15], a[148:151], v[200:203]
  v_mfma_f32_16x16x32_bf16 v[204:207], a[12:15], a[152:155], v[204:207]
  buffer_load_dwordx4 a[248:251], v54, s[72:75], s13 offen offset:3072 sc1
  v_sub_f32 v250, v20, v244
  v_sub_f32 v251, v21, v244
  v_mul_f32 v248, v248, v245
  v_mfma_f32_16x16x32_bf16 v[208:211], a[16:19], a[140:143], v[208:211]
  v_mfma_f32_16x16x32_bf16 v[212:215], a[16:19], a[144:147], v[212:215]
  buffer_load_dwordx4 a[12:15], v54, s[76:79], s7 offen offset:3072 sc1
  v_mfma_f32_16x16x32_bf16 v[216:219], a[16:19], a[148:151], v[216:219]
  v_mfma_f32_16x16x32_bf16 v[220:223], a[16:19], a[152:155], v[220:223]
  v_mul_f32 v249, v249, v245
  v_mul_f32 v250, v250, v245
  s_waitcnt vmcnt(52)
  v_mfma_f32_16x16x32_bf16 v[144:147], a[20:23], a[156:159], v[144:147]
  s_waitcnt vmcnt(50)
  v_mfma_f32_16x16x32_bf16 v[148:151], a[20:23], a[160:163], v[148:151]
  buffer_load_dwordx4 a[16:19], v56, s[76:79], s7 offen sc1
  s_waitcnt vmcnt(49)
  v_mfma_f32_16x16x32_bf16 v[152:155], a[20:23], a[164:167], v[152:155]
  s_waitcnt vmcnt(47)
  v_mfma_f32_16x16x32_bf16 v[156:159], a[20:23], a[168:171], v[156:159]
  s_add_u32 s13, s81, 2752512
  buffer_load_dwordx4 a[140:143], v54, s[72:75], s13 offen offset:0 sc1
  v_mul_f32 v251, v251, v245
  v_mul_f32 v38, v38, v248
  v_mul_f32 v39, v39, v249
  v_mfma_f32_16x16x32_bf16 v[160:163], a[24:27], a[156:159], v[160:163]
  v_mfma_f32_16x16x32_bf16 v[164:167], a[24:27], a[160:163], v[164:167]
  s_add_u32 s7, s80, 901120
  buffer_load_dwordx4 a[20:23], v54, s[76:79], s7 offen offset:0 sc1
  v_mfma_f32_16x16x32_bf16 v[168:171], a[24:27], a[164:167], v[168:171]
  v_mfma_f32_16x16x32_bf16 v[172:175], a[24:27], a[168:171], v[172:175]
  buffer_load_dwordx4 a[144:147], v54, s[72:75], s13 offen offset:1024 sc1
  v_mul_f32 v40, v40, v250
  v_mul_f32 v41, v41, v251
  v_lshlrev_b32 v22, 16, v228
  v_mfma_f32_16x16x32_bf16 v[176:179], a[28:31], a[156:159], v[176:179]
  v_mfma_f32_16x16x32_bf16 v[180:183], a[28:31], a[160:163], v[180:183]
  buffer_load_dwordx4 a[24:27], v54, s[76:79], s7 offen offset:1024 sc1
  v_mfma_f32_16x16x32_bf16 v[184:187], a[28:31], a[164:167], v[184:187]
  v_mfma_f32_16x16x32_bf16 v[188:191], a[28:31], a[168:171], v[188:191]
  buffer_load_dwordx4 a[148:151], v54, s[72:75], s13 offen offset:2048 sc1
  v_and_b32 v23, 0xffff0000, v228
  v_lshlrev_b32 v24, 16, v229
  v_mfma_f32_16x16x32_bf16 v[192:195], a[32:35], a[156:159], v[192:195]
  v_mfma_f32_16x16x32_bf16 v[196:199], a[32:35], a[160:163], v[196:199]
  buffer_load_dwordx4 a[28:31], v54, s[76:79], s7 offen offset:2048 sc1
  v_mfma_f32_16x16x32_bf16 v[200:203], a[32:35], a[164:167], v[200:203]
  v_mfma_f32_16x16x32_bf16 v[204:207], a[32:35], a[168:171], v[204:207]
  buffer_load_dwordx4 a[152:155], v54, s[72:75], s13 offen offset:3072 sc1
  v_and_b32 v25, 0xffff0000, v229
  v_lshlrev_b32 v42, 16, v238
  v_and_b32 v43, 0xffff0000, v238
  v_mfma_f32_16x16x32_bf16 v[208:211], a[36:39], a[156:159], v[208:211]
  v_mfma_f32_16x16x32_bf16 v[212:215], a[36:39], a[160:163], v[212:215]
  buffer_load_dwordx4 a[32:35], v54, s[76:79], s7 offen offset:3072 sc1
  v_mfma_f32_16x16x32_bf16 v[216:219], a[36:39], a[164:167], v[216:219]
  v_mfma_f32_16x16x32_bf16 v[220:223], a[36:39], a[168:171], v[220:223]
  v_lshlrev_b32 v44, 16, v239
  v_and_b32 v45, 0xffff0000, v239
  s_waitcnt vmcnt(52)
  v_mfma_f32_16x16x32_bf16 v[144:147], a[40:43], a[172:175], v[144:147]
  s_waitcnt vmcnt(50)
  v_mfma_f32_16x16x32_bf16 v[148:151], a[40:43], a[176:179], v[148:151]
  buffer_load_dwordx4 a[36:39], v56, s[76:79], s7 offen sc1
  s_waitcnt vmcnt(49)
  v_mfma_f32_16x16x32_bf16 v[152:155], a[40:43], a[180:183], v[152:155]
  s_waitcnt vmcnt(47)
  v_mfma_f32_16x16x32_bf16 v[156:159], a[40:43], a[184:187], v[156:159]
  s_add_u32 s13, s81, 2883584
  buffer_load_dwordx4 a[156:159], v54, s[72:75], s13 offen offset:0 sc1
  v_sub_f32 v248, v22, v244
  v_sub_f32 v249, v23, v244
  v_sub_f32 v250, v24, v244
  v_mfma_f32_16x16x32_bf16 v[160:163], a[44:47], a[172:175], v[160:163]
  v_mfma_f32_16x16x32_bf16 v[164:167], a[44:47], a[176:179], v[164:167]
  v_mfma_f32_16x16x32_bf16 v[168:171], a[44:47], a[180:183], v[168:171]
  v_mfma_f32_16x16x32_bf16 v[172:175], a[44:47], a[184:187], v[172:175]
  buffer_load_dwordx4 a[160:163], v54, s[72:75], s13 offen offset:1024 sc1
  v_sub_f32 v251, v25, v244
  v_mul_f32 v248, v248, v245
  v_mul_f32 v249, v249, v245
  v_mfma_f32_16x16x32_bf16 v[176:179], a[48:51], a[172:175], v[176:179]
  v_mfma_f32_16x16x32_bf16 v[180:183], a[48:51], a[176:179], v[180:183]
  v_mfma_f32_16x16x32_bf16 v[184:187], a[48:51], a[180:183], v[184:187]
  v_mfma_f32_16x16x32_bf16 v[188:191], a[48:51], a[184:187], v[188:191]
  buffer_load_dwordx4 a[164:167], v54, s[72:75], s13 offen offset:2048 sc1
  v_mul_f32 v250, v250, v245
  v_mul_f32 v251, v251, v245
  v_mfma_f32_16x16x32_bf16 v[192:195], a[52:55], a[172:175], v[192:195]
  v_mfma_f32_16x16x32_bf16 v[196:199], a[52:55], a[176:179], v[196:199]
  v_mfma_f32_16x16x32_bf16 v[200:203], a[52:55], a[180:183], v[200:203]
  v_mfma_f32_16x16x32_bf16 v[204:207], a[52:55], a[184:187], v[204:207]
  buffer_load_dwordx4 a[168:171], v54, s[72:75], s13 offen offset:3072 sc1
  v_mul_f32 v42, v42, v248
  v_mul_f32 v43, v43, v249
  v_mul_f32 v44, v44, v250
  v_mfma_f32_16x16x32_bf16 v[208:211], a[56:59], a[172:175], v[208:211]
  v_mfma_f32_16x16x32_bf16 v[212:215], a[56:59], a[176:179], v[212:215]
  v_mfma_f32_16x16x32_bf16 v[216:219], a[56:59], a[180:183], v[216:219]
  v_mfma_f32_16x16x32_bf16 v[220:223], a[56:59], a[184:187], v[220:223]
  v_mul_f32 v45, v45, v251
  v_lshlrev_b32 v26, 16, v230
  s_waitcnt vmcnt(48)
  v_mfma_f32_16x16x32_bf16 v[144:147], a[60:63], a[188:191], v[144:147]
  s_waitcnt vmcnt(46)
  v_mfma_f32_16x16x32_bf16 v[148:151], a[60:63], a[192:195], v[148:151]
  s_waitcnt vmcnt(44)
  v_mfma_f32_16x16x32_bf16 v[152:155], a[60:63], a[196:199], v[152:155]
  s_waitcnt vmcnt(42)
  v_mfma_f32_16x16x32_bf16 v[156:159], a[60:63], a[200:203], v[156:159]
  v_and_b32 v27, 0xffff0000, v230
  v_lshlrev_b32 v28, 16, v231
  v_and_b32 v29, 0xffff0000, v231
  v_mfma_f32_16x16x32_bf16 v[160:163], a[64:67], a[188:191], v[160:163]
  v_mfma_f32_16x16x32_bf16 v[164:167], a[64:67], a[192:195], v[164:167]
  v_mfma_f32_16x16x32_bf16 v[168:171], a[64:67], a[196:199], v[168:171]
  v_mfma_f32_16x16x32_bf16 v[172:175], a[64:67], a[200:203], v[172:175]
  v_lshlrev_b32 v46, 16, v240
  v_and_b32 v47, 0xffff0000, v240
  v_lshlrev_b32 v48, 16, v241
  v_mfma_f32_16x16x32_bf16 v[176:179], a[68:71], a[188:191], v[176:179]
  v_mfma_f32_16x16x32_bf16 v[180:183], a[68:71], a[192:195], v[180:183]
  v_mfma_f32_16x16x32_bf16 v[184:187], a[68:71], a[196:199], v[184:187]
  v_mfma_f32_16x16x32_bf16 v[188:191], a[68:71], a[200:203], v[188:191]
  v_and_b32 v49, 0xffff0000, v241
  v_sub_f32 v248, v26, v244
  v_mfma_f32_16x16x32_bf16 v[192:195], a[72:75], a[188:191], v[192:195]
  v_mfma_f32_16x16x32_bf16 v[196:199], a[72:75], a[192:195], v[196:199]
  v_mfma_f32_16x16x32_bf16 v[200:203], a[72:75], a[196:199], v[200:203]
  v_mfma_f32_16x16x32_bf16 v[204:207], a[72:75], a[200:203], v[204:207]
  v_sub_f32 v249, v27, v244
  v_sub_f32 v250, v28, v244
  v_sub_f32 v251, v29, v244
  v_mfma_f32_16x16x32_bf16 v[208:211], a[76:79], a[188:191], v[208:211]
  v_mfma_f32_16x16x32_bf16 v[212:215], a[76:79], a[192:195], v[212:215]
  v_mfma_f32_16x16x32_bf16 v[216:219], a[76:79], a[196:199], v[216:219]
  v_mfma_f32_16x16x32_bf16 v[220:223], a[76:79], a[200:203], v[220:223]
  v_mul_f32 v248, v248, v245
  v_mul_f32 v249, v249, v245
  s_waitcnt vmcnt(39)
  v_mfma_f32_16x16x32_bf16 v[144:147], a[80:83], a[204:207], v[144:147]
  s_waitcnt vmcnt(37)
  v_mfma_f32_16x16x32_bf16 v[148:151], a[80:83], a[208:211], v[148:151]
  s_waitcnt vmcnt(35)
  v_mfma_f32_16x16x32_bf16 v[152:155], a[80:83], a[212:215], v[152:155]
  s_waitcnt vmcnt(33)
  v_mfma_f32_16x16x32_bf16 v[156:159], a[80:83], a[216:219], v[156:159]
  v_mul_f32 v250, v250, v245
  v_mul_f32 v251, v251, v245
  v_mul_f32 v46, v46, v248
  v_mfma_f32_16x16x32_bf16 v[160:163], a[84:87], a[204:207], v[160:163]
  v_mfma_f32_16x16x32_bf16 v[164:167], a[84:87], a[208:211], v[164:167]
  v_mfma_f32_16x16x32_bf16 v[168:171], a[84:87], a[212:215], v[168:171]
  v_mfma_f32_16x16x32_bf16 v[172:175], a[84:87], a[216:219], v[172:175]
  v_mul_f32 v47, v47, v249
  v_mul_f32 v48, v48, v250
  v_mul_f32 v49, v49, v251
  v_mfma_f32_16x16x32_bf16 v[176:179], a[88:91], a[204:207], v[176:179]
  v_mfma_f32_16x16x32_bf16 v[180:183], a[88:91], a[208:211], v[180:183]
  v_mfma_f32_16x16x32_bf16 v[184:187], a[88:91], a[212:215], v[184:187]
  v_mfma_f32_16x16x32_bf16 v[188:191], a[88:91], a[216:219], v[188:191]
  v_lshlrev_b32 v30, 16, v232
  v_and_b32 v31, 0xffff0000, v232
  v_mfma_f32_16x16x32_bf16 v[192:195], a[92:95], a[204:207], v[192:195]
  v_mfma_f32_16x16x32_bf16 v[196:199], a[92:95], a[208:211], v[196:199]
  v_mfma_f32_16x16x32_bf16 v[200:203], a[92:95], a[212:215], v[200:203]
  v_mfma_f32_16x16x32_bf16 v[204:207], a[92:95], a[216:219], v[204:207]
  v_lshlrev_b32 v32, 16, v233
  v_and_b32 v33, 0xffff0000, v233
  v_lshlrev_b32 v50, 16, v242
  v_mfma_f32_16x16x32_bf16 v[208:211], a[96:99], a[204:207], v[208:211]
  v_mfma_f32_16x16x32_bf16 v[212:215], a[96:99], a[208:211], v[212:215]
  v_mfma_f32_16x16x32_bf16 v[216:219], a[96:99], a[212:215], v[216:219]
  v_mfma_f32_16x16x32_bf16 v[220:223], a[96:99], a[216:219], v[220:223]
  v_and_b32 v51, 0xffff0000, v242
  v_lshlrev_b32 v52, 16, v243
  s_waitcnt vmcnt(30)
  v_mfma_f32_16x16x32_bf16 v[144:147], a[100:103], a[220:223], v[144:147]
  s_waitcnt vmcnt(28)
  v_mfma_f32_16x16x32_bf16 v[148:151], a[100:103], a[224:227], v[148:151]
  s_waitcnt vmcnt(26)
  v_mfma_f32_16x16x32_bf16 v[152:155], a[100:103], a[228:231], v[152:155]
  s_waitcnt vmcnt(24)
  v_mfma_f32_16x16x32_bf16 v[156:159], a[100:103], a[232:235], v[156:159]
  v_and_b32 v53, 0xffff0000, v243
  v_sub_f32 v248, v30, v244
  v_sub_f32 v249, v31, v244
  v_mfma_f32_16x16x32_bf16 v[160:163], a[104:107], a[220:223], v[160:163]
  v_mfma_f32_16x16x32_bf16 v[164:167], a[104:107], a[224:227], v[164:167]
  v_mfma_f32_16x16x32_bf16 v[168:171], a[104:107], a[228:231], v[168:171]
  v_mfma_f32_16x16x32_bf16 v[172:175], a[104:107], a[232:235], v[172:175]
  v_sub_f32 v250, v32, v244
  v_sub_f32 v251, v33, v244
  v_mul_f32 v248, v248, v245
  v_mfma_f32_16x16x32_bf16 v[176:179], a[108:111], a[220:223], v[176:179]
  v_mfma_f32_16x16x32_bf16 v[180:183], a[108:111], a[224:227], v[180:183]
  v_mfma_f32_16x16x32_bf16 v[184:187], a[108:111], a[228:231], v[184:187]
  v_mfma_f32_16x16x32_bf16 v[188:191], a[108:111], a[232:235], v[188:191]
  v_mul_f32 v249, v249, v245
  v_mul_f32 v250, v250, v245
  v_mfma_f32_16x16x32_bf16 v[192:195], a[112:115], a[220:223], v[192:195]
  v_mfma_f32_16x16x32_bf16 v[196:199], a[112:115], a[224:227], v[196:199]
  v_mfma_f32_16x16x32_bf16 v[200:203], a[112:115], a[228:231], v[200:203]
  v_mfma_f32_16x16x32_bf16 v[204:207], a[112:115], a[232:235], v[204:207]
  v_mul_f32 v251, v251, v245
  v_mul_f32 v50, v50, v248
  v_mul_f32 v51, v51, v249
  v_mfma_f32_16x16x32_bf16 v[208:211], a[116:119], a[220:223], v[208:211]
  v_mfma_f32_16x16x32_bf16 v[212:215], a[116:119], a[224:227], v[212:215]
  v_mfma_f32_16x16x32_bf16 v[216:219], a[116:119], a[228:231], v[216:219]
  v_mfma_f32_16x16x32_bf16 v[220:223], a[116:119], a[232:235], v[220:223]
  v_mul_f32 v52, v52, v250
  v_mul_f32 v53, v53, v251
  s_waitcnt vmcnt(21)
  v_mfma_f32_16x16x32_bf16 v[144:147], a[120:123], a[236:239], v[144:147]
  s_waitcnt vmcnt(19)
  v_mfma_f32_16x16x32_bf16 v[148:151], a[120:123], a[240:243], v[148:151]
  s_waitcnt vmcnt(17)
  v_mfma_f32_16x16x32_bf16 v[152:155], a[120:123], a[244:247], v[152:155]
  s_waitcnt vmcnt(15)
  v_mfma_f32_16x16x32_bf16 v[156:159], a[120:123], a[248:251], v[156:159]
  v_mfma_f32_16x16x32_bf16 v[160:163], a[124:127], a[236:239], v[160:163]
  v_mfma_f32_16x16x32_bf16 v[164:167], a[124:127], a[240:243], v[164:167]
  v_mfma_f32_16x16x32_bf16 v[168:171], a[124:127], a[244:247], v[168:171]
  v_mfma_f32_16x16x32_bf16 v[172:175], a[124:127], a[248:251], v[172:175]
  v_mfma_f32_16x16x32_bf16 v[176:179], a[128:131], a[236:239], v[176:179]
  v_mfma_f32_16x16x32_bf16 v[180:183], a[128:131], a[240:243], v[180:183]
  v_mfma_f32_16x16x32_bf16 v[184:187], a[128:131], a[244:247], v[184:187]
  v_mfma_f32_16x16x32_bf16 v[188:191], a[128:131], a[248:251], v[188:191]
  v_mfma_f32_16x16x32_bf16 v[192:195], a[132:135], a[236:239], v[192:195]
  v_mfma_f32_16x16x32_bf16 v[196:199], a[132:135], a[240:243], v[196:199]
  v_mfma_f32_16x16x32_bf16 v[200:203], a[132:135], a[244:247], v[200:203]
  v_mfma_f32_16x16x32_bf16 v[204:207], a[132:135], a[248:251], v[204:207]
  v_mfma_f32_16x16x32_bf16 v[208:211], a[136:139], a[236:239], v[208:211]
  v_mfma_f32_16x16x32_bf16 v[212:215], a[136:139], a[240:243], v[212:215]
  v_mfma_f32_16x16x32_bf16 v[216:219], a[136:139], a[244:247], v[216:219]
  v_mfma_f32_16x16x32_bf16 v[220:223], a[136:139], a[248:251], v[220:223]
  s_waitcnt vmcnt(12)
  v_mfma_f32_16x16x32_bf16 v[144:147], a[0:3], a[140:143], v[144:147]
  s_waitcnt vmcnt(10)
  v_mfma_f32_16x16x32_bf16 v[148:151], a[0:3], a[144:147], v[148:151]
  s_waitcnt vmcnt(8)
  v_mfma_f32_16x16x32_bf16 v[152:155], a[0:3], a[148:151], v[152:155]
  s_waitcnt vmcnt(6)
  v_mfma_f32_16x16x32_bf16 v[156:159], a[0:3], a[152:155], v[156:159]
  v_mfma_f32_16x16x32_bf16 v[160:163], a[4:7], a[140:143], v[160:163]
  v_mfma_f32_16x16x32_bf16 v[164:167], a[4:7], a[144:147], v[164:167]
  v_mfma_f32_16x16x32_bf16 v[168:171], a[4:7], a[148:151], v[168:171]
  v_mfma_f32_16x16x32_bf16 v[172:175], a[4:7], a[152:155], v[172:175]
  v_mfma_f32_16x16x32_bf16 v[176:179], a[8:11], a[140:143], v[176:179]
  v_mfma_f32_16x16x32_bf16 v[180:183], a[8:11], a[144:147], v[180:183]
  v_mfma_f32_16x16x32_bf16 v[184:187], a[8:11], a[148:151], v[184:187]
  v_mfma_f32_16x16x32_bf16 v[188:191], a[8:11], a[152:155], v[188:191]
  v_mfma_f32_16x16x32_bf16 v[192:195], a[12:15], a[140:143], v[192:195]
  v_mfma_f32_16x16x32_bf16 v[196:199], a[12:15], a[144:147], v[196:199]
  v_mfma_f32_16x16x32_bf16 v[200:203], a[12:15], a[148:151], v[200:203]
  v_mfma_f32_16x16x32_bf16 v[204:207], a[12:15], a[152:155], v[204:207]
  v_mfma_f32_16x16x32_bf16 v[208:211], a[16:19], a[140:143], v[208:211]
  v_mfma_f32_16x16x32_bf16 v[212:215], a[16:19], a[144:147], v[212:215]
  v_mfma_f32_16x16x32_bf16 v[216:219], a[16:19], a[148:151], v[216:219]
  v_mfma_f32_16x16x32_bf16 v[220:223], a[16:19], a[152:155], v[220:223]
  s_waitcnt vmcnt(3)
  v_mfma_f32_16x16x32_bf16 v[144:147], a[20:23], a[156:159], v[144:147]
  s_waitcnt vmcnt(2)
  v_mfma_f32_16x16x32_bf16 v[148:151], a[20:23], a[160:163], v[148:151]
  s_waitcnt vmcnt(1)
  v_mfma_f32_16x16x32_bf16 v[152:155], a[20:23], a[164:167], v[152:155]
  s_waitcnt vmcnt(0)
  v_mfma_f32_16x16x32_bf16 v[156:159], a[20:23], a[168:171], v[156:159]
  v_mfma_f32_16x16x32_bf16 v[160:163], a[24:27], a[156:159], v[160:163]
  v_mfma_f32_16x16x32_bf16 v[164:167], a[24:27], a[160:163], v[164:167]
  v_mfma_f32_16x16x32_bf16 v[168:171], a[24:27], a[164:167], v[168:171]
  v_mfma_f32_16x16x32_bf16 v[172:175], a[24:27], a[168:171], v[172:175]
  v_mfma_f32_16x16x32_bf16 v[176:179], a[28:31], a[156:159], v[176:179]
  v_mfma_f32_16x16x32_bf16 v[180:183], a[28:31], a[160:163], v[180:183]
  v_mfma_f32_16x16x32_bf16 v[184:187], a[28:31], a[164:167], v[184:187]
  v_mfma_f32_16x16x32_bf16 v[188:191], a[28:31], a[168:171], v[188:191]
  v_mfma_f32_16x16x32_bf16 v[192:195], a[32:35], a[156:159], v[192:195]
  v_mfma_f32_16x16x32_bf16 v[196:199], a[32:35], a[160:163], v[196:199]
  v_mfma_f32_16x16x32_bf16 v[200:203], a[32:35], a[164:167], v[200:203]
  v_mfma_f32_16x16x32_bf16 v[204:207], a[32:35], a[168:171], v[204:207]
  v_mfma_f32_16x16x32_bf16 v[208:211], a[36:39], a[156:159], v[208:211]
  v_mfma_f32_16x16x32_bf16 v[212:215], a[36:39], a[160:163], v[212:215]
  v_mfma_f32_16x16x32_bf16 v[216:219], a[36:39], a[164:167], v[216:219]
  v_mfma_f32_16x16x32_bf16 v[220:223], a[36:39], a[168:171], v[220:223]
  s_waitcnt vmcnt(0)
L_P2_done:
  s_nop 7
  s_mul_i32 s8, s3, 20480
  v_add_u32 v4, s8, v13
  s_cmp_eq_u32 s3, 0
  s_cbranch_scc1 L_skipw_44
  ds_write_b128 v4, v[144:147] offset:0
  ds_write_b128 v4, v[160:163] offset:1024
  ds_write_b128 v4, v[176:179] offset:2048
  ds_write_b128 v4, v[192:195] offset:3072
  ds_write_b128 v4, v[208:211] offset:4096
L_skipw_44:
  s_cmp_eq_u32 s3, 1
  s_cbranch_scc1 L_skipw_45
  ds_write_b128 v4, v[148:151] offset:5120
  ds_write_b128 v4, v[164:167] offset:6144
  ds_write_b128 v4, v[180:183] offset:7168
  ds_write_b128 v4, v[196:199] offset:8192
  ds_write_b128 v4, v[212:215] offset:9216
L_skipw_45:
  s_cmp_eq_u32 s3, 2
  s_cbranch_scc1 L_skipw_46
  ds_write_b128 v4, v[152:155] offset:10240
  ds_write_b128 v4, v[168:171] offset:11264
  ds_write_b128 v4, v[184:187] offset:12288
  ds_write_b128 v4, v[200:203] offset:13312
  ds_write_b128 v4, v[216:219] offset:14336
L_skipw_46:
  s_cmp_eq_u32 s3, 3
  s_cbranch_scc1 L_skipw_47
  ds_write_b128 v4, v[156:159] offset:15360
  ds_write_b128 v4, v[172:175] offset:16384
  ds_write_b128 v4, v[188:191] offset:17408
  ds_write_b128 v4, v[204:207] offset:18432
  ds_write_b128 v4, v[220:223] offset:19456
L_skipw_47:
  s_cmp_lg_u32 s3, 0
  s_cbranch_scc1 L_skipo_48
  v_mov_b32 v224, v144
  v_mov_b32 v225, v145
  v_mov_b32 v226, v146
  v_mov_b32 v227, v147
  v_mov_b32 v228, v160
  v_mov_b32 v229, v161
  v_mov_b32 v230, v162
  v_mov_b32 v231, v163
  v_mov_b32 v232, v176
  v_mov_b32 v233, v177
  v_mov_b32 v234, v178
  v_mov_b32 v235, v179
  v_mov_b32 v236, v192
  v_mov_b32 v237, v193
  v_mov_b32 v238, v194
  v_mov_b32 v239, v195
  v_mov_b32 v240, v208
  v_mov_b32 v241, v209
  v_mov_b32 v242, v210
  v_mov_b32 v243, v211
L_skipo_48:
  s_cmp_lg_u32 s3, 1
  s_cbranch_scc1 L_skipo_49
  v_mov_b32 v224, v148
  v_mov_b32 v225, v149
  v_mov_b32 v226, v150
  v_mov_b32 v227, v151
  v_mov_b32 v228, v164
  v_mov_b32 v229, v165
  v_mov_b32 v230, v166
  v_mov_b32 v231, v167
  v_mov_b32 v232, v180
  v_mov_b32 v233, v181
  v_mov_b32 v234, v182
  v_mov_b32 v235, v183
  v_mov_b32 v236, v196
  v_mov_b32 v237, v197
  v_mov_b32 v238, v198
  v_mov_b32 v239, v199
  v_mov_b32 v240, v212
  v_mov_b32 v241, v213
  v_mov_b32 v242, v214
  v_mov_b32 v243, v215
L_skipo_49:
  s_cmp_lg_u32 s3, 2
  s_cbranch_scc1 L_skipo_50
  v_mov_b32 v224, v152
  v_mov_b32 v225, v153
  v_mov_b32 v226, v154
  v_mov_b32 v227, v155
  v_mov_b32 v228, v168
  v_mov_b32 v229, v169
  v_mov_b32 v230, v170
  v_mov_b32 v231, v171
  v_mov_b32 v232, v184
  v_mov_b32 v233, v185
  v_mov_b32 v234, v186
  v_mov_b32 v235, v187
  v_mov_b32 v236, v200
  v_mov_b32 v237, v201
  v_mov_b32 v238, v202
  v_mov_b32 v239, v203
  v_mov_b32 v240, v216
  v_mov_b32 v241, v217
  v_mov_b32 v242, v218
  v_mov_b32 v243, v219
L_skipo_50:
  s_cmp_lg_u32 s3, 3
  s_cbranch_scc1 L_skipo_51
  v_mov_b32 v224, v156
  v_mov_b32 v225, v157
  v_mov_b32 v226, v158
  v_mov_b32 v227, v159
  v_mov_b32 v228, v172
  v_mov_b32 v229, v173
  v_mov_b32 v230, v174
  v_mov_b32 v231, v175
  v_mov_b32 v232, v188
  v_mov_b32 v233, v189
  v_mov_b32 v234, v190
  v_mov_b32 v235, v191
  v_mov_b32 v236, v204
  v_mov_b32 v237, v205
  v_mov_b32 v238, v206
  v_mov_b32 v239, v207
  v_mov_b32 v240, v220
  v_mov_b32 v241, v221
  v_mov_b32 v242, v222
  v_mov_b32 v243, v223
L_skipo_51:
  s_xor_b32 s8, s3, 1
  s_lshl_b32 s8, s8, 2
  s_add_u32 s8, s8, s3
  s_mul_i32 s8, s8, 5120
  v_add_u32 v10, s8, v13
  s_xor_b32 s8, s3, 2
  s_lshl_b32 s8, s8, 2
  s_add_u32 s8, s8, s3
  s_mul_i32 s8, s8, 5120
  v_add_u32 v11, s8, v13
  s_xor_b32 s8, s3, 3
  s_lshl_b32 s8, s8, 2
  s_add_u32 s8, s8, s3
  s_mul_i32 s8, s8, 5120
  v_add_u32 v12, s8, v13
  s_mul_i32 s8, s3, 5120
  s_add_u32 s8, s8, 81920
  v_add_u32 v13, s8, v13
  s_waitcnt lgkmcnt(0)
  s_barrier
  ds_read_b128 v[64:67], v10 offset:0
  ds_read_b128 v[68:71], v11 offset:0
  ds_read_b128 v[72:75], v12 offset:0
  ds_read_b128 v[76:79], v13 offset:0
  ds_read_b128 v[80:83], v13 offset:20480
  ds_read_b128 v[84:87], v10 offset:1024
  ds_read_b128 v[88:91], v11 offset:1024
  ds_read_b128 v[92:95], v12 offset:1024
  ds_read_b128 v[96:99], v13 offset:1024
  ds_read_b128 v[100:103], v13 offset:21504
  ds_read_b128 v[104:107], v10 offset:2048
  ds_read_b128 v[108:111], v11 offset:2048
  ds_read_b128 v[112:115], v12 offset:2048
  ds_read_b128 v[116:119], v13 offset:2048
  ds_read_b128 v[120:123], v13 offset:22528
  ds_read_b128 v[124:127], v10 offset:3072
  ds_read_b128 v[128:131], v11 offset:3072
  ds_read_b128 v[132:135], v12 offset:3072
  ds_read_b128 v[136:139], v13 offset:3072
  ds_read_b128 v[140:143], v13 offset:23552
  ds_read_b128 v[144:147], v10 offset:4096
  ds_read_b128 v[148:151], v11 offset:4096
  ds_read_b128 v[152:155], v12 offset:4096
  ds_read_b128 v[156:159], v13 offset:4096
  ds_read_b128 v[160:163], v13 offset:24576
  s_mov_b32 s60, s42
  s_mov_b32 s61, s43
  s_mov_b32 s62, 0x500000
  s_mov_b32 s63, 0x20000
  s_mul_i32 s8, s86, 2560
  s_lshl_b32 s9, s87, 1
  s_add_u32 s8, s8, s9
  s_waitcnt lgkmcnt(15)
  v_add_f32 v224, v224, v64
  v_add_f32 v225, v225, v65
  v_add_f32 v226, v226, v66
  v_add_f32 v227, v227, v67
  v_add_f32 v68, v68, v72
  v_add_f32 v69, v69, v73
  v_add_f32 v70, v70, v74
  v_add_f32 v71, v71, v75
  v_add_f32 v76, v76, v80
  v_add_f32 v77, v77, v81
  v_add_f32 v78, v78, v82
  v_add_f32 v79, v79, v83
  v_add_f32 v224, v224, v68
  v_add_f32 v225, v225, v69
  v_add_f32 v226, v226, v70
  v_add_f32 v227, v227, v71
  v_add_f32 v76, v76, v34
  v_add_f32 v77, v77, v35
  v_add_f32 v78, v78, v36
  v_add_f32 v79, v79, v37
  v_mul_f32 v248, 0xbfb8aa3b, v224
  v_mul_f32 v249, 0xbfb8aa3b, v225
  v_mul_f32 v250, 0xbfb8aa3b, v226
  v_mul_f32 v251, 0xbfb8aa3b, v227
  v_exp_f32 v248, v248
  v_exp_f32 v249, v249
  v_exp_f32 v250, v250
  v_exp_f32 v251, v251
  v_mul_f32 v76, v76, v224
  v_mul_f32 v77, v77, v225
  v_mul_f32 v78, v78, v226
  v_mul_f32 v79, v79, v227
  v_add_f32 v248, 1.0, v248
  v_add_f32 v249, 1.0, v249
  v_add_f32 v250, 1.0, v250
  v_add_f32 v251, 1.0, v251
  v_rcp_f32 v248, v248
  v_rcp_f32 v249, v249
  v_rcp_f32 v250, v250
  v_rcp_f32 v251, v251
  v_fma_f32 v76, v76, v248, v14
  v_fma_f32 v77, v77, v249, v15
  v_fma_f32 v78, v78, v250, v16
  v_fma_f32 v79, v79, v251, v17
  buffer_store_dwordx4 v[76:79], v8, s[60:63], s8 offen offset:0 sc1
  v_add_f32 v228, v228, v84
  v_add_f32 v229, v229, v85
  v_add_f32 v230, v230, v86
  v_add_f32 v231, v231, v87
  v_add_f32 v88, v88, v92
  v_add_f32 v89, v89, v93
  v_add_f32 v90, v90, v94
  v_add_f32 v91, v91, v95
  v_add_f32 v96, v96, v100
  v_add_f32 v97, v97, v101
  v_add_f32 v98, v98, v102
  v_add_f32 v99, v99, v103
  v_add_f32 v228, v228, v88
  v_add_f32 v229, v229, v89
  v_add_f32 v230, v230, v90
  v_add_f32 v231, v231, v91
  v_add_f32 v96, v96, v38
  v_add_f32 v97, v97, v39
  v_add_f32 v98, v98, v40
  v_add_f32 v99, v99, v41
  v_mul_f32 v248, 0xbfb8aa3b, v228
  v_mul_f32 v249, 0xbfb8aa3b, v229
  v_mul_f32 v250, 0xbfb8aa3b, v230
  v_mul_f32 v251, 0xbfb8aa3b, v231
  v_exp_f32 v248, v248
  v_exp_f32 v249, v249
  v_exp_f32 v250, v250
  v_exp_f32 v251, v251
  v_mul_f32 v96, v96, v228
  v_mul_f32 v97, v97, v229
  v_mul_f32 v98, v98, v230
  v_mul_f32 v99, v99, v231
  v_add_f32 v248, 1.0, v248
  v_add_f32 v249, 1.0, v249
  v_add_f32 v250, 1.0, v250
  v_add_f32 v251, 1.0, v251
  v_rcp_f32 v248, v248
  v_rcp_f32 v249, v249
  v_rcp_f32 v250, v250
  v_rcp_f32 v251, v251
  v_fma_f32 v96, v96, v248, v18
  v_fma_f32 v97, v97, v249, v19
  v_fma_f32 v98, v98, v250, v20
  v_fma_f32 v99, v99, v251, v21
  buffer_store_dwordx4 v[96:99], v8, s[60:63], s8 offen offset:64 sc1
  s_waitcnt lgkmcnt(10)
  v_add_f32 v232, v232, v104
  v_add_f32 v233, v233, v105
  v_add_f32 v234, v234, v106
  v_add_f32 v235, v235, v107
  v_add_f32 v108, v108, v112
  v_add_f32 v109, v109, v113
  v_add_f32 v110, v110, v114
  v_add_f32 v111, v111, v115
  v_add_f32 v116, v116, v120
  v_add_f32 v117, v117, v121
  v_add_f32 v118, v118, v122
  v_add_f32 v119, v119, v123
  v_add_f32 v232, v232, v108
  v_add_f32 v233, v233, v109
  v_add_f32 v234, v234, v110
  v_add_f32 v235, v235, v111
  v_add_f32 v116, v116, v42
  v_add_f32 v117, v117, v43
  v_add_f32 v118, v118, v44
  v_add_f32 v119, v119, v45
  v_mul_f32 v248, 0xbfb8aa3b, v232
  v_mul_f32 v249, 0xbfb8aa3b, v233
  v_mul_f32 v250, 0xbfb8aa3b, v234
  v_mul_f32 v251, 0xbfb8aa3b, v235
  v_exp_f32 v248, v248
  v_exp_f32 v249, v249
  v_exp_f32 v250, v250
  v_exp_f32 v251, v251
  v_mul_f32 v116, v116, v232
  v_mul_f32 v117, v117, v233
  v_mul_f32 v118, v118, v234
  v_mul_f32 v119, v119, v235
  v_add_f32 v248, 1.0, v248
  v_add_f32 v249, 1.0, v249
  v_add_f32 v250, 1.0, v250
  v_add_f32 v251, 1.0, v251
  v_rcp_f32 v248, v248
  v_rcp_f32 v249, v249
  v_rcp_f32 v250, v250
  v_rcp_f32 v251, v251
  v_fma_f32 v116, v116, v248, v22
  v_fma_f32 v117, v117, v249, v23
  v_fma_f32 v118, v118, v250, v24
  v_fma_f32 v119, v119, v251, v25
  buffer_store_dwordx4 v[116:119], v8, s[60:63], s8 offen offset:128 sc1
  s_waitcnt lgkmcnt(5)
  v_add_f32 v236, v236, v124
  v_add_f32 v237, v237, v125
  v_add_f32 v238, v238, v126
  v_add_f32 v239, v239, v127
  v_add_f32 v128, v128, v132
  v_add_f32 v129, v129, v133
  v_add_f32 v130, v130, v134
  v_add_f32 v131, v131, v135
  v_add_f32 v136, v136, v140
  v_add_f32 v137, v137, v141
  v_add_f32 v138, v138, v142
  v_add_f32 v139, v139, v143
  v_add_f32 v236, v236, v128
  v_add_f32 v237, v237, v129
  v_add_f32 v238, v238, v130
  v_add_f32 v239, v239, v131
  v_add_f32 v136, v136, v46
  v_add_f32 v137, v137, v47
  v_add_f32 v138, v138, v48
  v_add_f32 v139, v139, v49
  v_mul_f32 v248, 0xbfb8aa3b, v236
  v_mul_f32 v249, 0xbfb8aa3b, v237
  v_mul_f32 v250, 0xbfb8aa3b, v238
  v_mul_f32 v251, 0xbfb8aa3b, v239
  v_exp_f32 v248, v248
  v_exp_f32 v249, v249
  v_exp_f32 v250, v250
  v_exp_f32 v251, v251
  v_mul_f32 v136, v136, v236
  v_mul_f32 v137, v137, v237
  v_mul_f32 v138, v138, v238
  v_mul_f32 v139, v139, v239
  v_add_f32 v248, 1.0, v248
  v_add_f32 v249, 1.0, v249
  v_add_f32 v250, 1.0, v250
  v_add_f32 v251, 1.0, v251
  v_rcp_f32 v248, v248
  v_rcp_f32 v249, v249
  v_rcp_f32 v250, v250
  v_rcp_f32 v251, v251
  v_fma_f32 v136, v136, v248, v26
  v_fma_f32 v137, v137, v249, v27
  v_fma_f32 v138, v138, v250, v28
  v_fma_f32 v139, v139, v251, v29
  buffer_store_dwordx4 v[136:139], v8, s[60:63], s8 offen offset:192 sc1
  s_waitcnt lgkmcnt(0)
  v_add_f32 v240, v240, v144
  v_add_f32 v241, v241, v145
  v_add_f32 v242, v242, v146
  v_add_f32 v243, v243, v147
  v_add_f32 v148, v148, v152
  v_add_f32 v149, v149, v153
  v_add_f32 v150, v150, v154
  v_add_f32 v151, v151, v155
  v_add_f32 v156, v156, v160
  v_add_f32 v157, v157, v161
  v_add_f32 v158, v158, v162
  v_add_f32 v159, v159, v163
  v_add_f32 v240, v240, v148
  v_add_f32 v241, v241, v149
  v_add_f32 v242, v242, v150
  v_add_f32 v243, v243, v151
  v_add_f32 v156, v156, v50
  v_add_f32 v157, v157, v51
  v_add_f32 v158, v158, v52
  v_add_f32 v159, v159, v53
  v_mul_f32 v248, 0xbfb8aa3b, v240
  v_mul_f32 v249, 0xbfb8aa3b, v241
  v_mul_f32 v250, 0xbfb8aa3b, v242
  v_mul_f32 v251, 0xbfb8aa3b, v243
  v_exp_f32 v248, v248
  v_exp_f32 v249, v249
  v_exp_f32 v250, v250
  v_exp_f32 v251, v251
  v_mul_f32 v156, v156, v240
  v_mul_f32 v157, v157, v241
  v_mul_f32 v158, v158, v242
  v_mul_f32 v159, v159, v243
  v_add_f32 v248, 1.0, v248
  v_add_f32 v249, 1.0, v249
  v_add_f32 v250, 1.0, v250
  v_add_f32 v251, 1.0, v251
  v_rcp_f32 v248, v248
  v_rcp_f32 v249, v249
  v_rcp_f32 v250, v250
  v_rcp_f32 v251, v251
  v_fma_f32 v156, v156, v248, v30
  v_fma_f32 v157, v157, v249, v31
  v_fma_f32 v158, v158, v250, v32
  v_fma_f32 v159, v159, v251, v33
  buffer_store_dwordx4 v[156:159], v8, s[60:63], s8 offen offset:256 sc1
L_END:
  s_endpgm
L_slow_2:
  s_mov_b32 s94, 0
  s_mov_b32 s60, s44
  s_mov_b32 s61, s45
  s_mov_b32 s62, 0x100
  s_mov_b32 s63, 0x20000
L_sl_4:
  s_sleep 1
  buffer_load_dword v55, v56, s[60:63], 0 offen sc1
  s_waitcnt vmcnt(0)
  v_readfirstlane_b32 s6, v55
  s_nop 1
  s_cmp_lg_u32 s6, 0
  s_cbranch_scc1 L_back_3
  s_add_u32 s94, s94, 1
  s_cmp_lt_u32 s94, 0x40000
  s_cbranch_scc1 L_sl_4
  s_branch L_back_3
L_slow_5:
  s_mov_b32 s94, 0
L_sl_7:
  s_sleep 1
  s_lshl_b32 s8, s4, 2
  s_add_u32 s8, s8, s3
  s_lshl_b32 s8, s8, 8
  s_add_u32 s8, s8, 0x1000000
  buffer_load_dwordx2 v[38:39], v37, s[56:59], s8 offen sc1
  s_waitcnt vmcnt(0)
  v_xor_b32 v60, s6, v39
  v_cmp_ne_u32 vcc, 0, v60
  s_nop 1
  s_cmp_eq_u64 vcc, 0
  s_cbranch_scc1 L_back_6
  s_add_u32 s94, s94, 1
  s_cmp_lt_u32 s94, 0x40000
  s_cbranch_scc1 L_sl_7
  s_branch L_back_6
L_slow_8:
  s_mov_b32 s94, 0
L_sl_10:
  s_sleep 1
  s_mul_i32 s8, s91, 1024
  s_add_u32 s8, s8, 0x1050000
  s_add_u32 s9, s8, 27648
  buffer_load_dwordx2 v[224:225], v42, s[56:59], s8 offen offset:0 sc1
  buffer_load_dwordx2 v[226:227], v42, s[56:59], s8 offen offset:512 sc1
  buffer_load_dwordx2 v[228:229], v42, s[56:59], s9 offen offset:0 sc1
  buffer_load_dwordx2 v[230:231], v42, s[56:59], s9 offen offset:512 sc1
  s_waitcnt vmcnt(0)
  v_xor_b32 v60, s6, v225
  v_xor_b32 v61, s6, v227
  v_or_b32 v60, v60, v61
  v_xor_b32 v61, s6, v229
  v_or_b32 v60, v60, v61
  v_xor_b32 v61, s6, v231
  v_or_b32 v60, v60, v61
  v_cmp_ne_u32 vcc, 0, v60
  s_nop 1
  s_cmp_eq_u64 vcc, 0
  s_cbranch_scc1 L_back_9
  s_add_u32 s94, s94, 1
  s_cmp_lt_u32 s94, 0x40000
  s_cbranch_scc1 L_sl_10
  s_branch L_back_9
L_slow_11:
  s_mov_b32 s94, 0
L_sl_13:
  s_sleep 1
  buffer_load_dwordx4 v[40:43], v54, s[56:59], s93 offen sc1
  s_waitcnt vmcnt(0)
  s_mov_b64 s[12:13], 0
  v_cmp_ne_u32 vcc, s6, v40
  s_nop 0
  s_or_b64 s[12:13], s[12:13], vcc
  v_cmp_ne_u32 vcc, s6, v41
  s_nop 0
  s_or_b64 s[12:13], s[12:13], vcc
  v_cmp_ne_u32 vcc, s6, v42
  s_nop 0
  s_or_b64 s[12:13], s[12:13], vcc
  v_cmp_ne_u32 vcc, s6, v43
  s_nop 0
  s_or_b64 s[12:13], s[12:13], vcc
  s_cmp_eq_u64 s[12:13], 0
  s_cbranch_scc1 L_back_12
  s_add_u32 s94, s94, 1
  s_cmp_lt_u32 s94, 0x40000
  s_cbranch_scc1 L_sl_13
  s_branch L_back_12
L_slow_14:
  s_mov_b32 s94, 0
  s_mov_b32 s60, s44
  s_mov_b32 s61, s45
  s_mov_b32 s62, 0x100
  s_mov_b32 s63, 0x20000
L_sl_16:
  s_sleep 1
  buffer_load_dword v55, v56, s[60:63], 0 offen sc1
  s_waitcnt vmcnt(0)
  v_readfirstlane_b32 s6, v55
  s_nop 1
  s_cmp_lg_u32 s6, 0
  s_cbranch_scc1 L_back_15
  s_add_u32 s94, s94, 1
  s_cmp_lt_u32 s94, 0x40000
  s_cbranch_scc1 L_sl_16
  s_branch L_back_15
L_slow_17:
  s_mov_b32 s94, 0
L_sl_19:
  s_sleep 1
  s_lshl_b32 s8, s4, 2
  s_add_u32 s8, s8, s3
  s_lshl_b32 s8, s8, 8
  s_add_u32 s8, s8, 0x1000000
  buffer_load_dwordx2 v[32:33], v56, s[56:59], s8 offen sc1
  s_waitcnt vmcnt(0)
  v_xor_b32 v60, s6, v33
  v_cmp_ne_u32 vcc, 0, v60
  s_nop 1
  s_cmp_eq_u64 vcc, 0
  s_cbranch_scc1 L_back_18
  s_add_u32 s94, s94, 1
  s_cmp_lt_u32 s94, 0x40000
  s_cbranch_scc1 L_sl_19
  s_branch L_back_18
L_slow_20:
  s_mov_b32 s94, 0
L_sl_22:
  s_sleep 1
  s_mul_i32 s8, s5, 768
  s_add_u32 s8, s8, 0x10a0000
  s_add_u32 s9, s8, 5120
  s_movk_i32 s11, 512
  s_cmp_eq_u32 s5, 6
  s_cselect_b32 s10, 256, s11
  s_add_u32 s11, s9, s10
  s_add_u32 s10, s8, s10
  buffer_load_dwordx2 v[160:161], v54, s[56:59], s8 offen offset:0 sc1
  buffer_load_dwordx2 v[162:163], v54, s[56:59], s9 offen offset:0 sc1
  buffer_load_dwordx2 v[164:165], v54, s[56:59], s8 offen offset:256 sc1
  buffer_load_dwordx2 v[166:167], v54, s[56:59], s9 offen offset:256 sc1
  buffer_load_dwordx2 v[168:169], v54, s[56:59], s10 offen sc1
  buffer_load_dwordx2 v[170:171], v54, s[56:59], s11 offen sc1
  s_waitcnt vmcnt(0)
  v_xor_b32 v60, s6, v161
  v_xor_b32 v61, s6, v163
  v_or_b32 v60, v60, v61
  v_xor_b32 v61, s6, v165
  v_or_b32 v60, v60, v61
  v_xor_b32 v61, s6, v167
  v_or_b32 v60, v60, v61
  v_xor_b32 v61, s6, v169
  v_or_b32 v60, v60, v61
  v_xor_b32 v61, s6, v171
  v_or_b32 v60, v60, v61
  v_cmp_ne_u32 vcc, 0, v60
  s_nop 1
  s_cmp_eq_u64 vcc, 0
  s_cbranch_scc1 L_back_21
  s_add_u32 s94, s94, 1
  s_cmp_lt_u32 s94, 0x40000
  s_cbranch_scc1 L_sl_22
  s_branch L_back_21
L_slow_23:
  s_mov_b32 s94, 0
L_sl_25:
  buffer_load_dwordx4 v[240:243], v16, s[56:59], s86 offen offset:0 sc1
  buffer_load_dwordx4 v[244:247], v16, s[56:59], s87 offen offset:0 sc1
  buffer_load_dwordx4 v[248:251], v16, s[56:59], s88 offen offset:0 sc1
  buffer_load_dwordx4 v[252:255], v16, s[56:59], s89 offen offset:0 sc1
  s_waitcnt vmcnt(0)
  s_cmp_ge_u32 s86, 0x40000000
  s_cselect_b32 s8, 0, s6
  v_xor_b32 v60, s8, v241
  v_xor_b32 v61, s8, v243
  v_or_b32 v62, v60, v61
  s_cmp_ge_u32 s87, 0x40000000
  s_cselect_b32 s8, 0, s6
  v_xor_b32 v60, s8, v245
  v_xor_b32 v61, s8, v247
  v_or3_b32 v62, v60, v61, v62
  s_cmp_ge_u32 s88, 0x40000000
  s_cselect_b32 s8, 0, s6
  v_xor_b32 v60, s8, v249
  v_xor_b32 v61, s8, v251
  v_or3_b32 v62, v60, v61, v62
  s_cmp_ge_u32 s89, 0x40000000
  s_cselect_b32 s8, 0, s6
  v_xor_b32 v60, s8, v253
  v_xor_b32 v61, s8, v255
  v_or3_b32 v62, v60, v61, v62
  v_cmp_ne_u32 vcc, 0, v62
  s_nop 1
  s_cmp_eq_u64 vcc, 0
  s_cbranch_scc1 L_back_24
  s_add_u32 s94, s94, 1
  s_cmp_lt_u32 s94, 0x40000
  s_cbranch_scc1 L_sl_25
  s_branch L_back_24
L_slow_27:
  s_mov_b32 s94, 0
L_sl_29:
  buffer_load_dwordx4 v[224:227], v16, s[56:59], s86 offen offset:1024 sc1
  buffer_load_dwordx4 v[228:231], v16, s[56:59], s87 offen offset:1024 sc1
  buffer_load_dwordx4 v[232:235], v16, s[56:59], s88 offen offset:1024 sc1
  buffer_load_dwordx4 v[236:239], v16, s[56:59], s89 offen offset:1024 sc1
  s_waitcnt vmcnt(0)
  s_cmp_ge_u32 s86, 0x40000000
  s_cselect_b32 s8, 0, s6
  v_xor_b32 v60, s8, v225
  v_xor_b32 v61, s8, v227
  v_or_b32 v62, v60, v61
  s_cmp_ge_u32 s87, 0x40000000
  s_cselect_b32 s8, 0, s6
  v_xor_b32 v60, s8, v229
  v_xor_b32 v61, s8, v231
  v_or3_b32 v62, v60, v61, v62
  s_cmp_ge_u32 s88, 0x40000000
  s_cselect_b32 s8, 0, s6
  v_xor_b32 v60, s8, v233
  v_xor_b32 v61, s8, v235
  v_or3_b32 v62, v60, v61, v62
  s_cmp_ge_u32 s89, 0x40000000
  s_cselect_b32 s8, 0, s6
  v_xor_b32 v60, s8, v237
  v_xor_b32 v61, s8, v239
  v_or3_b32 v62, v60, v61, v62
  v_cmp_ne_u32 vcc, 0, v62
  s_nop 1
  s_cmp_eq_u64 vcc, 0
  s_cbranch_scc1 L_back_28
  s_add_u32 s94, s94, 1
  s_cmp_lt_u32 s94, 0x40000
  s_cbranch_scc1 L_sl_29
  s_branch L_back_28
L_slow_31:
  s_mov_b32 s94, 0
L_sl_33:
  s_sleep 1
  buffer_load_dwordx4 v[240:243], v54, s[56:59], s93 offen sc1
  s_waitcnt vmcnt(0)
  s_mov_b64 s[12:13], 0
  v_cmp_ne_u32 vcc, s6, v240
  s_nop 0
  s_or_b64 s[12:13], s[12:13], vcc
  v_cmp_ne_u32 vcc, s6, v241
  s_nop 0
  s_or_b64 s[12:13], s[12:13], vcc
  v_cmp_ne_u32 vcc, s6, v242
  s_nop 0
  s_or_b64 s[12:13], s[12:13], vcc
  v_cmp_ne_u32 vcc, s6, v243
  s_nop 0
  s_or_b64 s[12:13], s[12:13], vcc
  s_cmp_eq_u64 s[12:13], 0
  s_cbranch_scc1 L_back_32
  s_add_u32 s94, s94, 1
  s_cmp_lt_u32 s94, 0x40000
  s_cbranch_scc1 L_sl_33
  s_branch L_back_32
L_slow_38:
  s_mov_b32 s94, 0
L_sl_40:
  s_sleep 1
  buffer_load_dword v9, v4, s[56:59], s89 offen sc1
  s_waitcnt vmcnt(0)
  v_cmp_ne_u32 vcc, s6, v9
  s_nop 1
  s_andn2_b64 vcc, vcc, s[98:99]
  s_cmp_eq_u64 vcc, 0
  s_cbranch_scc1 L_back_39
  s_add_u32 s94, s94, 1
  s_cmp_lt_u32 s94, 0x40000
  s_cbranch_scc1 L_sl_40
  s_branch L_back_39
L_slow_41:
  s_mov_b32 s94, 0
L_sl_43:
  s_sleep 1
  buffer_load_dword v9, v4, s[56:59], s89 offen sc1
  s_waitcnt vmcnt(0)
  v_cmp_ne_u32 vcc, s6, v9
  s_nop 1
  s_and_b64 vcc, vcc, s[98:99]
  s_cmp_eq_u64 vcc, 0
  s_cbranch_scc1 L_back_42
  s_add_u32 s94, s94, 1
  s_cmp_lt_u32 s94, 0x40000
  s_cbranch_scc1 L_sl_43
  s_branch L_back_42
L_CODE_END:
  s_endpgm
.section .rodata,"a"
.p2align 6
.amdhsa_kernel recurrent_scan__ssm_conv_s5__geglu_ffn__prompt_kernel
  .amdhsa_next_free_vgpr 512
  .amdhsa_next_free_sgpr 102
  .amdhsa_accum_offset 256
  .amdhsa_group_segment_fixed_size 0
  .amdhsa_kernarg_size 128
  .amdhsa_user_sgpr_count 2
  .amdhsa_user_sgpr_kernarg_segment_ptr 1
  .amdhsa_system_sgpr_workgroup_id_x 1
.end_amdhsa_kernel
```
